```python
import torch

def _softmax(x, axis=-1):
    return torch.softmax(x, dim=axis)

def _gelu(x):
    return torch.nn.functional.gelu(x, approximate='tanh')

def _silu(x):
    return torch.nn.functional.silu(x)

def _sigmoid(x):
    return torch.sigmoid(x)

def _layernorm(x, axis=-1, eps=1e-05):
    m = x.mean(dim=axis, keepdim=True)
    v = x.var(dim=axis, keepdim=True, unbiased=False)
    return (x - m) / torch.sqrt(v + eps)

def _scatter_add(tgt, idx, src, axis=0):
    return tgt.clone().index_add_(axis, idx, src)

def _segment_sum(src, seg, n):
    out = torch.zeros((n,) + src.shape[1:], dtype=src.dtype)
    return out.index_add_(0, seg, src)

def _pad(x, pw):
    flat = tuple((v for pair in reversed(pw) for v in pair))
    return torch.nn.functional.pad(x, flat)
kernel_name = 'sequential_preLN__sliding_block__mixer_gmlp__prompt'

def setup_inputs():

    _w = lambda a: (lambda t: t.to(torch.bfloat16) if t.is_floating_point() else t)(torch.as_tensor(a))

    def _A_setup():
        B, S, D = (1, 2048, 448)
        return {'x': _w((lambda *s: torch.randn(*s, dtype=torch.bfloat16) * 0.05)(B, S, D)), 'wqkv': _w((lambda *s: torch.randn(*s, dtype=torch.bfloat16) * 0.05)(D, 3 * D)), 'wo': _w((lambda *s: torch.randn(*s, dtype=torch.bfloat16) * 0.05)(D, D))}
    _A_in = _A_setup()

    def _B_setup():
        B, S, D, F = (1, 2048, 448, 1792)
        Fh = F // 2
        return {'x': _w((lambda *s: torch.randn(*s, dtype=torch.bfloat16) * 0.05)(B, S, D)), 'w_in': _w((lambda *s: torch.randn(*s, dtype=torch.bfloat16) * 0.4)(D, 2 * Fh)), 'w_sp': _w(0.01 * (lambda *s: torch.randn(*s, dtype=torch.bfloat16) * 0.4)(S, S)), 'b_sp': _w(1.0 + 0.01 * (lambda *s: torch.randn(*s, dtype=torch.bfloat16) * 0.05)(S)), 'w_out': _w((lambda *s: torch.randn(*s, dtype=torch.bfloat16) * 0.05)(Fh, D))}
    _B_in = _B_setup()
    return {'A_x': _A_in['x'], 'A_wqkv': _A_in['wqkv'], 'A_wo': _A_in['wo'], 'B_x': _B_in['x'], 'B_w_in': _B_in['w_in'], 'B_w_sp': _B_in['w_sp'], 'B_b_sp': _B_in['b_sp'], 'B_w_out': _B_in['w_out']}

def reference(A_x, A_wqkv, A_wo, B_x, B_w_in, B_w_sp, B_b_sp, B_w_out):

    def _A_ref(x, wqkv, wo):
        B, S, D = x.shape
        H = 16
        Dh = D // H
        W = 256
        qkv = (lambda x, *d: x.permute(*d))((x @ wqkv).reshape(B, S, 3, H, Dh), 2, 0, 3, 1, 4)
        q, k, v = (qkv[0], qkv[1], qkv[2])
        scores = torch.einsum('bhqd,bhkd->bhqk', q, k) * Dh ** (-0.5)
        idx = torch.arange(S)
        mask = (idx[:, None] - idx[None, :] >= 0) & (idx[:, None] - idx[None, :] < W)
        scores = torch.where(mask[None, None], scores, -1000000000.0)
        p = _softmax(scores, axis=-1)
        o = torch.einsum('bhqk,bhkd->bhqd', p, v)
        return (lambda x, *d: x.permute(*d))(o, 0, 2, 1, 3).reshape(B, S, D) @ wo

    def _B_ref(x, w_in, w_sp, b_sp, w_out):
        B, S, D = x.shape
        F = w_in.shape[-1]
        Fh = F // 2
        z = _gelu(torch.einsum('bsd,df->bsf', x, w_in))
        z1 = z[..., :Fh].clone()
        z2 = _layernorm(z[..., Fh:], axis=-1)
        g = torch.einsum('ts,bsf->btf', w_sp, z2) + b_sp[None, :, None]
        return torch.einsum('bsf,fd->bsd', z1 * g, w_out)
    x = A_x
    h = x + _A_ref(_layernorm(x, axis=-1), A_wqkv, A_wo)
    h2 = h + _B_ref(_layernorm(h, axis=-1), B_w_in, B_w_sp, B_b_sp, B_w_out)
    return h2
```

```asm
; @launch kernel=k1_qkv_kernel grid=(256,1,1) block=(512,1,1) lds=154624
; @launch kernel=k2_attn_kernel grid=(256,1,1) block=(512,1,1) lds=49152
; @launch kernel=k3_wo_kernel grid=(256,1,1) block=(512,1,1) lds=132096
; @launch kernel=k4_win_kernel grid=(256,1,1) block=(512,1,1) lds=156160
; @launch kernel=k5_sp_kernel grid=(256,1,1) block=(512,1,1) lds=163840
; @launch kernel=k6_wout_kernel grid=(224,1,1) block=(512,1,1) lds=147456
.amdgcn_target "amdgcn-amd-amdhsa--gfx950"
.text
.globl k1_qkv_kernel
.p2align 8
.type k1_qkv_kernel,@function
k1_qkv_kernel:
  s_cmp_ge_u32 s2, 256
  s_cbranch_scc1 k1_qkv_kernel_done_1
  s_load_dwordx4 s[4:7], s[0:1], 0
  s_load_dwordx2 s[8:9], s[0:1], 80
  v_lshrrev_b32 v4, 6, v0
  v_and_b32 v1, 63, v0
  v_readfirstlane_b32 s24, v4
  s_and_b32 s27, s2, 7
  s_lshr_b32 s28, s2, 3
  s_and_b32 s26, s28, 7
  s_lshr_b32 s28, s28, 3
  s_lshr_b32 s25, s27, 1
  s_lshl_b32 s25, s25, 2
  s_add_u32 s25, s25, s28
  s_and_b32 s27, s27, 1
  s_lshl_b32 s27, s27, 3
  s_add_u32 s26, s26, s27
  s_and_b32 s30, s24, 3
  v_and_b32 v7, 15, v1
  s_cmp_lt_u32 s24, 4
  s_cbranch_scc1 k1_qkv_kernel_compute_2
  v_lshrrev_b32 v4, 3, v1
  v_mul_u32_u24 v4, 896, v4
  v_lshrrev_b32 v5, 4, v1
  v_and_b32 v6, 7, v1
  v_xor_b32 v5, v5, v6
  v_lshl_add_u32 v8, v5, 4, v4
  v_xor_b32 v5, 4, v5
  v_lshl_add_u32 v9, v5, 4, v4
  v_add_u32 v9, 7168, v9
  v_add_u32 v10, 14336, v8
  v_add_u32 v11, 14336, v9
  v_mov_b32 v15, 0x7fffff00
  v_add_u32 v4, 0, v1
  v_mul_u32_u24 v5, 171, v4
  v_lshrrev_b32 v5, 11, v5
  v_mul_u32_u24 v6, 12, v5
  v_sub_u32 v4, v4, v6
  v_mul_u32_u24 v5, 2688, v5
  v_lshl_add_u32 v5, v4, 4, v5
  v_cmp_gt_u32 vcc, 11, v4
  s_nop 1
  v_cndmask_b32 v12, v15, v5, vcc
  v_add_u32 v4, 64, v1
  v_mul_u32_u24 v5, 171, v4
  v_lshrrev_b32 v5, 11, v5
  v_mul_u32_u24 v6, 12, v5
  v_sub_u32 v4, v4, v6
  v_mul_u32_u24 v5, 2688, v5
  v_lshl_add_u32 v5, v4, 4, v5
  v_cmp_gt_u32 vcc, 11, v4
  s_nop 1
  v_cndmask_b32 v13, v15, v5, vcc
  v_add_u32 v4, 128, v1
  v_mul_u32_u24 v5, 171, v4
  v_lshrrev_b32 v5, 11, v5
  v_mul_u32_u24 v6, 12, v5
  v_sub_u32 v4, v4, v6
  v_mul_u32_u24 v5, 2688, v5
  v_lshl_add_u32 v5, v4, 4, v5
  v_cmp_gt_u32 vcc, 11, v4
  s_nop 1
  v_cndmask_b32 v14, v15, v5, vcc
  s_mul_i32 s31, s26, 168
  s_mul_i32 s27, s30, 43008
  s_add_u32 s31, s31, s27
  s_mul_i32 s32, s30, 3072
  s_lshl_b32 s27, s25, 7
  s_lshl_b32 s28, s30, 5
  s_add_u32 s27, s27, s28
  s_mul_i32 s33, s27, 896
  s_mul_i32 s34, s30, 16384
  s_add_u32 s34, s34, 86016
  s_lshl_b32 s27, s25, 1
  s_add_u32 s27, s27, s26
  s_mul_i32 s28, s27, 37
  s_lshr_b32 s28, s28, 8
  s_mul_i32 s28, s28, 7
  s_sub_u32 s35, s27, s28
  s_waitcnt lgkmcnt(0)
  s_mov_b32 s16, s6
  s_and_b32 s17, s7, 0xffff
  s_mov_b32 s18, 0x126000
  s_mov_b32 s19, 0x20000
  s_mov_b32 s12, s4
  s_and_b32 s13, s5, 0xffff
  s_mov_b32 s14, 0x1c0000
  s_mov_b32 s15, 0x20000
  s_add_u32 s36, s35, 0
  s_cmp_ge_u32 s36, 7
  s_cselect_b32 s3, 7, 0
  s_sub_u32 s36, s36, s3
  s_mul_i32 s37, s36, 172032
  s_add_u32 s37, s37, s31
  s_add_u32 m0, s32, 0x0
  s_nop 0
  buffer_load_dwordx4 v12, s[16:19], s37 offen lds
  s_add_u32 m0, s32, 0x400
  s_nop 0
  buffer_load_dwordx4 v13, s[16:19], s37 offen lds
  s_add_u32 m0, s32, 0x800
  s_nop 0
  buffer_load_dwordx4 v14, s[16:19], s37 offen lds
  s_add_u32 s36, s35, 0
  s_cmp_ge_u32 s36, 7
  s_cselect_b32 s3, 7, 0
  s_sub_u32 s36, s36, s3
  s_lshl_b32 s29, s36, 7
  s_add_u32 s29, s29, s33
  s_add_u32 m0, s34, 0x0
  s_nop 0
  buffer_load_dwordx4 v8, s[12:15], s29 offen lds
  s_add_u32 m0, s34, 0x400
  s_nop 0
  buffer_load_dwordx4 v9, s[12:15], s29 offen lds
  s_add_u32 m0, s34, 0x800
  s_nop 0
  buffer_load_dwordx4 v10, s[12:15], s29 offen lds
  s_add_u32 m0, s34, 0xc00
  s_nop 0
  buffer_load_dwordx4 v11, s[12:15], s29 offen lds
  s_add_u32 s36, s35, 1
  s_cmp_ge_u32 s36, 7
  s_cselect_b32 s3, 7, 0
  s_sub_u32 s36, s36, s3
  s_mul_i32 s37, s36, 172032
  s_add_u32 s37, s37, s31
  s_add_u32 m0, s32, 0x3000
  s_nop 0
  buffer_load_dwordx4 v12, s[16:19], s37 offen lds
  s_add_u32 m0, s32, 0x3400
  s_nop 0
  buffer_load_dwordx4 v13, s[16:19], s37 offen lds
  s_add_u32 m0, s32, 0x3800
  s_nop 0
  buffer_load_dwordx4 v14, s[16:19], s37 offen lds
  s_add_u32 s36, s35, 1
  s_cmp_ge_u32 s36, 7
  s_cselect_b32 s3, 7, 0
  s_sub_u32 s36, s36, s3
  s_lshl_b32 s29, s36, 7
  s_add_u32 s29, s29, s33
  s_add_u32 m0, s34, 0x1000
  s_nop 0
  buffer_load_dwordx4 v8, s[12:15], s29 offen lds
  s_add_u32 m0, s34, 0x1400
  s_nop 0
  buffer_load_dwordx4 v9, s[12:15], s29 offen lds
  s_add_u32 m0, s34, 0x1800
  s_nop 0
  buffer_load_dwordx4 v10, s[12:15], s29 offen lds
  s_add_u32 m0, s34, 0x1c00
  s_nop 0
  buffer_load_dwordx4 v11, s[12:15], s29 offen lds
  s_add_u32 s36, s35, 2
  s_cmp_ge_u32 s36, 7
  s_cselect_b32 s3, 7, 0
  s_sub_u32 s36, s36, s3
  s_mul_i32 s37, s36, 172032
  s_add_u32 s37, s37, s31
  s_add_u32 m0, s32, 0x6000
  s_nop 0
  buffer_load_dwordx4 v12, s[16:19], s37 offen lds
  s_add_u32 m0, s32, 0x6400
  s_nop 0
  buffer_load_dwordx4 v13, s[16:19], s37 offen lds
  s_add_u32 m0, s32, 0x6800
  s_nop 0
  buffer_load_dwordx4 v14, s[16:19], s37 offen lds
  s_waitcnt vmcnt(10)
  s_barrier
  s_add_u32 s36, s35, 2
  s_cmp_ge_u32 s36, 7
  s_cselect_b32 s3, 7, 0
  s_sub_u32 s36, s36, s3
  s_lshl_b32 s29, s36, 7
  s_add_u32 s29, s29, s33
  s_add_u32 m0, s34, 0x2000
  s_nop 0
  buffer_load_dwordx4 v8, s[12:15], s29 offen lds
  s_add_u32 m0, s34, 0x2400
  s_nop 0
  buffer_load_dwordx4 v9, s[12:15], s29 offen lds
  s_add_u32 m0, s34, 0x2800
  s_nop 0
  buffer_load_dwordx4 v10, s[12:15], s29 offen lds
  s_add_u32 m0, s34, 0x2c00
  s_nop 0
  buffer_load_dwordx4 v11, s[12:15], s29 offen lds
  s_add_u32 s36, s35, 3
  s_cmp_ge_u32 s36, 7
  s_cselect_b32 s3, 7, 0
  s_sub_u32 s36, s36, s3
  s_mul_i32 s37, s36, 172032
  s_add_u32 s37, s37, s31
  s_add_u32 m0, s32, 0x9000
  s_nop 0
  buffer_load_dwordx4 v12, s[16:19], s37 offen lds
  s_add_u32 m0, s32, 0x9400
  s_nop 0
  buffer_load_dwordx4 v13, s[16:19], s37 offen lds
  s_add_u32 m0, s32, 0x9800
  s_nop 0
  buffer_load_dwordx4 v14, s[16:19], s37 offen lds
  s_waitcnt vmcnt(10)
  s_barrier
  s_add_u32 s36, s35, 3
  s_cmp_ge_u32 s36, 7
  s_cselect_b32 s3, 7, 0
  s_sub_u32 s36, s36, s3
  s_lshl_b32 s29, s36, 7
  s_add_u32 s29, s29, s33
  s_add_u32 m0, s34, 0x3000
  s_nop 0
  buffer_load_dwordx4 v8, s[12:15], s29 offen lds
  s_add_u32 m0, s34, 0x3400
  s_nop 0
  buffer_load_dwordx4 v9, s[12:15], s29 offen lds
  s_add_u32 m0, s34, 0x3800
  s_nop 0
  buffer_load_dwordx4 v10, s[12:15], s29 offen lds
  s_add_u32 m0, s34, 0x3c00
  s_nop 0
  buffer_load_dwordx4 v11, s[12:15], s29 offen lds
  s_add_u32 s36, s35, 4
  s_cmp_ge_u32 s36, 7
  s_cselect_b32 s3, 7, 0
  s_sub_u32 s36, s36, s3
  s_mul_i32 s37, s36, 172032
  s_add_u32 s37, s37, s31
  s_add_u32 m0, s32, 0xc000
  s_nop 0
  buffer_load_dwordx4 v12, s[16:19], s37 offen lds
  s_add_u32 m0, s32, 0xc400
  s_nop 0
  buffer_load_dwordx4 v13, s[16:19], s37 offen lds
  s_add_u32 m0, s32, 0xc800
  s_nop 0
  buffer_load_dwordx4 v14, s[16:19], s37 offen lds
  s_waitcnt vmcnt(10)
  s_barrier
  s_add_u32 s36, s35, 4
  s_cmp_ge_u32 s36, 7
  s_cselect_b32 s3, 7, 0
  s_sub_u32 s36, s36, s3
  s_lshl_b32 s29, s36, 7
  s_add_u32 s29, s29, s33
  s_add_u32 m0, s34, 0x0
  s_nop 0
  buffer_load_dwordx4 v8, s[12:15], s29 offen lds
  s_add_u32 m0, s34, 0x400
  s_nop 0
  buffer_load_dwordx4 v9, s[12:15], s29 offen lds
  s_add_u32 m0, s34, 0x800
  s_nop 0
  buffer_load_dwordx4 v10, s[12:15], s29 offen lds
  s_add_u32 m0, s34, 0xc00
  s_nop 0
  buffer_load_dwordx4 v11, s[12:15], s29 offen lds
  s_add_u32 s36, s35, 5
  s_cmp_ge_u32 s36, 7
  s_cselect_b32 s3, 7, 0
  s_sub_u32 s36, s36, s3
  s_mul_i32 s37, s36, 172032
  s_add_u32 s37, s37, s31
  s_add_u32 m0, s32, 0xf000
  s_nop 0
  buffer_load_dwordx4 v12, s[16:19], s37 offen lds
  s_add_u32 m0, s32, 0xf400
  s_nop 0
  buffer_load_dwordx4 v13, s[16:19], s37 offen lds
  s_add_u32 m0, s32, 0xf800
  s_nop 0
  buffer_load_dwordx4 v14, s[16:19], s37 offen lds
  s_waitcnt vmcnt(10)
  s_barrier
  s_add_u32 s36, s35, 5
  s_cmp_ge_u32 s36, 7
  s_cselect_b32 s3, 7, 0
  s_sub_u32 s36, s36, s3
  s_lshl_b32 s29, s36, 7
  s_add_u32 s29, s29, s33
  s_add_u32 m0, s34, 0x1000
  s_nop 0
  buffer_load_dwordx4 v8, s[12:15], s29 offen lds
  s_add_u32 m0, s34, 0x1400
  s_nop 0
  buffer_load_dwordx4 v9, s[12:15], s29 offen lds
  s_add_u32 m0, s34, 0x1800
  s_nop 0
  buffer_load_dwordx4 v10, s[12:15], s29 offen lds
  s_add_u32 m0, s34, 0x1c00
  s_nop 0
  buffer_load_dwordx4 v11, s[12:15], s29 offen lds
  s_add_u32 s36, s35, 6
  s_cmp_ge_u32 s36, 7
  s_cselect_b32 s3, 7, 0
  s_sub_u32 s36, s36, s3
  s_mul_i32 s37, s36, 172032
  s_add_u32 s37, s37, s31
  s_add_u32 m0, s32, 0x12000
  s_nop 0
  buffer_load_dwordx4 v12, s[16:19], s37 offen lds
  s_add_u32 m0, s32, 0x12400
  s_nop 0
  buffer_load_dwordx4 v13, s[16:19], s37 offen lds
  s_add_u32 m0, s32, 0x12800
  s_nop 0
  buffer_load_dwordx4 v14, s[16:19], s37 offen lds
  s_waitcnt vmcnt(10)
  s_barrier
  s_add_u32 s36, s35, 6
  s_cmp_ge_u32 s36, 7
  s_cselect_b32 s3, 7, 0
  s_sub_u32 s36, s36, s3
  s_lshl_b32 s29, s36, 7
  s_add_u32 s29, s29, s33
  s_add_u32 m0, s34, 0x2000
  s_nop 0
  buffer_load_dwordx4 v8, s[12:15], s29 offen lds
  s_add_u32 m0, s34, 0x2400
  s_nop 0
  buffer_load_dwordx4 v9, s[12:15], s29 offen lds
  s_add_u32 m0, s34, 0x2800
  s_nop 0
  buffer_load_dwordx4 v10, s[12:15], s29 offen lds
  s_add_u32 m0, s34, 0x2c00
  s_nop 0
  buffer_load_dwordx4 v11, s[12:15], s29 offen lds
  s_waitcnt vmcnt(7)
  s_barrier
  s_waitcnt vmcnt(0)
  s_barrier
  s_barrier
  s_endpgm
k1_qkv_kernel_compute_2:
  s_lshr_b32 s38, s2, 3
  s_getpc_b64 s[40:41]
k1_qkv_kernel_pc_3:
  s_add_u32 s40, s40, k2_attn_kernel-k1_qkv_kernel_pc_3
  s_addc_u32 s41, s41, 0
  s_mov_b32 s44, s40
  s_and_b32 s45, s41, 0xffff
  s_mov_b32 s46, k2_attn_kernel_end-k2_attn_kernel
  s_mov_b32 s47, 0x20000
  s_lshl_b32 s27, s38, 8
  v_add_u32 v8, s27, v0
  v_lshlrev_b32 v8, 7, v8
  buffer_load_dword v9, v8, s[44:47], 0 offen
  s_mul_i32 s48, s24, 16384
  s_add_u32 s48, s48, 86016
  v_and_b32 v2, 31, v0
  v_bfe_u32 v3, v0, 5, 1
  v_lshrrev_b32 v25, 4, v1
  v_bfe_u32 v4, v2, 1, 3
  v_add_u32 v5, 0, v3
  v_xor_b32 v5, v5, v4
  v_lshlrev_b32 v5, 4, v5
  v_lshl_add_u32 v12, v2, 7, v5
  v_add_u32 v12, s48, v12
  v_add_u32 v5, 2, v3
  v_xor_b32 v5, v5, v4
  v_lshlrev_b32 v5, 4, v5
  v_lshl_add_u32 v13, v2, 7, v5
  v_add_u32 v13, s48, v13
  v_add_u32 v5, 4, v3
  v_xor_b32 v5, v5, v4
  v_lshlrev_b32 v5, 4, v5
  v_lshl_add_u32 v14, v2, 7, v5
  v_add_u32 v14, s48, v14
  v_add_u32 v5, 6, v3
  v_xor_b32 v5, v5, v4
  v_lshlrev_b32 v5, 4, v5
  v_lshl_add_u32 v15, v2, 7, v5
  v_add_u32 v15, s48, v15
  v_add_u32 v4, 0, v7
  v_bfe_u32 v5, v4, 1, 3
  v_add_u32 v6, 0, v25
  v_xor_b32 v6, v6, v5
  v_lshlrev_b32 v6, 4, v6
  v_lshl_add_u32 v20, v4, 7, v6
  v_add_u32 v20, s48, v20
  v_add_u32 v6, 4, v25
  v_xor_b32 v6, v6, v5
  v_lshlrev_b32 v6, 4, v6
  v_lshl_add_u32 v21, v4, 7, v6
  v_add_u32 v21, s48, v21
  v_add_u32 v4, 16, v7
  v_bfe_u32 v5, v4, 1, 3
  v_add_u32 v6, 0, v25
  v_xor_b32 v6, v6, v5
  v_lshlrev_b32 v6, 4, v6
  v_lshl_add_u32 v22, v4, 7, v6
  v_add_u32 v22, s48, v22
  v_add_u32 v6, 4, v25
  v_xor_b32 v6, v6, v5
  v_lshlrev_b32 v6, 4, v6
  v_lshl_add_u32 v23, v4, 7, v6
  v_add_u32 v23, s48, v23
  v_bfe_u32 v4, v0, 2, 2
  v_lshl_add_u32 v5, v3, 3, v4
  v_mul_u32_u24 v5, 192, v5
  v_bfe_u32 v6, v0, 4, 1
  v_lshl_add_u32 v5, v6, 5, v5
  v_and_b32 v6, 3, v0
  v_lshl_add_u32 v16, v6, 3, v5
  v_lshl_add_u32 v4, v25, 3, v4
  v_mul_u32_u24 v4, 192, v4
  v_lshl_add_u32 v24, v6, 3, v4
  s_lshr_b32 s27, s24, 1
  s_mul_i32 s27, s27, 6144
  s_and_b32 s28, s24, 1
  s_mul_i32 s28, s28, 96
  s_add_u32 s27, s27, s28
  v_add_u32 v24, s27, v24
  v_add_u32 v26, 49152, v16
  v_add_u32 v27, 49152, v24
  v_and_b32 v4, 19, v1
  v_cmp_eq_u32 vcc, 19, v4
  v_mov_b32 v5, 153600
  s_nop 0
  v_cndmask_b32 v32, v16, v5, vcc
  v_mov_b32 v5, 3072
  v_cndmask_b32 v33, v5, 0, vcc
  v_lshlrev_b32 v4, 4, v1
  v_add_u32 v4, 153600, v4
  v_mov_b32 v28, 0x3f803f80
  v_mov_b32 v29, 0x3f803f80
  v_mov_b32 v30, 0x3f803f80
  v_mov_b32 v31, 0x3f803f80
  ds_write_b128 v4, v[28:31]
  v_mov_b32 v34, 0
  v_mov_b32 v35, 0
  v_lshlrev_b32 v36, 3, v1
  v_add_u32 v36, 151552, v36
  ds_write_b64 v36, v[34:35]
  v_lshlrev_b32 v108, 2, v7
  v_add_u32 v108, 151552, v108
  s_and_b32 s28, s24, 1
  s_mul_i32 s28, s28, 192
  v_add_u32 v109, s28, v108
  s_lshl_b32 s27, s24, 7
  v_add_u32 v110, s27, v108
  v_add_u32 v110, 1536, v110
  v_lshlrev_b32 v114, 2, v2
  v_add_u32 v114, 151552, v114
  v_add_u32 v111, s27, v114
  v_lshlrev_b32 v112, 4, v3
  v_add_u32 v112, 151552, v112
  v_add_u32 v113, s27, v112
  v_lshrrev_b32 v4, 4, v2
  v_lshlrev_b32 v115, 10, v4
  v_lshl_add_u32 v115, v7, 4, v115
  v_lshl_add_u32 v115, v3, 9, v115
  v_lshlrev_b32 v116, 9, v4
  v_lshl_add_u32 v116, v7, 3, v116
  v_lshl_add_u32 v116, v3, 7, v116
  s_mul_i32 s49, s26, 393216
  s_lshl_b32 s27, s25, 13
  s_add_u32 s49, s49, s27
  s_lshl_b32 s27, s24, 11
  s_add_u32 s49, s49, s27
  v_and_b32 v4, 3, v1
  v_cmp_eq_u32 s[50:51], 1, v4
  v_cmp_eq_u32 s[52:53], 2, v4
  v_cmp_eq_u32 s[54:55], 3, v4
  s_waitcnt lgkmcnt(0)
  s_mov_b32 s20, s8
  s_and_b32 s21, s9, 0xffff
  s_mov_b32 s22, 0x10000000
  s_mov_b32 s23, 0x20000
  s_cmp_ge_u32 s26, 11
  s_cbranch_scc1 k1_qkv_kernel_varC_5
  s_cmp_eq_u32 s26, 10
  s_cbranch_scc1 k1_qkv_kernel_varB_4
  s_barrier
  ds_read_b128 v[120:123], v12 offset:0
  ds_read_b64_tr_b16 v[132:133], v32 offset:0
  ds_read_b64_tr_b16 v[134:135], v32 offset:768
  v_add_u32 v32, v33, v32
  ds_read_b64_tr_b16 v[136:137], v16 offset:56
  ds_read_b64_tr_b16 v[138:139], v16 offset:824
  ds_read_b64_tr_b16 v[140:141], v16 offset:112
  ds_read_b64_tr_b16 v[142:143], v16 offset:880
  ds_read_b128 v[124:127], v13 offset:0
  ds_read_b64_tr_b16 v[144:145], v32 offset:0
  ds_read_b64_tr_b16 v[146:147], v32 offset:768
  v_add_u32 v32, v33, v32
  ds_read_b64_tr_b16 v[148:149], v16 offset:3128
  ds_read_b64_tr_b16 v[150:151], v16 offset:3896
  ds_read_b64_tr_b16 v[152:153], v16 offset:3184
  ds_read_b64_tr_b16 v[154:155], v16 offset:3952
  s_waitcnt lgkmcnt(7)
  v_mfma_f32_32x32x16_bf16 v[40:55], v[132:135], v[120:123], 0
  ds_read_b128 v[128:131], v14 offset:0
  ds_read_b64_tr_b16 v[156:157], v32 offset:0
  ds_read_b64_tr_b16 v[158:159], v32 offset:768
  v_add_u32 v32, v33, v32
  v_mfma_f32_32x32x16_bf16 v[56:71], v[136:139], v[120:123], 0
  ds_read_b64_tr_b16 v[160:161], v16 offset:6200
  ds_read_b64_tr_b16 v[162:163], v16 offset:6968
  ds_read_b64_tr_b16 v[164:165], v16 offset:6256
  ds_read_b64_tr_b16 v[166:167], v16 offset:7024
  v_mfma_f32_32x32x16_bf16 v[72:87], v[140:143], v[120:123], 0
  ds_read_b128 v[168:171], v20 offset:0
  ds_read_b128 v[172:175], v21 offset:0
  ds_read_b128 v[176:179], v22 offset:0
  ds_read_b128 v[180:183], v23 offset:0
  s_waitcnt lgkmcnt(11)
  v_mfma_f32_32x32x16_bf16 v[40:55], v[144:147], v[124:127], v[40:55]
  ds_read_b128 v[120:123], v15 offset:0
  ds_read_b64_tr_b16 v[132:133], v32 offset:0
  ds_read_b64_tr_b16 v[134:135], v32 offset:768
  v_add_u32 v32, v33, v32
  ds_read_b64_tr_b16 v[136:137], v16 offset:9272
  v_mfma_f32_32x32x16_bf16 v[56:71], v[148:151], v[124:127], v[56:71]
  ds_read_b64_tr_b16 v[138:139], v16 offset:10040
  ds_read_b64_tr_b16 v[140:141], v16 offset:9328
  ds_read_b64_tr_b16 v[142:143], v16 offset:10096
  ds_read_b64_tr_b16 v[184:185], v24 offset:0
  ds_read_b64_tr_b16 v[186:187], v24 offset:768
  v_mfma_f32_32x32x16_bf16 v[72:87], v[152:155], v[124:127], v[72:87]
  ds_read_b64_tr_b16 v[188:189], v24 offset:32
  ds_read_b64_tr_b16 v[190:191], v24 offset:800
  ds_read_b64_tr_b16 v[192:193], v24 offset:64
  ds_read_b64_tr_b16 v[194:195], v24 offset:832
  s_barrier
  s_waitcnt lgkmcnt(15)
  v_mfma_f32_32x32x16_bf16 v[40:55], v[156:159], v[128:131], v[40:55]
  ds_read_b128 v[124:127], v12 offset:4096
  ds_read_b64_tr_b16 v[144:145], v32 offset:0
  ds_read_b64_tr_b16 v[146:147], v32 offset:768
  v_mfma_f32_32x32x16_bf16 v[56:71], v[160:163], v[128:131], v[56:71]
  v_add_u32 v32, v33, v32
  ds_read_b64_tr_b16 v[148:149], v16 offset:12344
  ds_read_b64_tr_b16 v[150:151], v16 offset:13112
  v_mfma_f32_32x32x16_bf16 v[72:87], v[164:167], v[128:131], v[72:87]
  ds_read_b64_tr_b16 v[152:153], v16 offset:12400
  ds_read_b64_tr_b16 v[154:155], v16 offset:13168
  s_waitcnt lgkmcnt(15)
  v_mfma_f32_16x16x32_bf16 v[100:103], v[168:171], v[168:171], 0
  v_mfma_f32_16x16x32_bf16 v[100:103], v[172:175], v[172:175], v[100:103]
  v_mfma_f32_16x16x32_bf16 v[104:107], v[176:179], v[176:179], 0
  v_mfma_f32_16x16x32_bf16 v[104:107], v[180:183], v[180:183], v[104:107]
  s_waitcnt lgkmcnt(13)
  v_mfma_f32_32x32x16_bf16 v[40:55], v[132:135], v[120:123], v[40:55]
  ds_read_b128 v[128:131], v13 offset:4096
  ds_read_b64_tr_b16 v[156:157], v32 offset:0
  ds_read_b64_tr_b16 v[158:159], v32 offset:768
  v_mfma_f32_32x32x16_bf16 v[56:71], v[136:139], v[120:123], v[56:71]
  v_add_u32 v32, v33, v32
  ds_read_b64_tr_b16 v[160:161], v16 offset:15416
  ds_read_b64_tr_b16 v[162:163], v16 offset:16184
  v_mfma_f32_32x32x16_bf16 v[72:87], v[140:143], v[120:123], v[72:87]
  ds_read_b64_tr_b16 v[164:165], v16 offset:15472
  ds_read_b64_tr_b16 v[166:167], v16 offset:16240
  s_waitcnt lgkmcnt(14)
  v_mfma_f32_16x16x32_bf16 v[88:91], v[28:31], v[184:187], 0
  v_mfma_f32_16x16x32_bf16 v[92:95], v[28:31], v[188:191], 0
  v_mfma_f32_16x16x32_bf16 v[96:99], v[28:31], v[192:195], 0
  s_waitcnt lgkmcnt(7)
  v_mfma_f32_32x32x16_bf16 v[40:55], v[144:147], v[124:127], v[40:55]
  ds_read_b128 v[120:123], v14 offset:4096
  ds_read_b64_tr_b16 v[132:133], v32 offset:0
  ds_read_b64_tr_b16 v[134:135], v32 offset:768
  v_add_u32 v32, v33, v32
  v_mfma_f32_32x32x16_bf16 v[56:71], v[148:151], v[124:127], v[56:71]
  ds_read_b64_tr_b16 v[136:137], v16 offset:18488
  ds_read_b64_tr_b16 v[138:139], v16 offset:19256
  ds_read_b64_tr_b16 v[140:141], v16 offset:18544
  ds_read_b64_tr_b16 v[142:143], v16 offset:19312
  v_mfma_f32_32x32x16_bf16 v[72:87], v[152:155], v[124:127], v[72:87]
  ds_read_b128 v[168:171], v20 offset:4096
  ds_read_b128 v[172:175], v21 offset:4096
  ds_read_b128 v[176:179], v22 offset:4096
  ds_read_b128 v[180:183], v23 offset:4096
  s_waitcnt lgkmcnt(11)
  v_mfma_f32_32x32x16_bf16 v[40:55], v[156:159], v[128:131], v[40:55]
  ds_read_b128 v[124:127], v15 offset:4096
  ds_read_b64_tr_b16 v[144:145], v32 offset:0
  ds_read_b64_tr_b16 v[146:147], v32 offset:768
  v_add_u32 v32, v33, v32
  ds_read_b64_tr_b16 v[148:149], v16 offset:21560
  v_mfma_f32_32x32x16_bf16 v[56:71], v[160:163], v[128:131], v[56:71]
  ds_read_b64_tr_b16 v[150:151], v16 offset:22328
  ds_read_b64_tr_b16 v[152:153], v16 offset:21616
  ds_read_b64_tr_b16 v[154:155], v16 offset:22384
  ds_read_b64_tr_b16 v[184:185], v24 offset:12288
  ds_read_b64_tr_b16 v[186:187], v24 offset:13056
  v_mfma_f32_32x32x16_bf16 v[72:87], v[164:167], v[128:131], v[72:87]
  ds_read_b64_tr_b16 v[188:189], v24 offset:12320
  ds_read_b64_tr_b16 v[190:191], v24 offset:13088
  ds_read_b64_tr_b16 v[192:193], v24 offset:12352
  ds_read_b64_tr_b16 v[194:195], v24 offset:13120
  s_barrier
  s_waitcnt lgkmcnt(15)
  v_mfma_f32_32x32x16_bf16 v[40:55], v[132:135], v[120:123], v[40:55]
  ds_read_b128 v[128:131], v12 offset:8192
  ds_read_b64_tr_b16 v[156:157], v32 offset:0
  ds_read_b64_tr_b16 v[158:159], v32 offset:768
  v_mfma_f32_32x32x16_bf16 v[56:71], v[136:139], v[120:123], v[56:71]
  v_add_u32 v32, v33, v32
  ds_read_b64_tr_b16 v[160:161], v16 offset:24632
  ds_read_b64_tr_b16 v[162:163], v16 offset:25400
  v_mfma_f32_32x32x16_bf16 v[72:87], v[140:143], v[120:123], v[72:87]
  ds_read_b64_tr_b16 v[164:165], v16 offset:24688
  ds_read_b64_tr_b16 v[166:167], v16 offset:25456
  s_waitcnt lgkmcnt(15)
  v_mfma_f32_16x16x32_bf16 v[100:103], v[168:171], v[168:171], v[100:103]
  v_mfma_f32_16x16x32_bf16 v[100:103], v[172:175], v[172:175], v[100:103]
  v_mfma_f32_16x16x32_bf16 v[104:107], v[176:179], v[176:179], v[104:107]
  v_mfma_f32_16x16x32_bf16 v[104:107], v[180:183], v[180:183], v[104:107]
  s_waitcnt lgkmcnt(13)
  v_mfma_f32_32x32x16_bf16 v[40:55], v[144:147], v[124:127], v[40:55]
  ds_read_b128 v[120:123], v13 offset:8192
  ds_read_b64_tr_b16 v[132:133], v32 offset:0
  ds_read_b64_tr_b16 v[134:135], v32 offset:768
  v_mfma_f32_32x32x16_bf16 v[56:71], v[148:151], v[124:127], v[56:71]
  v_add_u32 v32, v33, v32
  ds_read_b64_tr_b16 v[136:137], v16 offset:27704
  ds_read_b64_tr_b16 v[138:139], v16 offset:28472
  v_mfma_f32_32x32x16_bf16 v[72:87], v[152:155], v[124:127], v[72:87]
  ds_read_b64_tr_b16 v[140:141], v16 offset:27760
  ds_read_b64_tr_b16 v[142:143], v16 offset:28528
  s_waitcnt lgkmcnt(14)
  v_mfma_f32_16x16x32_bf16 v[88:91], v[28:31], v[184:187], v[88:91]
  v_mfma_f32_16x16x32_bf16 v[92:95], v[28:31], v[188:191], v[92:95]
  v_mfma_f32_16x16x32_bf16 v[96:99], v[28:31], v[192:195], v[96:99]
  s_waitcnt lgkmcnt(7)
  v_mfma_f32_32x32x16_bf16 v[40:55], v[156:159], v[128:131], v[40:55]
  ds_read_b128 v[124:127], v14 offset:8192
  ds_read_b64_tr_b16 v[144:145], v32 offset:0
  ds_read_b64_tr_b16 v[146:147], v32 offset:768
  v_add_u32 v32, v33, v32
  v_mfma_f32_32x32x16_bf16 v[56:71], v[160:163], v[128:131], v[56:71]
  ds_read_b64_tr_b16 v[148:149], v16 offset:30776
  ds_read_b64_tr_b16 v[150:151], v16 offset:31544
  ds_read_b64_tr_b16 v[152:153], v16 offset:30832
  ds_read_b64_tr_b16 v[154:155], v16 offset:31600
  v_mfma_f32_32x32x16_bf16 v[72:87], v[164:167], v[128:131], v[72:87]
  ds_read_b128 v[168:171], v20 offset:8192
  ds_read_b128 v[172:175], v21 offset:8192
  ds_read_b128 v[176:179], v22 offset:8192
  ds_read_b128 v[180:183], v23 offset:8192
  s_waitcnt lgkmcnt(11)
  v_mfma_f32_32x32x16_bf16 v[40:55], v[132:135], v[120:123], v[40:55]
  ds_read_b128 v[128:131], v15 offset:8192
  ds_read_b64_tr_b16 v[156:157], v32 offset:0
  ds_read_b64_tr_b16 v[158:159], v32 offset:768
  v_add_u32 v32, v33, v32
  ds_read_b64_tr_b16 v[160:161], v16 offset:33848
  v_mfma_f32_32x32x16_bf16 v[56:71], v[136:139], v[120:123], v[56:71]
  ds_read_b64_tr_b16 v[162:163], v16 offset:34616
  ds_read_b64_tr_b16 v[164:165], v16 offset:33904
  ds_read_b64_tr_b16 v[166:167], v16 offset:34672
  ds_read_b64_tr_b16 v[184:185], v24 offset:24576
  ds_read_b64_tr_b16 v[186:187], v24 offset:25344
  v_mfma_f32_32x32x16_bf16 v[72:87], v[140:143], v[120:123], v[72:87]
  ds_read_b64_tr_b16 v[188:189], v24 offset:24608
  ds_read_b64_tr_b16 v[190:191], v24 offset:25376
  ds_read_b64_tr_b16 v[192:193], v24 offset:24640
  ds_read_b64_tr_b16 v[194:195], v24 offset:25408
  s_barrier
  s_waitcnt lgkmcnt(15)
  v_mfma_f32_32x32x16_bf16 v[40:55], v[144:147], v[124:127], v[40:55]
  ds_read_b128 v[120:123], v12 offset:12288
  ds_read_b64_tr_b16 v[132:133], v32 offset:0
  ds_read_b64_tr_b16 v[134:135], v32 offset:768
  v_mfma_f32_32x32x16_bf16 v[56:71], v[148:151], v[124:127], v[56:71]
  v_add_u32 v32, v33, v32
  ds_read_b64_tr_b16 v[136:137], v16 offset:36920
  ds_read_b64_tr_b16 v[138:139], v16 offset:37688
  v_mfma_f32_32x32x16_bf16 v[72:87], v[152:155], v[124:127], v[72:87]
  ds_read_b64_tr_b16 v[140:141], v16 offset:36976
  ds_read_b64_tr_b16 v[142:143], v16 offset:37744
  s_waitcnt lgkmcnt(15)
  v_mfma_f32_16x16x32_bf16 v[100:103], v[168:171], v[168:171], v[100:103]
  v_mfma_f32_16x16x32_bf16 v[100:103], v[172:175], v[172:175], v[100:103]
  v_mfma_f32_16x16x32_bf16 v[104:107], v[176:179], v[176:179], v[104:107]
  v_mfma_f32_16x16x32_bf16 v[104:107], v[180:183], v[180:183], v[104:107]
  s_waitcnt lgkmcnt(13)
  v_mfma_f32_32x32x16_bf16 v[40:55], v[156:159], v[128:131], v[40:55]
  ds_read_b128 v[124:127], v13 offset:12288
  ds_read_b64_tr_b16 v[144:145], v32 offset:0
  ds_read_b64_tr_b16 v[146:147], v32 offset:768
  v_mfma_f32_32x32x16_bf16 v[56:71], v[160:163], v[128:131], v[56:71]
  v_add_u32 v32, v33, v32
  ds_read_b64_tr_b16 v[148:149], v16 offset:39992
  ds_read_b64_tr_b16 v[150:151], v16 offset:40760
  v_mfma_f32_32x32x16_bf16 v[72:87], v[164:167], v[128:131], v[72:87]
  ds_read_b64_tr_b16 v[152:153], v16 offset:40048
  ds_read_b64_tr_b16 v[154:155], v16 offset:40816
  s_waitcnt lgkmcnt(14)
  v_mfma_f32_16x16x32_bf16 v[88:91], v[28:31], v[184:187], v[88:91]
  v_mfma_f32_16x16x32_bf16 v[92:95], v[28:31], v[188:191], v[92:95]
  v_mfma_f32_16x16x32_bf16 v[96:99], v[28:31], v[192:195], v[96:99]
  s_waitcnt lgkmcnt(7)
  v_mfma_f32_32x32x16_bf16 v[40:55], v[132:135], v[120:123], v[40:55]
  ds_read_b128 v[128:131], v14 offset:12288
  ds_read_b64_tr_b16 v[156:157], v32 offset:0
  ds_read_b64_tr_b16 v[158:159], v32 offset:768
  v_add_u32 v32, v33, v32
  v_mfma_f32_32x32x16_bf16 v[56:71], v[136:139], v[120:123], v[56:71]
  ds_read_b64_tr_b16 v[160:161], v16 offset:43064
  ds_read_b64_tr_b16 v[162:163], v16 offset:43832
  ds_read_b64_tr_b16 v[164:165], v16 offset:43120
  ds_read_b64_tr_b16 v[166:167], v16 offset:43888
  v_mfma_f32_32x32x16_bf16 v[72:87], v[140:143], v[120:123], v[72:87]
  ds_read_b128 v[168:171], v20 offset:12288
  ds_read_b128 v[172:175], v21 offset:12288
  ds_read_b128 v[176:179], v22 offset:12288
  ds_read_b128 v[180:183], v23 offset:12288
  s_waitcnt lgkmcnt(11)
  v_mfma_f32_32x32x16_bf16 v[40:55], v[144:147], v[124:127], v[40:55]
  ds_read_b128 v[120:123], v15 offset:12288
  ds_read_b64_tr_b16 v[132:133], v32 offset:0
  ds_read_b64_tr_b16 v[134:135], v32 offset:768
  v_add_u32 v32, v33, v32
  ds_read_b64_tr_b16 v[136:137], v16 offset:46136
  v_mfma_f32_32x32x16_bf16 v[56:71], v[148:151], v[124:127], v[56:71]
  ds_read_b64_tr_b16 v[138:139], v16 offset:46904
  ds_read_b64_tr_b16 v[140:141], v16 offset:46192
  ds_read_b64_tr_b16 v[142:143], v16 offset:46960
  ds_read_b64_tr_b16 v[184:185], v24 offset:36864
  ds_read_b64_tr_b16 v[186:187], v24 offset:37632
  v_mfma_f32_32x32x16_bf16 v[72:87], v[152:155], v[124:127], v[72:87]
  ds_read_b64_tr_b16 v[188:189], v24 offset:36896
  ds_read_b64_tr_b16 v[190:191], v24 offset:37664
  ds_read_b64_tr_b16 v[192:193], v24 offset:36928
  ds_read_b64_tr_b16 v[194:195], v24 offset:37696
  s_barrier
  s_waitcnt lgkmcnt(15)
  v_mfma_f32_32x32x16_bf16 v[40:55], v[156:159], v[128:131], v[40:55]
  ds_read_b128 v[124:127], v12 offset:0
  ds_read_b64_tr_b16 v[144:145], v32 offset:0
  ds_read_b64_tr_b16 v[146:147], v32 offset:768
  v_mfma_f32_32x32x16_bf16 v[56:71], v[160:163], v[128:131], v[56:71]
  v_add_u32 v32, v33, v32
  ds_read_b64_tr_b16 v[148:149], v26 offset:56
  ds_read_b64_tr_b16 v[150:151], v26 offset:824
  v_mfma_f32_32x32x16_bf16 v[72:87], v[164:167], v[128:131], v[72:87]
  ds_read_b64_tr_b16 v[152:153], v26 offset:112
  ds_read_b64_tr_b16 v[154:155], v26 offset:880
  s_waitcnt lgkmcnt(15)
  v_mfma_f32_16x16x32_bf16 v[100:103], v[168:171], v[168:171], v[100:103]
  v_mfma_f32_16x16x32_bf16 v[100:103], v[172:175], v[172:175], v[100:103]
  v_mfma_f32_16x16x32_bf16 v[104:107], v[176:179], v[176:179], v[104:107]
  v_mfma_f32_16x16x32_bf16 v[104:107], v[180:183], v[180:183], v[104:107]
  s_waitcnt lgkmcnt(13)
  v_mfma_f32_32x32x16_bf16 v[40:55], v[132:135], v[120:123], v[40:55]
  ds_read_b128 v[128:131], v13 offset:0
  ds_read_b64_tr_b16 v[156:157], v32 offset:0
  ds_read_b64_tr_b16 v[158:159], v32 offset:768
  v_mfma_f32_32x32x16_bf16 v[56:71], v[136:139], v[120:123], v[56:71]
  v_add_u32 v32, v33, v32
  ds_read_b64_tr_b16 v[160:161], v26 offset:3128
  ds_read_b64_tr_b16 v[162:163], v26 offset:3896
  v_mfma_f32_32x32x16_bf16 v[72:87], v[140:143], v[120:123], v[72:87]
  ds_read_b64_tr_b16 v[164:165], v26 offset:3184
  ds_read_b64_tr_b16 v[166:167], v26 offset:3952
  s_waitcnt lgkmcnt(14)
  v_mfma_f32_16x16x32_bf16 v[88:91], v[28:31], v[184:187], v[88:91]
  v_mfma_f32_16x16x32_bf16 v[92:95], v[28:31], v[188:191], v[92:95]
  v_mfma_f32_16x16x32_bf16 v[96:99], v[28:31], v[192:195], v[96:99]
  s_waitcnt lgkmcnt(7)
  v_mfma_f32_32x32x16_bf16 v[40:55], v[144:147], v[124:127], v[40:55]
  ds_read_b128 v[120:123], v14 offset:0
  ds_read_b64_tr_b16 v[132:133], v32 offset:0
  ds_read_b64_tr_b16 v[134:135], v32 offset:768
  v_add_u32 v32, v33, v32
  v_mfma_f32_32x32x16_bf16 v[56:71], v[148:151], v[124:127], v[56:71]
  ds_read_b64_tr_b16 v[136:137], v26 offset:6200
  ds_read_b64_tr_b16 v[138:139], v26 offset:6968
  ds_read_b64_tr_b16 v[140:141], v26 offset:6256
  ds_read_b64_tr_b16 v[142:143], v26 offset:7024
  v_mfma_f32_32x32x16_bf16 v[72:87], v[152:155], v[124:127], v[72:87]
  ds_read_b128 v[168:171], v20 offset:0
  ds_read_b128 v[172:175], v21 offset:0
  ds_read_b128 v[176:179], v22 offset:0
  ds_read_b128 v[180:183], v23 offset:0
  s_waitcnt lgkmcnt(11)
  v_mfma_f32_32x32x16_bf16 v[40:55], v[156:159], v[128:131], v[40:55]
  ds_read_b128 v[124:127], v15 offset:0
  ds_read_b64_tr_b16 v[144:145], v32 offset:0
  ds_read_b64_tr_b16 v[146:147], v32 offset:768
  v_add_u32 v32, v33, v32
  ds_read_b64_tr_b16 v[148:149], v26 offset:9272
  v_mfma_f32_32x32x16_bf16 v[56:71], v[160:163], v[128:131], v[56:71]
  ds_read_b64_tr_b16 v[150:151], v26 offset:10040
  ds_read_b64_tr_b16 v[152:153], v26 offset:9328
  ds_read_b64_tr_b16 v[154:155], v26 offset:10096
  ds_read_b64_tr_b16 v[184:185], v27 offset:0
  ds_read_b64_tr_b16 v[186:187], v27 offset:768
  v_mfma_f32_32x32x16_bf16 v[72:87], v[164:167], v[128:131], v[72:87]
  ds_read_b64_tr_b16 v[188:189], v27 offset:32
  ds_read_b64_tr_b16 v[190:191], v27 offset:800
  ds_read_b64_tr_b16 v[192:193], v27 offset:64
  ds_read_b64_tr_b16 v[194:195], v27 offset:832
  s_barrier
  s_waitcnt lgkmcnt(15)
  v_mfma_f32_32x32x16_bf16 v[40:55], v[132:135], v[120:123], v[40:55]
  ds_read_b128 v[128:131], v12 offset:4096
  ds_read_b64_tr_b16 v[156:157], v32 offset:0
  ds_read_b64_tr_b16 v[158:159], v32 offset:768
  v_mfma_f32_32x32x16_bf16 v[56:71], v[136:139], v[120:123], v[56:71]
  v_add_u32 v32, v33, v32
  ds_read_b64_tr_b16 v[160:161], v26 offset:12344
  ds_read_b64_tr_b16 v[162:163], v26 offset:13112
  v_mfma_f32_32x32x16_bf16 v[72:87], v[140:143], v[120:123], v[72:87]
  ds_read_b64_tr_b16 v[164:165], v26 offset:12400
  ds_read_b64_tr_b16 v[166:167], v26 offset:13168
  s_waitcnt lgkmcnt(15)
  v_mfma_f32_16x16x32_bf16 v[100:103], v[168:171], v[168:171], v[100:103]
  v_mfma_f32_16x16x32_bf16 v[100:103], v[172:175], v[172:175], v[100:103]
  v_mfma_f32_16x16x32_bf16 v[104:107], v[176:179], v[176:179], v[104:107]
  v_mfma_f32_16x16x32_bf16 v[104:107], v[180:183], v[180:183], v[104:107]
  s_waitcnt lgkmcnt(13)
  v_mfma_f32_32x32x16_bf16 v[40:55], v[144:147], v[124:127], v[40:55]
  ds_read_b128 v[120:123], v13 offset:4096
  ds_read_b64_tr_b16 v[132:133], v32 offset:0
  ds_read_b64_tr_b16 v[134:135], v32 offset:768
  v_mfma_f32_32x32x16_bf16 v[56:71], v[148:151], v[124:127], v[56:71]
  v_add_u32 v32, v33, v32
  ds_read_b64_tr_b16 v[136:137], v26 offset:15416
  ds_read_b64_tr_b16 v[138:139], v26 offset:16184
  v_mfma_f32_32x32x16_bf16 v[72:87], v[152:155], v[124:127], v[72:87]
  ds_read_b64_tr_b16 v[140:141], v26 offset:15472
  ds_read_b64_tr_b16 v[142:143], v26 offset:16240
  s_waitcnt lgkmcnt(14)
  v_mfma_f32_16x16x32_bf16 v[88:91], v[28:31], v[184:187], v[88:91]
  v_mfma_f32_16x16x32_bf16 v[92:95], v[28:31], v[188:191], v[92:95]
  v_mfma_f32_16x16x32_bf16 v[96:99], v[28:31], v[192:195], v[96:99]
  s_waitcnt lgkmcnt(7)
  v_mfma_f32_32x32x16_bf16 v[40:55], v[156:159], v[128:131], v[40:55]
  ds_read_b128 v[124:127], v14 offset:4096
  ds_read_b64_tr_b16 v[144:145], v32 offset:0
  ds_read_b64_tr_b16 v[146:147], v32 offset:768
  v_add_u32 v32, v33, v32
  v_mfma_f32_32x32x16_bf16 v[56:71], v[160:163], v[128:131], v[56:71]
  ds_read_b64_tr_b16 v[148:149], v26 offset:18488
  ds_read_b64_tr_b16 v[150:151], v26 offset:19256
  ds_read_b64_tr_b16 v[152:153], v26 offset:18544
  ds_read_b64_tr_b16 v[154:155], v26 offset:19312
  v_mfma_f32_32x32x16_bf16 v[72:87], v[164:167], v[128:131], v[72:87]
  ds_read_b128 v[168:171], v20 offset:4096
  ds_read_b128 v[172:175], v21 offset:4096
  ds_read_b128 v[176:179], v22 offset:4096
  ds_read_b128 v[180:183], v23 offset:4096
  s_waitcnt lgkmcnt(11)
  v_mfma_f32_32x32x16_bf16 v[40:55], v[132:135], v[120:123], v[40:55]
  ds_read_b128 v[128:131], v15 offset:4096
  ds_read_b64_tr_b16 v[156:157], v32 offset:0
  ds_read_b64_tr_b16 v[158:159], v32 offset:768
  v_add_u32 v32, v33, v32
  ds_read_b64_tr_b16 v[160:161], v26 offset:21560
  v_mfma_f32_32x32x16_bf16 v[56:71], v[136:139], v[120:123], v[56:71]
  ds_read_b64_tr_b16 v[162:163], v26 offset:22328
  ds_read_b64_tr_b16 v[164:165], v26 offset:21616
  ds_read_b64_tr_b16 v[166:167], v26 offset:22384
  ds_read_b64_tr_b16 v[184:185], v27 offset:12288
  ds_read_b64_tr_b16 v[186:187], v27 offset:13056
  v_mfma_f32_32x32x16_bf16 v[72:87], v[140:143], v[120:123], v[72:87]
  ds_read_b64_tr_b16 v[188:189], v27 offset:12320
  ds_read_b64_tr_b16 v[190:191], v27 offset:13088
  ds_read_b64_tr_b16 v[192:193], v27 offset:12352
  ds_read_b64_tr_b16 v[194:195], v27 offset:13120
  s_barrier
  s_waitcnt lgkmcnt(15)
  v_mfma_f32_32x32x16_bf16 v[40:55], v[144:147], v[124:127], v[40:55]
  ds_read_b128 v[120:123], v12 offset:8192
  ds_read_b64_tr_b16 v[132:133], v32 offset:0
  ds_read_b64_tr_b16 v[134:135], v32 offset:768
  v_mfma_f32_32x32x16_bf16 v[56:71], v[148:151], v[124:127], v[56:71]
  v_add_u32 v32, v33, v32
  ds_read_b64_tr_b16 v[136:137], v26 offset:24632
  ds_read_b64_tr_b16 v[138:139], v26 offset:25400
  v_mfma_f32_32x32x16_bf16 v[72:87], v[152:155], v[124:127], v[72:87]
  ds_read_b64_tr_b16 v[140:141], v26 offset:24688
  ds_read_b64_tr_b16 v[142:143], v26 offset:25456
  s_waitcnt lgkmcnt(15)
  v_mfma_f32_16x16x32_bf16 v[100:103], v[168:171], v[168:171], v[100:103]
  v_mfma_f32_16x16x32_bf16 v[100:103], v[172:175], v[172:175], v[100:103]
  v_mfma_f32_16x16x32_bf16 v[104:107], v[176:179], v[176:179], v[104:107]
  v_mfma_f32_16x16x32_bf16 v[104:107], v[180:183], v[180:183], v[104:107]
  s_waitcnt lgkmcnt(13)
  v_mfma_f32_32x32x16_bf16 v[40:55], v[156:159], v[128:131], v[40:55]
  ds_read_b128 v[124:127], v13 offset:8192
  ds_read_b64_tr_b16 v[144:145], v32 offset:0
  ds_read_b64_tr_b16 v[146:147], v32 offset:768
  v_mfma_f32_32x32x16_bf16 v[56:71], v[160:163], v[128:131], v[56:71]
  v_add_u32 v32, v33, v32
  ds_read_b64_tr_b16 v[148:149], v26 offset:27704
  ds_read_b64_tr_b16 v[150:151], v26 offset:28472
  v_mfma_f32_32x32x16_bf16 v[72:87], v[164:167], v[128:131], v[72:87]
  ds_read_b64_tr_b16 v[152:153], v26 offset:27760
  ds_read_b64_tr_b16 v[154:155], v26 offset:28528
  s_waitcnt lgkmcnt(14)
  v_mfma_f32_16x16x32_bf16 v[88:91], v[28:31], v[184:187], v[88:91]
  v_mfma_f32_16x16x32_bf16 v[92:95], v[28:31], v[188:191], v[92:95]
  v_mfma_f32_16x16x32_bf16 v[96:99], v[28:31], v[192:195], v[96:99]
  s_waitcnt lgkmcnt(7)
  v_mfma_f32_32x32x16_bf16 v[40:55], v[132:135], v[120:123], v[40:55]
  ds_read_b128 v[128:131], v14 offset:8192
  ds_read_b64_tr_b16 v[156:157], v32 offset:0
  ds_read_b64_tr_b16 v[158:159], v32 offset:768
  v_add_u32 v32, v33, v32
  v_mfma_f32_32x32x16_bf16 v[56:71], v[136:139], v[120:123], v[56:71]
  ds_read_b64_tr_b16 v[160:161], v26 offset:30776
  ds_read_b64_tr_b16 v[162:163], v26 offset:31544
  ds_read_b64_tr_b16 v[164:165], v26 offset:30832
  ds_read_b64_tr_b16 v[166:167], v26 offset:31600
  v_mfma_f32_32x32x16_bf16 v[72:87], v[140:143], v[120:123], v[72:87]
  ds_read_b128 v[168:171], v20 offset:8192
  ds_read_b128 v[172:175], v21 offset:8192
  ds_read_b128 v[176:179], v22 offset:8192
  ds_read_b128 v[180:183], v23 offset:8192
  s_waitcnt lgkmcnt(11)
  v_mfma_f32_32x32x16_bf16 v[40:55], v[144:147], v[124:127], v[40:55]
  ds_read_b128 v[120:123], v15 offset:8192
  ds_read_b64_tr_b16 v[132:133], v32 offset:0
  ds_read_b64_tr_b16 v[134:135], v32 offset:768
  v_add_u32 v32, v33, v32
  ds_read_b64_tr_b16 v[136:137], v26 offset:33848
  v_mfma_f32_32x32x16_bf16 v[56:71], v[148:151], v[124:127], v[56:71]
  ds_read_b64_tr_b16 v[138:139], v26 offset:34616
  ds_read_b64_tr_b16 v[140:141], v26 offset:33904
  ds_read_b64_tr_b16 v[142:143], v26 offset:34672
  ds_read_b64_tr_b16 v[184:185], v27 offset:24576
  ds_read_b64_tr_b16 v[186:187], v27 offset:25344
  v_mfma_f32_32x32x16_bf16 v[72:87], v[152:155], v[124:127], v[72:87]
  ds_read_b64_tr_b16 v[188:189], v27 offset:24608
  ds_read_b64_tr_b16 v[190:191], v27 offset:25376
  ds_read_b64_tr_b16 v[192:193], v27 offset:24640
  ds_read_b64_tr_b16 v[194:195], v27 offset:25408
  s_waitcnt lgkmcnt(13)
  v_mfma_f32_16x16x32_bf16 v[100:103], v[168:171], v[168:171], v[100:103]
  v_mfma_f32_16x16x32_bf16 v[100:103], v[172:175], v[172:175], v[100:103]
  v_mfma_f32_16x16x32_bf16 v[104:107], v[176:179], v[176:179], v[104:107]
  v_mfma_f32_16x16x32_bf16 v[104:107], v[180:183], v[180:183], v[104:107]
  v_mfma_f32_32x32x16_bf16 v[40:55], v[156:159], v[128:131], v[40:55]
  v_mfma_f32_32x32x16_bf16 v[56:71], v[160:163], v[128:131], v[56:71]
  v_mfma_f32_32x32x16_bf16 v[72:87], v[164:167], v[128:131], v[72:87]
  s_waitcnt lgkmcnt(0)
  v_mfma_f32_16x16x32_bf16 v[88:91], v[28:31], v[184:187], v[88:91]
  v_mfma_f32_16x16x32_bf16 v[92:95], v[28:31], v[188:191], v[92:95]
  v_mfma_f32_16x16x32_bf16 v[96:99], v[28:31], v[192:195], v[96:99]
  v_mfma_f32_32x32x16_bf16 v[40:55], v[132:135], v[120:123], v[40:55]
  s_mov_b32 exec_lo, 0xffff
  s_mov_b32 exec_hi, 0
  s_nop 2
  ds_add_f32 v109, v88 offset:0
  ds_add_f32 v109, v92 offset:64
  ds_add_f32 v109, v96 offset:128
  s_mov_b64 exec, -1
  v_mfma_f32_32x32x16_bf16 v[56:71], v[136:139], v[120:123], v[56:71]
  v_cndmask_b32 v100, v100, v101, s[50:51]
  v_cndmask_b32 v100, v100, v102, s[52:53]
  v_cndmask_b32 v100, v100, v103, s[54:55]
  v_cndmask_b32 v104, v104, v105, s[50:51]
  v_cndmask_b32 v104, v104, v106, s[52:53]
  v_cndmask_b32 v104, v104, v107, s[54:55]
  s_mov_b32 exec_lo, 0x00f0000f
  s_mov_b32 exec_hi, 0xf0000f00
  ds_write_b32 v110, v100 offset:0
  ds_write_b32 v110, v104 offset:64
  s_mov_b64 exec, -1
  v_mfma_f32_32x32x16_bf16 v[72:87], v[140:143], v[120:123], v[72:87]
  ds_read_b32 v118, v111 offset:1536
  s_waitcnt lgkmcnt(1)
  s_barrier
  ds_read_b128 v[124:127], v112 offset:0
  ds_read_b128 v[128:131], v112 offset:32
  ds_read_b128 v[132:135], v112 offset:64
  ds_read_b128 v[136:139], v112 offset:96
  ds_read_b128 v[140:143], v112 offset:112
  ds_read_b128 v[144:147], v112 offset:144
  ds_read_b128 v[148:151], v112 offset:176
  ds_read_b128 v[152:155], v112 offset:208
  ds_read_b128 v[156:159], v112 offset:224
  ds_read_b128 v[160:163], v112 offset:256
  ds_read_b128 v[164:167], v112 offset:288
  ds_read_b128 v[168:171], v112 offset:320
  v_mov_b32 v122, v52
  v_mov_b32 v123, v52
  s_nop 1
  v_permlane32_swap_b32 v122, v123
  v_mul_f32 v122, 0xbb124925, v123
  s_waitcnt lgkmcnt(12)
  v_mul_f32 v118, 0x3b124925, v118
  v_fma_f32 v118, -v122, v122, v118
  v_max_f32 v118, 0, v118
  v_cvt_pk_bf16_f32 v122, v122, v122
  v_lshlrev_b32 v122, 16, v122
  v_cvt_pk_bf16_f32 v118, v118, v118
  v_lshlrev_b32 v118, 16, v118
  v_add_f32 v118, 0x3727c5ac, v118
  v_cvt_pk_bf16_f32 v118, v118, v118
  v_lshlrev_b32 v118, 16, v118
  v_sqrt_f32 v118, v118
  s_nop 0
  v_cvt_pk_bf16_f32 v118, v118, v118
  v_lshlrev_b32 v118, 16, v118
  v_rcp_f32 v120, v118
  v_cmp_eq_u32 s[56:57], 0, v3
  v_cmp_gt_u32 s[58:59], 28, v2
  v_mov_b32 v204, 0x3f803f80
  v_cmp_eq_u32 vcc, 28, v2
  s_nop 1
  v_cndmask_b32 v204, 0, v204, vcc
  s_waitcnt lgkmcnt(8)
  v_pk_fma_f32 v[40:41], v[124:125], v[122:123], v[40:41] op_sel_hi:[1,0,1]
  v_pk_fma_f32 v[42:43], v[126:127], v[122:123], v[42:43] op_sel_hi:[1,0,1]
  v_pk_fma_f32 v[44:45], v[128:129], v[122:123], v[44:45] op_sel_hi:[1,0,1]
  v_pk_fma_f32 v[46:47], v[130:131], v[122:123], v[46:47] op_sel_hi:[1,0,1]
  v_pk_fma_f32 v[48:49], v[132:133], v[122:123], v[48:49] op_sel_hi:[1,0,1]
  v_pk_fma_f32 v[50:51], v[134:135], v[122:123], v[50:51] op_sel_hi:[1,0,1]
  v_pk_fma_f32 v[52:53], v[136:137], v[122:123], v[52:53] op_sel_hi:[1,0,1]
  v_pk_fma_f32 v[54:55], v[138:139], v[122:123], v[54:55] op_sel_hi:[1,0,1]
  v_pk_mul_f32 v[40:41], v[40:41], v[120:121] op_sel_hi:[1,0]
  v_pk_mul_f32 v[42:43], v[42:43], v[120:121] op_sel_hi:[1,0]
  v_pk_mul_f32 v[44:45], v[44:45], v[120:121] op_sel_hi:[1,0]
  v_pk_mul_f32 v[46:47], v[46:47], v[120:121] op_sel_hi:[1,0]
  v_pk_mul_f32 v[48:49], v[48:49], v[120:121] op_sel_hi:[1,0]
  v_pk_mul_f32 v[50:51], v[50:51], v[120:121] op_sel_hi:[1,0]
  v_pk_mul_f32 v[52:53], v[52:53], v[120:121] op_sel_hi:[1,0]
  v_pk_mul_f32 v[54:55], v[54:55], v[120:121] op_sel_hi:[1,0]
  v_cvt_pk_bf16_f32 v208, v40, v41
  v_cvt_pk_bf16_f32 v209, v42, v43
  v_cvt_pk_bf16_f32 v210, v44, v45
  v_cvt_pk_bf16_f32 v211, v46, v47
  v_cvt_pk_bf16_f32 v212, v48, v49
  v_cvt_pk_bf16_f32 v213, v50, v51
  v_cvt_pk_bf16_f32 v214, v52, v53
  v_cvt_pk_bf16_f32 v215, v54, v55
  v_cndmask_b32 v214, 0, v214, s[56:57]
  v_cndmask_b32 v215, 0, v215, s[56:57]
  s_add_u32 s29, s49, 0x0
  buffer_store_dwordx4 v[208:211], v115, s[20:23], s29 offen sc1
  buffer_store_dwordx4 v[212:215], v115, s[20:23], s29 offen offset:256 sc1
  s_waitcnt lgkmcnt(4)
  v_pk_fma_f32 v[56:57], v[140:141], v[122:123], v[56:57] op_sel_hi:[1,0,1]
  v_pk_fma_f32 v[58:59], v[142:143], v[122:123], v[58:59] op_sel_hi:[1,0,1]
  v_pk_fma_f32 v[60:61], v[144:145], v[122:123], v[60:61] op_sel_hi:[1,0,1]
  v_pk_fma_f32 v[62:63], v[146:147], v[122:123], v[62:63] op_sel_hi:[1,0,1]
  v_pk_fma_f32 v[64:65], v[148:149], v[122:123], v[64:65] op_sel_hi:[1,0,1]
  v_pk_fma_f32 v[66:67], v[150:151], v[122:123], v[66:67] op_sel_hi:[1,0,1]
  v_pk_fma_f32 v[68:69], v[152:153], v[122:123], v[68:69] op_sel_hi:[1,0,1]
  v_pk_fma_f32 v[70:71], v[154:155], v[122:123], v[70:71] op_sel_hi:[1,0,1]
  v_pk_mul_f32 v[56:57], v[56:57], v[120:121] op_sel_hi:[1,0]
  v_pk_mul_f32 v[58:59], v[58:59], v[120:121] op_sel_hi:[1,0]
  v_pk_mul_f32 v[60:61], v[60:61], v[120:121] op_sel_hi:[1,0]
  v_pk_mul_f32 v[62:63], v[62:63], v[120:121] op_sel_hi:[1,0]
  v_pk_mul_f32 v[64:65], v[64:65], v[120:121] op_sel_hi:[1,0]
  v_pk_mul_f32 v[66:67], v[66:67], v[120:121] op_sel_hi:[1,0]
  v_pk_mul_f32 v[68:69], v[68:69], v[120:121] op_sel_hi:[1,0]
  v_pk_mul_f32 v[70:71], v[70:71], v[120:121] op_sel_hi:[1,0]
  v_cvt_pk_bf16_f32 v216, v56, v57
  v_cvt_pk_bf16_f32 v217, v58, v59
  v_cvt_pk_bf16_f32 v218, v60, v61
  v_cvt_pk_bf16_f32 v219, v62, v63
  v_cvt_pk_bf16_f32 v220, v64, v65
  v_cvt_pk_bf16_f32 v221, v66, v67
  v_cvt_pk_bf16_f32 v222, v68, v69
  v_cvt_pk_bf16_f32 v223, v70, v71
  v_cndmask_b32 v222, 0, v222, s[56:57]
  v_cndmask_b32 v223, 0, v223, s[56:57]
  s_add_u32 s29, s49, 0x20000
  buffer_store_dwordx4 v[216:219], v115, s[20:23], s29 offen sc1
  buffer_store_dwordx4 v[220:223], v115, s[20:23], s29 offen offset:256 sc1
  s_waitcnt lgkmcnt(0)
  v_pk_fma_f32 v[72:73], v[156:157], v[122:123], v[72:73] op_sel_hi:[1,0,1]
  v_pk_fma_f32 v[74:75], v[158:159], v[122:123], v[74:75] op_sel_hi:[1,0,1]
  v_pk_fma_f32 v[76:77], v[160:161], v[122:123], v[76:77] op_sel_hi:[1,0,1]
  v_pk_fma_f32 v[78:79], v[162:163], v[122:123], v[78:79] op_sel_hi:[1,0,1]
  v_pk_fma_f32 v[80:81], v[164:165], v[122:123], v[80:81] op_sel_hi:[1,0,1]
  v_pk_fma_f32 v[82:83], v[166:167], v[122:123], v[82:83] op_sel_hi:[1,0,1]
  v_pk_fma_f32 v[84:85], v[168:169], v[122:123], v[84:85] op_sel_hi:[1,0,1]
  v_pk_fma_f32 v[86:87], v[170:171], v[122:123], v[86:87] op_sel_hi:[1,0,1]
  v_pk_mul_f32 v[72:73], v[72:73], v[120:121] op_sel_hi:[1,0]
  v_pk_mul_f32 v[74:75], v[74:75], v[120:121] op_sel_hi:[1,0]
  v_pk_mul_f32 v[76:77], v[76:77], v[120:121] op_sel_hi:[1,0]
  v_pk_mul_f32 v[78:79], v[78:79], v[120:121] op_sel_hi:[1,0]
  v_pk_mul_f32 v[80:81], v[80:81], v[120:121] op_sel_hi:[1,0]
  v_pk_mul_f32 v[82:83], v[82:83], v[120:121] op_sel_hi:[1,0]
  v_pk_mul_f32 v[84:85], v[84:85], v[120:121] op_sel_hi:[1,0]
  v_pk_mul_f32 v[86:87], v[86:87], v[120:121] op_sel_hi:[1,0]
  v_cvt_pk_bf16_f32 v208, v72, v73
  v_cvt_pk_bf16_f32 v209, v74, v75
  v_cvt_pk_bf16_f32 v210, v76, v77
  v_cvt_pk_bf16_f32 v211, v78, v79
  v_cvt_pk_bf16_f32 v212, v80, v81
  v_cvt_pk_bf16_f32 v213, v82, v83
  v_cvt_pk_bf16_f32 v214, v84, v85
  v_cvt_pk_bf16_f32 v215, v86, v87
  v_cndmask_b32 v214, 0, v214, s[56:57]
  v_cndmask_b32 v215, 0, v215, s[56:57]
  s_add_u32 s29, s49, 0x40000
  buffer_store_dwordx4 v[208:211], v115, s[20:23], s29 offen sc1
  buffer_store_dwordx4 v[212:215], v115, s[20:23], s29 offen offset:256 sc1
  s_endpgm
k1_qkv_kernel_varB_4:
  s_barrier
  ds_read_b128 v[120:123], v12 offset:0
  ds_read_b64_tr_b16 v[132:133], v32 offset:0
  ds_read_b64_tr_b16 v[134:135], v32 offset:768
  v_add_u32 v32, v33, v32
  ds_read_b64_tr_b16 v[136:137], v16 offset:56
  ds_read_b64_tr_b16 v[138:139], v16 offset:824
  ds_read_b64_tr_b16 v[140:141], v16 offset:112
  ds_read_b64_tr_b16 v[142:143], v16 offset:880
  ds_read_b128 v[124:127], v13 offset:0
  ds_read_b64_tr_b16 v[144:145], v32 offset:0
  ds_read_b64_tr_b16 v[146:147], v32 offset:768
  v_add_u32 v32, v33, v32
  ds_read_b64_tr_b16 v[148:149], v16 offset:3128
  ds_read_b64_tr_b16 v[150:151], v16 offset:3896
  ds_read_b64_tr_b16 v[152:153], v16 offset:3184
  ds_read_b64_tr_b16 v[154:155], v16 offset:3952
  s_waitcnt lgkmcnt(7)
  v_mfma_f32_32x32x16_bf16 v[40:55], v[132:135], v[120:123], 0
  ds_read_b128 v[128:131], v14 offset:0
  ds_read_b64_tr_b16 v[156:157], v32 offset:0
  ds_read_b64_tr_b16 v[158:159], v32 offset:768
  v_add_u32 v32, v33, v32
  v_mfma_f32_32x32x16_bf16 v[56:71], v[136:139], v[120:123], 0
  ds_read_b64_tr_b16 v[160:161], v16 offset:6200
  ds_read_b64_tr_b16 v[162:163], v16 offset:6968
  ds_read_b64_tr_b16 v[164:165], v16 offset:6256
  ds_read_b64_tr_b16 v[166:167], v16 offset:7024
  v_mfma_f32_32x32x16_bf16 v[72:87], v[120:123], v[140:143], 0
  ds_read_b128 v[168:171], v20 offset:0
  ds_read_b128 v[172:175], v21 offset:0
  ds_read_b128 v[176:179], v22 offset:0
  ds_read_b128 v[180:183], v23 offset:0
  s_waitcnt lgkmcnt(11)
  v_mfma_f32_32x32x16_bf16 v[40:55], v[144:147], v[124:127], v[40:55]
  ds_read_b128 v[120:123], v15 offset:0
  ds_read_b64_tr_b16 v[132:133], v32 offset:0
  ds_read_b64_tr_b16 v[134:135], v32 offset:768
  v_add_u32 v32, v33, v32
  ds_read_b64_tr_b16 v[136:137], v16 offset:9272
  v_mfma_f32_32x32x16_bf16 v[56:71], v[148:151], v[124:127], v[56:71]
  ds_read_b64_tr_b16 v[138:139], v16 offset:10040
  ds_read_b64_tr_b16 v[140:141], v16 offset:9328
  ds_read_b64_tr_b16 v[142:143], v16 offset:10096
  ds_read_b64_tr_b16 v[184:185], v24 offset:0
  ds_read_b64_tr_b16 v[186:187], v24 offset:768
  v_mfma_f32_32x32x16_bf16 v[72:87], v[124:127], v[152:155], v[72:87]
  ds_read_b64_tr_b16 v[188:189], v24 offset:32
  ds_read_b64_tr_b16 v[190:191], v24 offset:800
  ds_read_b64_tr_b16 v[192:193], v24 offset:64
  ds_read_b64_tr_b16 v[194:195], v24 offset:832
  s_barrier
  s_waitcnt lgkmcnt(15)
  v_mfma_f32_32x32x16_bf16 v[40:55], v[156:159], v[128:131], v[40:55]
  ds_read_b128 v[124:127], v12 offset:4096
  ds_read_b64_tr_b16 v[144:145], v32 offset:0
  ds_read_b64_tr_b16 v[146:147], v32 offset:768
  v_mfma_f32_32x32x16_bf16 v[56:71], v[160:163], v[128:131], v[56:71]
  v_add_u32 v32, v33, v32
  ds_read_b64_tr_b16 v[148:149], v16 offset:12344
  ds_read_b64_tr_b16 v[150:151], v16 offset:13112
  v_mfma_f32_32x32x16_bf16 v[72:87], v[128:131], v[164:167], v[72:87]
  ds_read_b64_tr_b16 v[152:153], v16 offset:12400
  ds_read_b64_tr_b16 v[154:155], v16 offset:13168
  s_waitcnt lgkmcnt(15)
  v_mfma_f32_16x16x32_bf16 v[100:103], v[168:171], v[168:171], 0
  v_mfma_f32_16x16x32_bf16 v[100:103], v[172:175], v[172:175], v[100:103]
  v_mfma_f32_16x16x32_bf16 v[104:107], v[176:179], v[176:179], 0
  v_mfma_f32_16x16x32_bf16 v[104:107], v[180:183], v[180:183], v[104:107]
  s_waitcnt lgkmcnt(13)
  v_mfma_f32_32x32x16_bf16 v[40:55], v[132:135], v[120:123], v[40:55]
  ds_read_b128 v[128:131], v13 offset:4096
  ds_read_b64_tr_b16 v[156:157], v32 offset:0
  ds_read_b64_tr_b16 v[158:159], v32 offset:768
  v_mfma_f32_32x32x16_bf16 v[56:71], v[136:139], v[120:123], v[56:71]
  v_add_u32 v32, v33, v32
  ds_read_b64_tr_b16 v[160:161], v16 offset:15416
  ds_read_b64_tr_b16 v[162:163], v16 offset:16184
  v_mfma_f32_32x32x16_bf16 v[72:87], v[120:123], v[140:143], v[72:87]
  ds_read_b64_tr_b16 v[164:165], v16 offset:15472
  ds_read_b64_tr_b16 v[166:167], v16 offset:16240
  s_waitcnt lgkmcnt(14)
  v_mfma_f32_16x16x32_bf16 v[88:91], v[28:31], v[184:187], 0
  v_mfma_f32_16x16x32_bf16 v[92:95], v[28:31], v[188:191], 0
  v_mfma_f32_16x16x32_bf16 v[96:99], v[28:31], v[192:195], 0
  s_waitcnt lgkmcnt(7)
  v_mfma_f32_32x32x16_bf16 v[40:55], v[144:147], v[124:127], v[40:55]
  ds_read_b128 v[120:123], v14 offset:4096
  ds_read_b64_tr_b16 v[132:133], v32 offset:0
  ds_read_b64_tr_b16 v[134:135], v32 offset:768
  v_add_u32 v32, v33, v32
  v_mfma_f32_32x32x16_bf16 v[56:71], v[148:151], v[124:127], v[56:71]
  ds_read_b64_tr_b16 v[136:137], v16 offset:18488
  ds_read_b64_tr_b16 v[138:139], v16 offset:19256
  ds_read_b64_tr_b16 v[140:141], v16 offset:18544
  ds_read_b64_tr_b16 v[142:143], v16 offset:19312
  v_mfma_f32_32x32x16_bf16 v[72:87], v[124:127], v[152:155], v[72:87]
  ds_read_b128 v[168:171], v20 offset:4096
  ds_read_b128 v[172:175], v21 offset:4096
  ds_read_b128 v[176:179], v22 offset:4096
  ds_read_b128 v[180:183], v23 offset:4096
  s_waitcnt lgkmcnt(11)
  v_mfma_f32_32x32x16_bf16 v[40:55], v[156:159], v[128:131], v[40:55]
  ds_read_b128 v[124:127], v15 offset:4096
  ds_read_b64_tr_b16 v[144:145], v32 offset:0
  ds_read_b64_tr_b16 v[146:147], v32 offset:768
  v_add_u32 v32, v33, v32
  ds_read_b64_tr_b16 v[148:149], v16 offset:21560
  v_mfma_f32_32x32x16_bf16 v[56:71], v[160:163], v[128:131], v[56:71]
  ds_read_b64_tr_b16 v[150:151], v16 offset:22328
  ds_read_b64_tr_b16 v[152:153], v16 offset:21616
  ds_read_b64_tr_b16 v[154:155], v16 offset:22384
  ds_read_b64_tr_b16 v[184:185], v24 offset:12288
  ds_read_b64_tr_b16 v[186:187], v24 offset:13056
  v_mfma_f32_32x32x16_bf16 v[72:87], v[128:131], v[164:167], v[72:87]
  ds_read_b64_tr_b16 v[188:189], v24 offset:12320
  ds_read_b64_tr_b16 v[190:191], v24 offset:13088
  ds_read_b64_tr_b16 v[192:193], v24 offset:12352
  ds_read_b64_tr_b16 v[194:195], v24 offset:13120
  s_barrier
  s_waitcnt lgkmcnt(15)
  v_mfma_f32_32x32x16_bf16 v[40:55], v[132:135], v[120:123], v[40:55]
  ds_read_b128 v[128:131], v12 offset:8192
  ds_read_b64_tr_b16 v[156:157], v32 offset:0
  ds_read_b64_tr_b16 v[158:159], v32 offset:768
  v_mfma_f32_32x32x16_bf16 v[56:71], v[136:139], v[120:123], v[56:71]
  v_add_u32 v32, v33, v32
  ds_read_b64_tr_b16 v[160:161], v16 offset:24632
  ds_read_b64_tr_b16 v[162:163], v16 offset:25400
  v_mfma_f32_32x32x16_bf16 v[72:87], v[120:123], v[140:143], v[72:87]
  ds_read_b64_tr_b16 v[164:165], v16 offset:24688
  ds_read_b64_tr_b16 v[166:167], v16 offset:25456
  s_waitcnt lgkmcnt(15)
  v_mfma_f32_16x16x32_bf16 v[100:103], v[168:171], v[168:171], v[100:103]
  v_mfma_f32_16x16x32_bf16 v[100:103], v[172:175], v[172:175], v[100:103]
  v_mfma_f32_16x16x32_bf16 v[104:107], v[176:179], v[176:179], v[104:107]
  v_mfma_f32_16x16x32_bf16 v[104:107], v[180:183], v[180:183], v[104:107]
  s_waitcnt lgkmcnt(13)
  v_mfma_f32_32x32x16_bf16 v[40:55], v[144:147], v[124:127], v[40:55]
  ds_read_b128 v[120:123], v13 offset:8192
  ds_read_b64_tr_b16 v[132:133], v32 offset:0
  ds_read_b64_tr_b16 v[134:135], v32 offset:768
  v_mfma_f32_32x32x16_bf16 v[56:71], v[148:151], v[124:127], v[56:71]
  v_add_u32 v32, v33, v32
  ds_read_b64_tr_b16 v[136:137], v16 offset:27704
  ds_read_b64_tr_b16 v[138:139], v16 offset:28472
  v_mfma_f32_32x32x16_bf16 v[72:87], v[124:127], v[152:155], v[72:87]
  ds_read_b64_tr_b16 v[140:141], v16 offset:27760
  ds_read_b64_tr_b16 v[142:143], v16 offset:28528
  s_waitcnt lgkmcnt(14)
  v_mfma_f32_16x16x32_bf16 v[88:91], v[28:31], v[184:187], v[88:91]
  v_mfma_f32_16x16x32_bf16 v[92:95], v[28:31], v[188:191], v[92:95]
  v_mfma_f32_16x16x32_bf16 v[96:99], v[28:31], v[192:195], v[96:99]
  s_waitcnt lgkmcnt(7)
  v_mfma_f32_32x32x16_bf16 v[40:55], v[156:159], v[128:131], v[40:55]
  ds_read_b128 v[124:127], v14 offset:8192
  ds_read_b64_tr_b16 v[144:145], v32 offset:0
  ds_read_b64_tr_b16 v[146:147], v32 offset:768
  v_add_u32 v32, v33, v32
  v_mfma_f32_32x32x16_bf16 v[56:71], v[160:163], v[128:131], v[56:71]
  ds_read_b64_tr_b16 v[148:149], v16 offset:30776
  ds_read_b64_tr_b16 v[150:151], v16 offset:31544
  ds_read_b64_tr_b16 v[152:153], v16 offset:30832
  ds_read_b64_tr_b16 v[154:155], v16 offset:31600
  v_mfma_f32_32x32x16_bf16 v[72:87], v[128:131], v[164:167], v[72:87]
  ds_read_b128 v[168:171], v20 offset:8192
  ds_read_b128 v[172:175], v21 offset:8192
  ds_read_b128 v[176:179], v22 offset:8192
  ds_read_b128 v[180:183], v23 offset:8192
  s_waitcnt lgkmcnt(11)
  v_mfma_f32_32x32x16_bf16 v[40:55], v[132:135], v[120:123], v[40:55]
  ds_read_b128 v[128:131], v15 offset:8192
  ds_read_b64_tr_b16 v[156:157], v32 offset:0
  ds_read_b64_tr_b16 v[158:159], v32 offset:768
  v_add_u32 v32, v33, v32
  ds_read_b64_tr_b16 v[160:161], v16 offset:33848
  v_mfma_f32_32x32x16_bf16 v[56:71], v[136:139], v[120:123], v[56:71]
  ds_read_b64_tr_b16 v[162:163], v16 offset:34616
  ds_read_b64_tr_b16 v[164:165], v16 offset:33904
  ds_read_b64_tr_b16 v[166:167], v16 offset:34672
  ds_read_b64_tr_b16 v[184:185], v24 offset:24576
  ds_read_b64_tr_b16 v[186:187], v24 offset:25344
  v_mfma_f32_32x32x16_bf16 v[72:87], v[120:123], v[140:143], v[72:87]
  ds_read_b64_tr_b16 v[188:189], v24 offset:24608
  ds_read_b64_tr_b16 v[190:191], v24 offset:25376
  ds_read_b64_tr_b16 v[192:193], v24 offset:24640
  ds_read_b64_tr_b16 v[194:195], v24 offset:25408
  s_barrier
  s_waitcnt lgkmcnt(15)
  v_mfma_f32_32x32x16_bf16 v[40:55], v[144:147], v[124:127], v[40:55]
  ds_read_b128 v[120:123], v12 offset:12288
  ds_read_b64_tr_b16 v[132:133], v32 offset:0
  ds_read_b64_tr_b16 v[134:135], v32 offset:768
  v_mfma_f32_32x32x16_bf16 v[56:71], v[148:151], v[124:127], v[56:71]
  v_add_u32 v32, v33, v32
  ds_read_b64_tr_b16 v[136:137], v16 offset:36920
  ds_read_b64_tr_b16 v[138:139], v16 offset:37688
  v_mfma_f32_32x32x16_bf16 v[72:87], v[124:127], v[152:155], v[72:87]
  ds_read_b64_tr_b16 v[140:141], v16 offset:36976
  ds_read_b64_tr_b16 v[142:143], v16 offset:37744
  s_waitcnt lgkmcnt(15)
  v_mfma_f32_16x16x32_bf16 v[100:103], v[168:171], v[168:171], v[100:103]
  v_mfma_f32_16x16x32_bf16 v[100:103], v[172:175], v[172:175], v[100:103]
  v_mfma_f32_16x16x32_bf16 v[104:107], v[176:179], v[176:179], v[104:107]
  v_mfma_f32_16x16x32_bf16 v[104:107], v[180:183], v[180:183], v[104:107]
  s_waitcnt lgkmcnt(13)
  v_mfma_f32_32x32x16_bf16 v[40:55], v[156:159], v[128:131], v[40:55]
  ds_read_b128 v[124:127], v13 offset:12288
  ds_read_b64_tr_b16 v[144:145], v32 offset:0
  ds_read_b64_tr_b16 v[146:147], v32 offset:768
  v_mfma_f32_32x32x16_bf16 v[56:71], v[160:163], v[128:131], v[56:71]
  v_add_u32 v32, v33, v32
  ds_read_b64_tr_b16 v[148:149], v16 offset:39992
  ds_read_b64_tr_b16 v[150:151], v16 offset:40760
  v_mfma_f32_32x32x16_bf16 v[72:87], v[128:131], v[164:167], v[72:87]
  ds_read_b64_tr_b16 v[152:153], v16 offset:40048
  ds_read_b64_tr_b16 v[154:155], v16 offset:40816
  s_waitcnt lgkmcnt(14)
  v_mfma_f32_16x16x32_bf16 v[88:91], v[28:31], v[184:187], v[88:91]
  v_mfma_f32_16x16x32_bf16 v[92:95], v[28:31], v[188:191], v[92:95]
  v_mfma_f32_16x16x32_bf16 v[96:99], v[28:31], v[192:195], v[96:99]
  s_waitcnt lgkmcnt(7)
  v_mfma_f32_32x32x16_bf16 v[40:55], v[132:135], v[120:123], v[40:55]
  ds_read_b128 v[128:131], v14 offset:12288
  ds_read_b64_tr_b16 v[156:157], v32 offset:0
  ds_read_b64_tr_b16 v[158:159], v32 offset:768
  v_add_u32 v32, v33, v32
  v_mfma_f32_32x32x16_bf16 v[56:71], v[136:139], v[120:123], v[56:71]
  ds_read_b64_tr_b16 v[160:161], v16 offset:43064
  ds_read_b64_tr_b16 v[162:163], v16 offset:43832
  ds_read_b64_tr_b16 v[164:165], v16 offset:43120
  ds_read_b64_tr_b16 v[166:167], v16 offset:43888
  v_mfma_f32_32x32x16_bf16 v[72:87], v[120:123], v[140:143], v[72:87]
  ds_read_b128 v[168:171], v20 offset:12288
  ds_read_b128 v[172:175], v21 offset:12288
  ds_read_b128 v[176:179], v22 offset:12288
  ds_read_b128 v[180:183], v23 offset:12288
  s_waitcnt lgkmcnt(11)
  v_mfma_f32_32x32x16_bf16 v[40:55], v[144:147], v[124:127], v[40:55]
  ds_read_b128 v[120:123], v15 offset:12288
  ds_read_b64_tr_b16 v[132:133], v32 offset:0
  ds_read_b64_tr_b16 v[134:135], v32 offset:768
  v_add_u32 v32, v33, v32
  ds_read_b64_tr_b16 v[136:137], v16 offset:46136
  v_mfma_f32_32x32x16_bf16 v[56:71], v[148:151], v[124:127], v[56:71]
  ds_read_b64_tr_b16 v[138:139], v16 offset:46904
  ds_read_b64_tr_b16 v[140:141], v16 offset:46192
  ds_read_b64_tr_b16 v[142:143], v16 offset:46960
  ds_read_b64_tr_b16 v[184:185], v24 offset:36864
  ds_read_b64_tr_b16 v[186:187], v24 offset:37632
  v_mfma_f32_32x32x16_bf16 v[72:87], v[124:127], v[152:155], v[72:87]
  ds_read_b64_tr_b16 v[188:189], v24 offset:36896
  ds_read_b64_tr_b16 v[190:191], v24 offset:37664
  ds_read_b64_tr_b16 v[192:193], v24 offset:36928
  ds_read_b64_tr_b16 v[194:195], v24 offset:37696
  s_barrier
  s_waitcnt lgkmcnt(15)
  v_mfma_f32_32x32x16_bf16 v[40:55], v[156:159], v[128:131], v[40:55]
  ds_read_b128 v[124:127], v12 offset:0
  ds_read_b64_tr_b16 v[144:145], v32 offset:0
  ds_read_b64_tr_b16 v[146:147], v32 offset:768
  v_mfma_f32_32x32x16_bf16 v[56:71], v[160:163], v[128:131], v[56:71]
  v_add_u32 v32, v33, v32
  ds_read_b64_tr_b16 v[148:149], v26 offset:56
  ds_read_b64_tr_b16 v[150:151], v26 offset:824
  v_mfma_f32_32x32x16_bf16 v[72:87], v[128:131], v[164:167], v[72:87]
  ds_read_b64_tr_b16 v[152:153], v26 offset:112
  ds_read_b64_tr_b16 v[154:155], v26 offset:880
  s_waitcnt lgkmcnt(15)
  v_mfma_f32_16x16x32_bf16 v[100:103], v[168:171], v[168:171], v[100:103]
  v_mfma_f32_16x16x32_bf16 v[100:103], v[172:175], v[172:175], v[100:103]
  v_mfma_f32_16x16x32_bf16 v[104:107], v[176:179], v[176:179], v[104:107]
  v_mfma_f32_16x16x32_bf16 v[104:107], v[180:183], v[180:183], v[104:107]
  s_waitcnt lgkmcnt(13)
  v_mfma_f32_32x32x16_bf16 v[40:55], v[132:135], v[120:123], v[40:55]
  ds_read_b128 v[128:131], v13 offset:0
  ds_read_b64_tr_b16 v[156:157], v32 offset:0
  ds_read_b64_tr_b16 v[158:159], v32 offset:768
  v_mfma_f32_32x32x16_bf16 v[56:71], v[136:139], v[120:123], v[56:71]
  v_add_u32 v32, v33, v32
  ds_read_b64_tr_b16 v[160:161], v26 offset:3128
  ds_read_b64_tr_b16 v[162:163], v26 offset:3896
  v_mfma_f32_32x32x16_bf16 v[72:87], v[120:123], v[140:143], v[72:87]
  ds_read_b64_tr_b16 v[164:165], v26 offset:3184
  ds_read_b64_tr_b16 v[166:167], v26 offset:3952
  s_waitcnt lgkmcnt(14)
  v_mfma_f32_16x16x32_bf16 v[88:91], v[28:31], v[184:187], v[88:91]
  v_mfma_f32_16x16x32_bf16 v[92:95], v[28:31], v[188:191], v[92:95]
  v_mfma_f32_16x16x32_bf16 v[96:99], v[28:31], v[192:195], v[96:99]
  s_waitcnt lgkmcnt(7)
  v_mfma_f32_32x32x16_bf16 v[40:55], v[144:147], v[124:127], v[40:55]
  ds_read_b128 v[120:123], v14 offset:0
  ds_read_b64_tr_b16 v[132:133], v32 offset:0
  ds_read_b64_tr_b16 v[134:135], v32 offset:768
  v_add_u32 v32, v33, v32
  v_mfma_f32_32x32x16_bf16 v[56:71], v[148:151], v[124:127], v[56:71]
  ds_read_b64_tr_b16 v[136:137], v26 offset:6200
  ds_read_b64_tr_b16 v[138:139], v26 offset:6968
  ds_read_b64_tr_b16 v[140:141], v26 offset:6256
  ds_read_b64_tr_b16 v[142:143], v26 offset:7024
  v_mfma_f32_32x32x16_bf16 v[72:87], v[124:127], v[152:155], v[72:87]
  ds_read_b128 v[168:171], v20 offset:0
  ds_read_b128 v[172:175], v21 offset:0
  ds_read_b128 v[176:179], v22 offset:0
  ds_read_b128 v[180:183], v23 offset:0
  s_waitcnt lgkmcnt(11)
  v_mfma_f32_32x32x16_bf16 v[40:55], v[156:159], v[128:131], v[40:55]
  ds_read_b128 v[124:127], v15 offset:0
  ds_read_b64_tr_b16 v[144:145], v32 offset:0
  ds_read_b64_tr_b16 v[146:147], v32 offset:768
  v_add_u32 v32, v33, v32
  ds_read_b64_tr_b16 v[148:149], v26 offset:9272
  v_mfma_f32_32x32x16_bf16 v[56:71], v[160:163], v[128:131], v[56:71]
  ds_read_b64_tr_b16 v[150:151], v26 offset:10040
  ds_read_b64_tr_b16 v[152:153], v26 offset:9328
  ds_read_b64_tr_b16 v[154:155], v26 offset:10096
  ds_read_b64_tr_b16 v[184:185], v27 offset:0
  ds_read_b64_tr_b16 v[186:187], v27 offset:768
  v_mfma_f32_32x32x16_bf16 v[72:87], v[128:131], v[164:167], v[72:87]
  ds_read_b64_tr_b16 v[188:189], v27 offset:32
  ds_read_b64_tr_b16 v[190:191], v27 offset:800
  ds_read_b64_tr_b16 v[192:193], v27 offset:64
  ds_read_b64_tr_b16 v[194:195], v27 offset:832
  s_barrier
  s_waitcnt lgkmcnt(15)
  v_mfma_f32_32x32x16_bf16 v[40:55], v[132:135], v[120:123], v[40:55]
  ds_read_b128 v[128:131], v12 offset:4096
  ds_read_b64_tr_b16 v[156:157], v32 offset:0
  ds_read_b64_tr_b16 v[158:159], v32 offset:768
  v_mfma_f32_32x32x16_bf16 v[56:71], v[136:139], v[120:123], v[56:71]
  v_add_u32 v32, v33, v32
  ds_read_b64_tr_b16 v[160:161], v26 offset:12344
  ds_read_b64_tr_b16 v[162:163], v26 offset:13112
  v_mfma_f32_32x32x16_bf16 v[72:87], v[120:123], v[140:143], v[72:87]
  ds_read_b64_tr_b16 v[164:165], v26 offset:12400
  ds_read_b64_tr_b16 v[166:167], v26 offset:13168
  s_waitcnt lgkmcnt(15)
  v_mfma_f32_16x16x32_bf16 v[100:103], v[168:171], v[168:171], v[100:103]
  v_mfma_f32_16x16x32_bf16 v[100:103], v[172:175], v[172:175], v[100:103]
  v_mfma_f32_16x16x32_bf16 v[104:107], v[176:179], v[176:179], v[104:107]
  v_mfma_f32_16x16x32_bf16 v[104:107], v[180:183], v[180:183], v[104:107]
  s_waitcnt lgkmcnt(13)
  v_mfma_f32_32x32x16_bf16 v[40:55], v[144:147], v[124:127], v[40:55]
  ds_read_b128 v[120:123], v13 offset:4096
  ds_read_b64_tr_b16 v[132:133], v32 offset:0
  ds_read_b64_tr_b16 v[134:135], v32 offset:768
  v_mfma_f32_32x32x16_bf16 v[56:71], v[148:151], v[124:127], v[56:71]
  v_add_u32 v32, v33, v32
  ds_read_b64_tr_b16 v[136:137], v26 offset:15416
  ds_read_b64_tr_b16 v[138:139], v26 offset:16184
  v_mfma_f32_32x32x16_bf16 v[72:87], v[124:127], v[152:155], v[72:87]
  ds_read_b64_tr_b16 v[140:141], v26 offset:15472
  ds_read_b64_tr_b16 v[142:143], v26 offset:16240
  s_waitcnt lgkmcnt(14)
  v_mfma_f32_16x16x32_bf16 v[88:91], v[28:31], v[184:187], v[88:91]
  v_mfma_f32_16x16x32_bf16 v[92:95], v[28:31], v[188:191], v[92:95]
  v_mfma_f32_16x16x32_bf16 v[96:99], v[28:31], v[192:195], v[96:99]
  s_waitcnt lgkmcnt(7)
  v_mfma_f32_32x32x16_bf16 v[40:55], v[156:159], v[128:131], v[40:55]
  ds_read_b128 v[124:127], v14 offset:4096
  ds_read_b64_tr_b16 v[144:145], v32 offset:0
  ds_read_b64_tr_b16 v[146:147], v32 offset:768
  v_add_u32 v32, v33, v32
  v_mfma_f32_32x32x16_bf16 v[56:71], v[160:163], v[128:131], v[56:71]
  ds_read_b64_tr_b16 v[148:149], v26 offset:18488
  ds_read_b64_tr_b16 v[150:151], v26 offset:19256
  ds_read_b64_tr_b16 v[152:153], v26 offset:18544
  ds_read_b64_tr_b16 v[154:155], v26 offset:19312
  v_mfma_f32_32x32x16_bf16 v[72:87], v[128:131], v[164:167], v[72:87]
  ds_read_b128 v[168:171], v20 offset:4096
  ds_read_b128 v[172:175], v21 offset:4096
  ds_read_b128 v[176:179], v22 offset:4096
  ds_read_b128 v[180:183], v23 offset:4096
  s_waitcnt lgkmcnt(11)
  v_mfma_f32_32x32x16_bf16 v[40:55], v[132:135], v[120:123], v[40:55]
  ds_read_b128 v[128:131], v15 offset:4096
  ds_read_b64_tr_b16 v[156:157], v32 offset:0
  ds_read_b64_tr_b16 v[158:159], v32 offset:768
  v_add_u32 v32, v33, v32
  ds_read_b64_tr_b16 v[160:161], v26 offset:21560
  v_mfma_f32_32x32x16_bf16 v[56:71], v[136:139], v[120:123], v[56:71]
  ds_read_b64_tr_b16 v[162:163], v26 offset:22328
  ds_read_b64_tr_b16 v[164:165], v26 offset:21616
  ds_read_b64_tr_b16 v[166:167], v26 offset:22384
  ds_read_b64_tr_b16 v[184:185], v27 offset:12288
  ds_read_b64_tr_b16 v[186:187], v27 offset:13056
  v_mfma_f32_32x32x16_bf16 v[72:87], v[120:123], v[140:143], v[72:87]
  ds_read_b64_tr_b16 v[188:189], v27 offset:12320
  ds_read_b64_tr_b16 v[190:191], v27 offset:13088
  ds_read_b64_tr_b16 v[192:193], v27 offset:12352
  ds_read_b64_tr_b16 v[194:195], v27 offset:13120
  s_barrier
  s_waitcnt lgkmcnt(15)
  v_mfma_f32_32x32x16_bf16 v[40:55], v[144:147], v[124:127], v[40:55]
  ds_read_b128 v[120:123], v12 offset:8192
  ds_read_b64_tr_b16 v[132:133], v32 offset:0
  ds_read_b64_tr_b16 v[134:135], v32 offset:768
  v_mfma_f32_32x32x16_bf16 v[56:71], v[148:151], v[124:127], v[56:71]
  v_add_u32 v32, v33, v32
  ds_read_b64_tr_b16 v[136:137], v26 offset:24632
  ds_read_b64_tr_b16 v[138:139], v26 offset:25400
  v_mfma_f32_32x32x16_bf16 v[72:87], v[124:127], v[152:155], v[72:87]
  ds_read_b64_tr_b16 v[140:141], v26 offset:24688
  ds_read_b64_tr_b16 v[142:143], v26 offset:25456
  s_waitcnt lgkmcnt(15)
  v_mfma_f32_16x16x32_bf16 v[100:103], v[168:171], v[168:171], v[100:103]
  v_mfma_f32_16x16x32_bf16 v[100:103], v[172:175], v[172:175], v[100:103]
  v_mfma_f32_16x16x32_bf16 v[104:107], v[176:179], v[176:179], v[104:107]
  v_mfma_f32_16x16x32_bf16 v[104:107], v[180:183], v[180:183], v[104:107]
  s_waitcnt lgkmcnt(13)
  v_mfma_f32_32x32x16_bf16 v[40:55], v[156:159], v[128:131], v[40:55]
  ds_read_b128 v[124:127], v13 offset:8192
  ds_read_b64_tr_b16 v[144:145], v32 offset:0
  ds_read_b64_tr_b16 v[146:147], v32 offset:768
  v_mfma_f32_32x32x16_bf16 v[56:71], v[160:163], v[128:131], v[56:71]
  v_add_u32 v32, v33, v32
  ds_read_b64_tr_b16 v[148:149], v26 offset:27704
  ds_read_b64_tr_b16 v[150:151], v26 offset:28472
  v_mfma_f32_32x32x16_bf16 v[72:87], v[128:131], v[164:167], v[72:87]
  ds_read_b64_tr_b16 v[152:153], v26 offset:27760
  ds_read_b64_tr_b16 v[154:155], v26 offset:28528
  s_waitcnt lgkmcnt(14)
  v_mfma_f32_16x16x32_bf16 v[88:91], v[28:31], v[184:187], v[88:91]
  v_mfma_f32_16x16x32_bf16 v[92:95], v[28:31], v[188:191], v[92:95]
  v_mfma_f32_16x16x32_bf16 v[96:99], v[28:31], v[192:195], v[96:99]
  s_waitcnt lgkmcnt(7)
  v_mfma_f32_32x32x16_bf16 v[40:55], v[132:135], v[120:123], v[40:55]
  ds_read_b128 v[128:131], v14 offset:8192
  ds_read_b64_tr_b16 v[156:157], v32 offset:0
  ds_read_b64_tr_b16 v[158:159], v32 offset:768
  v_add_u32 v32, v33, v32
  v_mfma_f32_32x32x16_bf16 v[56:71], v[136:139], v[120:123], v[56:71]
  ds_read_b64_tr_b16 v[160:161], v26 offset:30776
  ds_read_b64_tr_b16 v[162:163], v26 offset:31544
  ds_read_b64_tr_b16 v[164:165], v26 offset:30832
  ds_read_b64_tr_b16 v[166:167], v26 offset:31600
  v_mfma_f32_32x32x16_bf16 v[72:87], v[120:123], v[140:143], v[72:87]
  ds_read_b128 v[168:171], v20 offset:8192
  ds_read_b128 v[172:175], v21 offset:8192
  ds_read_b128 v[176:179], v22 offset:8192
  ds_read_b128 v[180:183], v23 offset:8192
  s_waitcnt lgkmcnt(11)
  v_mfma_f32_32x32x16_bf16 v[40:55], v[144:147], v[124:127], v[40:55]
  ds_read_b128 v[120:123], v15 offset:8192
  ds_read_b64_tr_b16 v[132:133], v32 offset:0
  ds_read_b64_tr_b16 v[134:135], v32 offset:768
  v_add_u32 v32, v33, v32
  ds_read_b64_tr_b16 v[136:137], v26 offset:33848
  v_mfma_f32_32x32x16_bf16 v[56:71], v[148:151], v[124:127], v[56:71]
  ds_read_b64_tr_b16 v[138:139], v26 offset:34616
  ds_read_b64_tr_b16 v[140:141], v26 offset:33904
  ds_read_b64_tr_b16 v[142:143], v26 offset:34672
  ds_read_b64_tr_b16 v[184:185], v27 offset:24576
  ds_read_b64_tr_b16 v[186:187], v27 offset:25344
  v_mfma_f32_32x32x16_bf16 v[72:87], v[124:127], v[152:155], v[72:87]
  ds_read_b64_tr_b16 v[188:189], v27 offset:24608
  ds_read_b64_tr_b16 v[190:191], v27 offset:25376
  ds_read_b64_tr_b16 v[192:193], v27 offset:24640
  ds_read_b64_tr_b16 v[194:195], v27 offset:25408
  s_waitcnt lgkmcnt(13)
  v_mfma_f32_16x16x32_bf16 v[100:103], v[168:171], v[168:171], v[100:103]
  v_mfma_f32_16x16x32_bf16 v[100:103], v[172:175], v[172:175], v[100:103]
  v_mfma_f32_16x16x32_bf16 v[104:107], v[176:179], v[176:179], v[104:107]
  v_mfma_f32_16x16x32_bf16 v[104:107], v[180:183], v[180:183], v[104:107]
  v_mfma_f32_32x32x16_bf16 v[40:55], v[156:159], v[128:131], v[40:55]
  v_mfma_f32_32x32x16_bf16 v[56:71], v[160:163], v[128:131], v[56:71]
  v_mfma_f32_32x32x16_bf16 v[72:87], v[128:131], v[164:167], v[72:87]
  s_waitcnt lgkmcnt(0)
  v_mfma_f32_16x16x32_bf16 v[88:91], v[28:31], v[184:187], v[88:91]
  v_mfma_f32_16x16x32_bf16 v[92:95], v[28:31], v[188:191], v[92:95]
  v_mfma_f32_16x16x32_bf16 v[96:99], v[28:31], v[192:195], v[96:99]
  v_mfma_f32_32x32x16_bf16 v[40:55], v[132:135], v[120:123], v[40:55]
  s_mov_b32 exec_lo, 0xffff
  s_mov_b32 exec_hi, 0
  s_nop 2
  ds_add_f32 v109, v88 offset:0
  ds_add_f32 v109, v92 offset:64
  ds_add_f32 v109, v96 offset:128
  s_mov_b64 exec, -1
  v_mfma_f32_32x32x16_bf16 v[56:71], v[136:139], v[120:123], v[56:71]
  v_cndmask_b32 v100, v100, v101, s[50:51]
  v_cndmask_b32 v100, v100, v102, s[52:53]
  v_cndmask_b32 v100, v100, v103, s[54:55]
  v_cndmask_b32 v104, v104, v105, s[50:51]
  v_cndmask_b32 v104, v104, v106, s[52:53]
  v_cndmask_b32 v104, v104, v107, s[54:55]
  s_mov_b32 exec_lo, 0x00f0000f
  s_mov_b32 exec_hi, 0xf0000f00
  ds_write_b32 v110, v100 offset:0
  ds_write_b32 v110, v104 offset:64
  s_mov_b64 exec, -1
  v_mfma_f32_32x32x16_bf16 v[72:87], v[120:123], v[140:143], v[72:87]
  ds_read_b32 v118, v111 offset:1536
  s_waitcnt lgkmcnt(1)
  s_barrier
  ds_read_b128 v[124:127], v112 offset:0
  ds_read_b128 v[128:131], v112 offset:32
  ds_read_b128 v[132:135], v112 offset:64
  ds_read_b128 v[136:139], v112 offset:96
  ds_read_b128 v[140:143], v112 offset:112
  ds_read_b128 v[144:147], v112 offset:144
  ds_read_b128 v[148:151], v112 offset:176
  ds_read_b128 v[152:155], v112 offset:208
  ds_read_b32 v156, v114 offset:224
  v_mov_b32 v122, v52
  v_mov_b32 v123, v52
  s_nop 1
  v_permlane32_swap_b32 v122, v123
  v_mul_f32 v122, 0xbb124925, v123
  s_waitcnt lgkmcnt(9)
  v_mul_f32 v118, 0x3b124925, v118
  v_fma_f32 v118, -v122, v122, v118
  v_max_f32 v118, 0, v118
  v_cvt_pk_bf16_f32 v122, v122, v122
  v_lshlrev_b32 v122, 16, v122
  v_cvt_pk_bf16_f32 v118, v118, v118
  v_lshlrev_b32 v118, 16, v118
  v_add_f32 v118, 0x3727c5ac, v118
  v_cvt_pk_bf16_f32 v118, v118, v118
  v_lshlrev_b32 v118, 16, v118
  v_sqrt_f32 v118, v118
  s_nop 0
  v_cvt_pk_bf16_f32 v118, v118, v118
  v_lshlrev_b32 v118, 16, v118
  v_rcp_f32 v120, v118
  ds_write_b32 v111, v122 offset:1024
  ds_write_b32 v111, v120 offset:512
  ds_read_b128 v[172:175], v113 offset:512
  ds_read_b128 v[188:191], v113 offset:1024
  ds_read_b128 v[176:179], v113 offset:544
  ds_read_b128 v[192:195], v113 offset:1056
  ds_read_b128 v[180:183], v113 offset:576
  ds_read_b128 v[196:199], v113 offset:1088
  ds_read_b128 v[184:187], v113 offset:608
  ds_read_b128 v[200:203], v113 offset:1120
  v_cmp_eq_u32 s[56:57], 0, v3
  v_cmp_gt_u32 s[58:59], 28, v2
  v_mov_b32 v204, 0x3f803f80
  v_cmp_eq_u32 vcc, 28, v2
  s_nop 1
  v_cndmask_b32 v204, 0, v204, vcc
  s_waitcnt lgkmcnt(15)
  v_pk_fma_f32 v[40:41], v[124:125], v[122:123], v[40:41] op_sel_hi:[1,0,1]
  v_pk_fma_f32 v[42:43], v[126:127], v[122:123], v[42:43] op_sel_hi:[1,0,1]
  v_pk_fma_f32 v[44:45], v[128:129], v[122:123], v[44:45] op_sel_hi:[1,0,1]
  v_pk_fma_f32 v[46:47], v[130:131], v[122:123], v[46:47] op_sel_hi:[1,0,1]
  v_pk_fma_f32 v[48:49], v[132:133], v[122:123], v[48:49] op_sel_hi:[1,0,1]
  v_pk_fma_f32 v[50:51], v[134:135], v[122:123], v[50:51] op_sel_hi:[1,0,1]
  v_pk_fma_f32 v[52:53], v[136:137], v[122:123], v[52:53] op_sel_hi:[1,0,1]
  v_pk_fma_f32 v[54:55], v[138:139], v[122:123], v[54:55] op_sel_hi:[1,0,1]
  v_pk_mul_f32 v[40:41], v[40:41], v[120:121] op_sel_hi:[1,0]
  v_pk_mul_f32 v[42:43], v[42:43], v[120:121] op_sel_hi:[1,0]
  v_pk_mul_f32 v[44:45], v[44:45], v[120:121] op_sel_hi:[1,0]
  v_pk_mul_f32 v[46:47], v[46:47], v[120:121] op_sel_hi:[1,0]
  v_pk_mul_f32 v[48:49], v[48:49], v[120:121] op_sel_hi:[1,0]
  v_pk_mul_f32 v[50:51], v[50:51], v[120:121] op_sel_hi:[1,0]
  v_pk_mul_f32 v[52:53], v[52:53], v[120:121] op_sel_hi:[1,0]
  v_pk_mul_f32 v[54:55], v[54:55], v[120:121] op_sel_hi:[1,0]
  v_cvt_pk_bf16_f32 v208, v40, v41
  v_cvt_pk_bf16_f32 v209, v42, v43
  v_cvt_pk_bf16_f32 v210, v44, v45
  v_cvt_pk_bf16_f32 v211, v46, v47
  v_cvt_pk_bf16_f32 v212, v48, v49
  v_cvt_pk_bf16_f32 v213, v50, v51
  v_cvt_pk_bf16_f32 v214, v52, v53
  v_cvt_pk_bf16_f32 v215, v54, v55
  v_cndmask_b32 v214, 0, v214, s[56:57]
  v_cndmask_b32 v215, 0, v215, s[56:57]
  s_add_u32 s29, s49, 0x0
  buffer_store_dwordx4 v[208:211], v115, s[20:23], s29 offen sc1
  buffer_store_dwordx4 v[212:215], v115, s[20:23], s29 offen offset:256 sc1
  s_waitcnt lgkmcnt(11)
  v_pk_fma_f32 v[56:57], v[140:141], v[122:123], v[56:57] op_sel_hi:[1,0,1]
  v_pk_fma_f32 v[58:59], v[142:143], v[122:123], v[58:59] op_sel_hi:[1,0,1]
  v_pk_fma_f32 v[60:61], v[144:145], v[122:123], v[60:61] op_sel_hi:[1,0,1]
  v_pk_fma_f32 v[62:63], v[146:147], v[122:123], v[62:63] op_sel_hi:[1,0,1]
  v_pk_fma_f32 v[64:65], v[148:149], v[122:123], v[64:65] op_sel_hi:[1,0,1]
  v_pk_fma_f32 v[66:67], v[150:151], v[122:123], v[66:67] op_sel_hi:[1,0,1]
  v_pk_fma_f32 v[68:69], v[152:153], v[122:123], v[68:69] op_sel_hi:[1,0,1]
  v_pk_fma_f32 v[70:71], v[154:155], v[122:123], v[70:71] op_sel_hi:[1,0,1]
  v_pk_mul_f32 v[56:57], v[56:57], v[120:121] op_sel_hi:[1,0]
  v_pk_mul_f32 v[58:59], v[58:59], v[120:121] op_sel_hi:[1,0]
  v_pk_mul_f32 v[60:61], v[60:61], v[120:121] op_sel_hi:[1,0]
  v_pk_mul_f32 v[62:63], v[62:63], v[120:121] op_sel_hi:[1,0]
  v_pk_mul_f32 v[64:65], v[64:65], v[120:121] op_sel_hi:[1,0]
  v_pk_mul_f32 v[66:67], v[66:67], v[120:121] op_sel_hi:[1,0]
  v_pk_mul_f32 v[68:69], v[68:69], v[120:121] op_sel_hi:[1,0]
  v_pk_mul_f32 v[70:71], v[70:71], v[120:121] op_sel_hi:[1,0]
  v_cvt_pk_bf16_f32 v216, v56, v57
  v_cvt_pk_bf16_f32 v217, v58, v59
  v_cvt_pk_bf16_f32 v218, v60, v61
  v_cvt_pk_bf16_f32 v219, v62, v63
  v_cvt_pk_bf16_f32 v220, v64, v65
  v_cvt_pk_bf16_f32 v221, v66, v67
  v_cvt_pk_bf16_f32 v222, v68, v69
  v_cvt_pk_bf16_f32 v223, v70, v71
  v_cndmask_b32 v222, 0, v222, s[56:57]
  v_cndmask_b32 v223, 0, v223, s[56:57]
  s_add_u32 s29, s49, 0x20000
  buffer_store_dwordx4 v[216:219], v115, s[20:23], s29 offen sc1
  buffer_store_dwordx4 v[220:223], v115, s[20:23], s29 offen offset:256 sc1
  s_waitcnt lgkmcnt(10)
  s_waitcnt lgkmcnt(0)
  v_pk_fma_f32 v[72:73], v[188:189], v[156:157], v[72:73] op_sel_hi:[1,0,1]
  v_pk_fma_f32 v[74:75], v[190:191], v[156:157], v[74:75] op_sel_hi:[1,0,1]
  v_pk_fma_f32 v[76:77], v[192:193], v[156:157], v[76:77] op_sel_hi:[1,0,1]
  v_pk_fma_f32 v[78:79], v[194:195], v[156:157], v[78:79] op_sel_hi:[1,0,1]
  v_pk_fma_f32 v[80:81], v[196:197], v[156:157], v[80:81] op_sel_hi:[1,0,1]
  v_pk_fma_f32 v[82:83], v[198:199], v[156:157], v[82:83] op_sel_hi:[1,0,1]
  v_pk_fma_f32 v[84:85], v[200:201], v[156:157], v[84:85] op_sel_hi:[1,0,1]
  v_pk_fma_f32 v[86:87], v[202:203], v[156:157], v[86:87] op_sel_hi:[1,0,1]
  v_pk_mul_f32 v[72:73], v[72:73], v[172:173]
  v_pk_mul_f32 v[74:75], v[74:75], v[174:175]
  v_pk_mul_f32 v[76:77], v[76:77], v[176:177]
  v_pk_mul_f32 v[78:79], v[78:79], v[178:179]
  v_pk_mul_f32 v[80:81], v[80:81], v[180:181]
  v_pk_mul_f32 v[82:83], v[82:83], v[182:183]
  v_pk_mul_f32 v[84:85], v[84:85], v[184:185]
  v_pk_mul_f32 v[86:87], v[86:87], v[186:187]
  v_cvt_pk_bf16_f32 v208, v72, v73
  v_cvt_pk_bf16_f32 v209, v74, v75
  v_cvt_pk_bf16_f32 v210, v76, v77
  v_cvt_pk_bf16_f32 v211, v78, v79
  v_cvt_pk_bf16_f32 v212, v80, v81
  v_cvt_pk_bf16_f32 v213, v82, v83
  v_cvt_pk_bf16_f32 v214, v84, v85
  v_cvt_pk_bf16_f32 v215, v86, v87
  v_cndmask_b32 v208, v204, v208, s[58:59]
  v_cndmask_b32 v209, v204, v209, s[58:59]
  v_cndmask_b32 v210, v204, v210, s[58:59]
  v_cndmask_b32 v211, v204, v211, s[58:59]
  v_cndmask_b32 v212, v204, v212, s[58:59]
  v_cndmask_b32 v213, v204, v213, s[58:59]
  v_cndmask_b32 v214, v204, v214, s[58:59]
  v_cndmask_b32 v215, v204, v215, s[58:59]
  s_add_u32 s29, s49, 0x40000
  buffer_store_dwordx2 v[208:209], v116, s[20:23], s29 offen offset:0 sc1
  buffer_store_dwordx2 v[210:211], v116, s[20:23], s29 offen offset:256 sc1
  buffer_store_dwordx2 v[212:213], v116, s[20:23], s29 offen offset:1024 sc1
  buffer_store_dwordx2 v[214:215], v116, s[20:23], s29 offen offset:1280 sc1
  s_endpgm
k1_qkv_kernel_varC_5:
  s_barrier
  ds_read_b128 v[120:123], v12 offset:0
  ds_read_b64_tr_b16 v[132:133], v32 offset:0
  ds_read_b64_tr_b16 v[134:135], v32 offset:768
  v_add_u32 v32, v33, v32
  ds_read_b64_tr_b16 v[136:137], v16 offset:56
  ds_read_b64_tr_b16 v[138:139], v16 offset:824
  ds_read_b64_tr_b16 v[140:141], v16 offset:112
  ds_read_b64_tr_b16 v[142:143], v16 offset:880
  ds_read_b128 v[124:127], v13 offset:0
  ds_read_b64_tr_b16 v[144:145], v32 offset:0
  ds_read_b64_tr_b16 v[146:147], v32 offset:768
  v_add_u32 v32, v33, v32
  ds_read_b64_tr_b16 v[148:149], v16 offset:3128
  ds_read_b64_tr_b16 v[150:151], v16 offset:3896
  ds_read_b64_tr_b16 v[152:153], v16 offset:3184
  ds_read_b64_tr_b16 v[154:155], v16 offset:3952
  s_waitcnt lgkmcnt(7)
  v_mfma_f32_32x32x16_bf16 v[40:55], v[120:123], v[132:135], 0
  ds_read_b128 v[128:131], v14 offset:0
  ds_read_b64_tr_b16 v[156:157], v32 offset:0
  ds_read_b64_tr_b16 v[158:159], v32 offset:768
  v_add_u32 v32, v33, v32
  v_mfma_f32_32x32x16_bf16 v[56:71], v[120:123], v[136:139], 0
  ds_read_b64_tr_b16 v[160:161], v16 offset:6200
  ds_read_b64_tr_b16 v[162:163], v16 offset:6968
  ds_read_b64_tr_b16 v[164:165], v16 offset:6256
  ds_read_b64_tr_b16 v[166:167], v16 offset:7024
  v_mfma_f32_32x32x16_bf16 v[72:87], v[120:123], v[140:143], 0
  ds_read_b128 v[168:171], v20 offset:0
  ds_read_b128 v[172:175], v21 offset:0
  ds_read_b128 v[176:179], v22 offset:0
  ds_read_b128 v[180:183], v23 offset:0
  s_waitcnt lgkmcnt(11)
  v_mfma_f32_32x32x16_bf16 v[40:55], v[124:127], v[144:147], v[40:55]
  ds_read_b128 v[120:123], v15 offset:0
  ds_read_b64_tr_b16 v[132:133], v32 offset:0
  ds_read_b64_tr_b16 v[134:135], v32 offset:768
  v_add_u32 v32, v33, v32
  ds_read_b64_tr_b16 v[136:137], v16 offset:9272
  v_mfma_f32_32x32x16_bf16 v[56:71], v[124:127], v[148:151], v[56:71]
  ds_read_b64_tr_b16 v[138:139], v16 offset:10040
  ds_read_b64_tr_b16 v[140:141], v16 offset:9328
  ds_read_b64_tr_b16 v[142:143], v16 offset:10096
  ds_read_b64_tr_b16 v[184:185], v24 offset:0
  ds_read_b64_tr_b16 v[186:187], v24 offset:768
  v_mfma_f32_32x32x16_bf16 v[72:87], v[124:127], v[152:155], v[72:87]
  ds_read_b64_tr_b16 v[188:189], v24 offset:32
  ds_read_b64_tr_b16 v[190:191], v24 offset:800
  ds_read_b64_tr_b16 v[192:193], v24 offset:64
  ds_read_b64_tr_b16 v[194:195], v24 offset:832
  s_barrier
  s_waitcnt lgkmcnt(15)
  v_mfma_f32_32x32x16_bf16 v[40:55], v[128:131], v[156:159], v[40:55]
  ds_read_b128 v[124:127], v12 offset:4096
  ds_read_b64_tr_b16 v[144:145], v32 offset:0
  ds_read_b64_tr_b16 v[146:147], v32 offset:768
  v_mfma_f32_32x32x16_bf16 v[56:71], v[128:131], v[160:163], v[56:71]
  v_add_u32 v32, v33, v32
  ds_read_b64_tr_b16 v[148:149], v16 offset:12344
  ds_read_b64_tr_b16 v[150:151], v16 offset:13112
  v_mfma_f32_32x32x16_bf16 v[72:87], v[128:131], v[164:167], v[72:87]
  ds_read_b64_tr_b16 v[152:153], v16 offset:12400
  ds_read_b64_tr_b16 v[154:155], v16 offset:13168
  s_waitcnt lgkmcnt(15)
  v_mfma_f32_16x16x32_bf16 v[100:103], v[168:171], v[168:171], 0
  v_mfma_f32_16x16x32_bf16 v[100:103], v[172:175], v[172:175], v[100:103]
  v_mfma_f32_16x16x32_bf16 v[104:107], v[176:179], v[176:179], 0
  v_mfma_f32_16x16x32_bf16 v[104:107], v[180:183], v[180:183], v[104:107]
  s_waitcnt lgkmcnt(13)
  v_mfma_f32_32x32x16_bf16 v[40:55], v[120:123], v[132:135], v[40:55]
  ds_read_b128 v[128:131], v13 offset:4096
  ds_read_b64_tr_b16 v[156:157], v32 offset:0
  ds_read_b64_tr_b16 v[158:159], v32 offset:768
  v_mfma_f32_32x32x16_bf16 v[56:71], v[120:123], v[136:139], v[56:71]
  v_add_u32 v32, v33, v32
  ds_read_b64_tr_b16 v[160:161], v16 offset:15416
  ds_read_b64_tr_b16 v[162:163], v16 offset:16184
  v_mfma_f32_32x32x16_bf16 v[72:87], v[120:123], v[140:143], v[72:87]
  ds_read_b64_tr_b16 v[164:165], v16 offset:15472
  ds_read_b64_tr_b16 v[166:167], v16 offset:16240
  s_waitcnt lgkmcnt(14)
  v_mfma_f32_16x16x32_bf16 v[88:91], v[28:31], v[184:187], 0
  v_mfma_f32_16x16x32_bf16 v[92:95], v[28:31], v[188:191], 0
  v_mfma_f32_16x16x32_bf16 v[96:99], v[28:31], v[192:195], 0
  s_waitcnt lgkmcnt(7)
  v_mfma_f32_32x32x16_bf16 v[40:55], v[124:127], v[144:147], v[40:55]
  ds_read_b128 v[120:123], v14 offset:4096
  ds_read_b64_tr_b16 v[132:133], v32 offset:0
  ds_read_b64_tr_b16 v[134:135], v32 offset:768
  v_add_u32 v32, v33, v32
  v_mfma_f32_32x32x16_bf16 v[56:71], v[124:127], v[148:151], v[56:71]
  ds_read_b64_tr_b16 v[136:137], v16 offset:18488
  ds_read_b64_tr_b16 v[138:139], v16 offset:19256
  ds_read_b64_tr_b16 v[140:141], v16 offset:18544
  ds_read_b64_tr_b16 v[142:143], v16 offset:19312
  v_mfma_f32_32x32x16_bf16 v[72:87], v[124:127], v[152:155], v[72:87]
  ds_read_b128 v[168:171], v20 offset:4096
  ds_read_b128 v[172:175], v21 offset:4096
  ds_read_b128 v[176:179], v22 offset:4096
  ds_read_b128 v[180:183], v23 offset:4096
  s_waitcnt lgkmcnt(11)
  v_mfma_f32_32x32x16_bf16 v[40:55], v[128:131], v[156:159], v[40:55]
  ds_read_b128 v[124:127], v15 offset:4096
  ds_read_b64_tr_b16 v[144:145], v32 offset:0
  ds_read_b64_tr_b16 v[146:147], v32 offset:768
  v_add_u32 v32, v33, v32
  ds_read_b64_tr_b16 v[148:149], v16 offset:21560
  v_mfma_f32_32x32x16_bf16 v[56:71], v[128:131], v[160:163], v[56:71]
  ds_read_b64_tr_b16 v[150:151], v16 offset:22328
  ds_read_b64_tr_b16 v[152:153], v16 offset:21616
  ds_read_b64_tr_b16 v[154:155], v16 offset:22384
  ds_read_b64_tr_b16 v[184:185], v24 offset:12288
  ds_read_b64_tr_b16 v[186:187], v24 offset:13056
  v_mfma_f32_32x32x16_bf16 v[72:87], v[128:131], v[164:167], v[72:87]
  ds_read_b64_tr_b16 v[188:189], v24 offset:12320
  ds_read_b64_tr_b16 v[190:191], v24 offset:13088
  ds_read_b64_tr_b16 v[192:193], v24 offset:12352
  ds_read_b64_tr_b16 v[194:195], v24 offset:13120
  s_barrier
  s_waitcnt lgkmcnt(15)
  v_mfma_f32_32x32x16_bf16 v[40:55], v[120:123], v[132:135], v[40:55]
  ds_read_b128 v[128:131], v12 offset:8192
  ds_read_b64_tr_b16 v[156:157], v32 offset:0
  ds_read_b64_tr_b16 v[158:159], v32 offset:768
  v_mfma_f32_32x32x16_bf16 v[56:71], v[120:123], v[136:139], v[56:71]
  v_add_u32 v32, v33, v32
  ds_read_b64_tr_b16 v[160:161], v16 offset:24632
  ds_read_b64_tr_b16 v[162:163], v16 offset:25400
  v_mfma_f32_32x32x16_bf16 v[72:87], v[120:123], v[140:143], v[72:87]
  ds_read_b64_tr_b16 v[164:165], v16 offset:24688
  ds_read_b64_tr_b16 v[166:167], v16 offset:25456
  s_waitcnt lgkmcnt(15)
  v_mfma_f32_16x16x32_bf16 v[100:103], v[168:171], v[168:171], v[100:103]
  v_mfma_f32_16x16x32_bf16 v[100:103], v[172:175], v[172:175], v[100:103]
  v_mfma_f32_16x16x32_bf16 v[104:107], v[176:179], v[176:179], v[104:107]
  v_mfma_f32_16x16x32_bf16 v[104:107], v[180:183], v[180:183], v[104:107]
  s_waitcnt lgkmcnt(13)
  v_mfma_f32_32x32x16_bf16 v[40:55], v[124:127], v[144:147], v[40:55]
  ds_read_b128 v[120:123], v13 offset:8192
  ds_read_b64_tr_b16 v[132:133], v32 offset:0
  ds_read_b64_tr_b16 v[134:135], v32 offset:768
  v_mfma_f32_32x32x16_bf16 v[56:71], v[124:127], v[148:151], v[56:71]
  v_add_u32 v32, v33, v32
  ds_read_b64_tr_b16 v[136:137], v16 offset:27704
  ds_read_b64_tr_b16 v[138:139], v16 offset:28472
  v_mfma_f32_32x32x16_bf16 v[72:87], v[124:127], v[152:155], v[72:87]
  ds_read_b64_tr_b16 v[140:141], v16 offset:27760
  ds_read_b64_tr_b16 v[142:143], v16 offset:28528
  s_waitcnt lgkmcnt(14)
  v_mfma_f32_16x16x32_bf16 v[88:91], v[28:31], v[184:187], v[88:91]
  v_mfma_f32_16x16x32_bf16 v[92:95], v[28:31], v[188:191], v[92:95]
  v_mfma_f32_16x16x32_bf16 v[96:99], v[28:31], v[192:195], v[96:99]
  s_waitcnt lgkmcnt(7)
  v_mfma_f32_32x32x16_bf16 v[40:55], v[128:131], v[156:159], v[40:55]
  ds_read_b128 v[124:127], v14 offset:8192
  ds_read_b64_tr_b16 v[144:145], v32 offset:0
  ds_read_b64_tr_b16 v[146:147], v32 offset:768
  v_add_u32 v32, v33, v32
  v_mfma_f32_32x32x16_bf16 v[56:71], v[128:131], v[160:163], v[56:71]
  ds_read_b64_tr_b16 v[148:149], v16 offset:30776
  ds_read_b64_tr_b16 v[150:151], v16 offset:31544
  ds_read_b64_tr_b16 v[152:153], v16 offset:30832
  ds_read_b64_tr_b16 v[154:155], v16 offset:31600
  v_mfma_f32_32x32x16_bf16 v[72:87], v[128:131], v[164:167], v[72:87]
  ds_read_b128 v[168:171], v20 offset:8192
  ds_read_b128 v[172:175], v21 offset:8192
  ds_read_b128 v[176:179], v22 offset:8192
  ds_read_b128 v[180:183], v23 offset:8192
  s_waitcnt lgkmcnt(11)
  v_mfma_f32_32x32x16_bf16 v[40:55], v[120:123], v[132:135], v[40:55]
  ds_read_b128 v[128:131], v15 offset:8192
  ds_read_b64_tr_b16 v[156:157], v32 offset:0
  ds_read_b64_tr_b16 v[158:159], v32 offset:768
  v_add_u32 v32, v33, v32
  ds_read_b64_tr_b16 v[160:161], v16 offset:33848
  v_mfma_f32_32x32x16_bf16 v[56:71], v[120:123], v[136:139], v[56:71]
  ds_read_b64_tr_b16 v[162:163], v16 offset:34616
  ds_read_b64_tr_b16 v[164:165], v16 offset:33904
  ds_read_b64_tr_b16 v[166:167], v16 offset:34672
  ds_read_b64_tr_b16 v[184:185], v24 offset:24576
  ds_read_b64_tr_b16 v[186:187], v24 offset:25344
  v_mfma_f32_32x32x16_bf16 v[72:87], v[120:123], v[140:143], v[72:87]
  ds_read_b64_tr_b16 v[188:189], v24 offset:24608
  ds_read_b64_tr_b16 v[190:191], v24 offset:25376
  ds_read_b64_tr_b16 v[192:193], v24 offset:24640
  ds_read_b64_tr_b16 v[194:195], v24 offset:25408
  s_barrier
  s_waitcnt lgkmcnt(15)
  v_mfma_f32_32x32x16_bf16 v[40:55], v[124:127], v[144:147], v[40:55]
  ds_read_b128 v[120:123], v12 offset:12288
  ds_read_b64_tr_b16 v[132:133], v32 offset:0
  ds_read_b64_tr_b16 v[134:135], v32 offset:768
  v_mfma_f32_32x32x16_bf16 v[56:71], v[124:127], v[148:151], v[56:71]
  v_add_u32 v32, v33, v32
  ds_read_b64_tr_b16 v[136:137], v16 offset:36920
  ds_read_b64_tr_b16 v[138:139], v16 offset:37688
  v_mfma_f32_32x32x16_bf16 v[72:87], v[124:127], v[152:155], v[72:87]
  ds_read_b64_tr_b16 v[140:141], v16 offset:36976
  ds_read_b64_tr_b16 v[142:143], v16 offset:37744
  s_waitcnt lgkmcnt(15)
  v_mfma_f32_16x16x32_bf16 v[100:103], v[168:171], v[168:171], v[100:103]
  v_mfma_f32_16x16x32_bf16 v[100:103], v[172:175], v[172:175], v[100:103]
  v_mfma_f32_16x16x32_bf16 v[104:107], v[176:179], v[176:179], v[104:107]
  v_mfma_f32_16x16x32_bf16 v[104:107], v[180:183], v[180:183], v[104:107]
  s_waitcnt lgkmcnt(13)
  v_mfma_f32_32x32x16_bf16 v[40:55], v[128:131], v[156:159], v[40:55]
  ds_read_b128 v[124:127], v13 offset:12288
  ds_read_b64_tr_b16 v[144:145], v32 offset:0
  ds_read_b64_tr_b16 v[146:147], v32 offset:768
  v_mfma_f32_32x32x16_bf16 v[56:71], v[128:131], v[160:163], v[56:71]
  v_add_u32 v32, v33, v32
  ds_read_b64_tr_b16 v[148:149], v16 offset:39992
  ds_read_b64_tr_b16 v[150:151], v16 offset:40760
  v_mfma_f32_32x32x16_bf16 v[72:87], v[128:131], v[164:167], v[72:87]
  ds_read_b64_tr_b16 v[152:153], v16 offset:40048
  ds_read_b64_tr_b16 v[154:155], v16 offset:40816
  s_waitcnt lgkmcnt(14)
  v_mfma_f32_16x16x32_bf16 v[88:91], v[28:31], v[184:187], v[88:91]
  v_mfma_f32_16x16x32_bf16 v[92:95], v[28:31], v[188:191], v[92:95]
  v_mfma_f32_16x16x32_bf16 v[96:99], v[28:31], v[192:195], v[96:99]
  s_waitcnt lgkmcnt(7)
  v_mfma_f32_32x32x16_bf16 v[40:55], v[120:123], v[132:135], v[40:55]
  ds_read_b128 v[128:131], v14 offset:12288
  ds_read_b64_tr_b16 v[156:157], v32 offset:0
  ds_read_b64_tr_b16 v[158:159], v32 offset:768
  v_add_u32 v32, v33, v32
  v_mfma_f32_32x32x16_bf16 v[56:71], v[120:123], v[136:139], v[56:71]
  ds_read_b64_tr_b16 v[160:161], v16 offset:43064
  ds_read_b64_tr_b16 v[162:163], v16 offset:43832
  ds_read_b64_tr_b16 v[164:165], v16 offset:43120
  ds_read_b64_tr_b16 v[166:167], v16 offset:43888
  v_mfma_f32_32x32x16_bf16 v[72:87], v[120:123], v[140:143], v[72:87]
  ds_read_b128 v[168:171], v20 offset:12288
  ds_read_b128 v[172:175], v21 offset:12288
  ds_read_b128 v[176:179], v22 offset:12288
  ds_read_b128 v[180:183], v23 offset:12288
  s_waitcnt lgkmcnt(11)
  v_mfma_f32_32x32x16_bf16 v[40:55], v[124:127], v[144:147], v[40:55]
  ds_read_b128 v[120:123], v15 offset:12288
  ds_read_b64_tr_b16 v[132:133], v32 offset:0
  ds_read_b64_tr_b16 v[134:135], v32 offset:768
  v_add_u32 v32, v33, v32
  ds_read_b64_tr_b16 v[136:137], v16 offset:46136
  v_mfma_f32_32x32x16_bf16 v[56:71], v[124:127], v[148:151], v[56:71]
  ds_read_b64_tr_b16 v[138:139], v16 offset:46904
  ds_read_b64_tr_b16 v[140:141], v16 offset:46192
  ds_read_b64_tr_b16 v[142:143], v16 offset:46960
  ds_read_b64_tr_b16 v[184:185], v24 offset:36864
  ds_read_b64_tr_b16 v[186:187], v24 offset:37632
  v_mfma_f32_32x32x16_bf16 v[72:87], v[124:127], v[152:155], v[72:87]
  ds_read_b64_tr_b16 v[188:189], v24 offset:36896
  ds_read_b64_tr_b16 v[190:191], v24 offset:37664
  ds_read_b64_tr_b16 v[192:193], v24 offset:36928
  ds_read_b64_tr_b16 v[194:195], v24 offset:37696
  s_barrier
  s_waitcnt lgkmcnt(15)
  v_mfma_f32_32x32x16_bf16 v[40:55], v[128:131], v[156:159], v[40:55]
  ds_read_b128 v[124:127], v12 offset:0
  ds_read_b64_tr_b16 v[144:145], v32 offset:0
  ds_read_b64_tr_b16 v[146:147], v32 offset:768
  v_mfma_f32_32x32x16_bf16 v[56:71], v[128:131], v[160:163], v[56:71]
  v_add_u32 v32, v33, v32
  ds_read_b64_tr_b16 v[148:149], v26 offset:56
  ds_read_b64_tr_b16 v[150:151], v26 offset:824
  v_mfma_f32_32x32x16_bf16 v[72:87], v[128:131], v[164:167], v[72:87]
  ds_read_b64_tr_b16 v[152:153], v26 offset:112
  ds_read_b64_tr_b16 v[154:155], v26 offset:880
  s_waitcnt lgkmcnt(15)
  v_mfma_f32_16x16x32_bf16 v[100:103], v[168:171], v[168:171], v[100:103]
  v_mfma_f32_16x16x32_bf16 v[100:103], v[172:175], v[172:175], v[100:103]
  v_mfma_f32_16x16x32_bf16 v[104:107], v[176:179], v[176:179], v[104:107]
  v_mfma_f32_16x16x32_bf16 v[104:107], v[180:183], v[180:183], v[104:107]
  s_waitcnt lgkmcnt(13)
  v_mfma_f32_32x32x16_bf16 v[40:55], v[120:123], v[132:135], v[40:55]
  ds_read_b128 v[128:131], v13 offset:0
  ds_read_b64_tr_b16 v[156:157], v32 offset:0
  ds_read_b64_tr_b16 v[158:159], v32 offset:768
  v_mfma_f32_32x32x16_bf16 v[56:71], v[120:123], v[136:139], v[56:71]
  v_add_u32 v32, v33, v32
  ds_read_b64_tr_b16 v[160:161], v26 offset:3128
  ds_read_b64_tr_b16 v[162:163], v26 offset:3896
  v_mfma_f32_32x32x16_bf16 v[72:87], v[120:123], v[140:143], v[72:87]
  ds_read_b64_tr_b16 v[164:165], v26 offset:3184
  ds_read_b64_tr_b16 v[166:167], v26 offset:3952
  s_waitcnt lgkmcnt(14)
  v_mfma_f32_16x16x32_bf16 v[88:91], v[28:31], v[184:187], v[88:91]
  v_mfma_f32_16x16x32_bf16 v[92:95], v[28:31], v[188:191], v[92:95]
  v_mfma_f32_16x16x32_bf16 v[96:99], v[28:31], v[192:195], v[96:99]
  s_waitcnt lgkmcnt(7)
  v_mfma_f32_32x32x16_bf16 v[40:55], v[124:127], v[144:147], v[40:55]
  ds_read_b128 v[120:123], v14 offset:0
  ds_read_b64_tr_b16 v[132:133], v32 offset:0
  ds_read_b64_tr_b16 v[134:135], v32 offset:768
  v_add_u32 v32, v33, v32
  v_mfma_f32_32x32x16_bf16 v[56:71], v[124:127], v[148:151], v[56:71]
  ds_read_b64_tr_b16 v[136:137], v26 offset:6200
  ds_read_b64_tr_b16 v[138:139], v26 offset:6968
  ds_read_b64_tr_b16 v[140:141], v26 offset:6256
  ds_read_b64_tr_b16 v[142:143], v26 offset:7024
  v_mfma_f32_32x32x16_bf16 v[72:87], v[124:127], v[152:155], v[72:87]
  ds_read_b128 v[168:171], v20 offset:0
  ds_read_b128 v[172:175], v21 offset:0
  ds_read_b128 v[176:179], v22 offset:0
  ds_read_b128 v[180:183], v23 offset:0
  s_waitcnt lgkmcnt(11)
  v_mfma_f32_32x32x16_bf16 v[40:55], v[128:131], v[156:159], v[40:55]
  ds_read_b128 v[124:127], v15 offset:0
  ds_read_b64_tr_b16 v[144:145], v32 offset:0
  ds_read_b64_tr_b16 v[146:147], v32 offset:768
  v_add_u32 v32, v33, v32
  ds_read_b64_tr_b16 v[148:149], v26 offset:9272
  v_mfma_f32_32x32x16_bf16 v[56:71], v[128:131], v[160:163], v[56:71]
  ds_read_b64_tr_b16 v[150:151], v26 offset:10040
  ds_read_b64_tr_b16 v[152:153], v26 offset:9328
  ds_read_b64_tr_b16 v[154:155], v26 offset:10096
  ds_read_b64_tr_b16 v[184:185], v27 offset:0
  ds_read_b64_tr_b16 v[186:187], v27 offset:768
  v_mfma_f32_32x32x16_bf16 v[72:87], v[128:131], v[164:167], v[72:87]
  ds_read_b64_tr_b16 v[188:189], v27 offset:32
  ds_read_b64_tr_b16 v[190:191], v27 offset:800
  ds_read_b64_tr_b16 v[192:193], v27 offset:64
  ds_read_b64_tr_b16 v[194:195], v27 offset:832
  s_barrier
  s_waitcnt lgkmcnt(15)
  v_mfma_f32_32x32x16_bf16 v[40:55], v[120:123], v[132:135], v[40:55]
  ds_read_b128 v[128:131], v12 offset:4096
  ds_read_b64_tr_b16 v[156:157], v32 offset:0
  ds_read_b64_tr_b16 v[158:159], v32 offset:768
  v_mfma_f32_32x32x16_bf16 v[56:71], v[120:123], v[136:139], v[56:71]
  v_add_u32 v32, v33, v32
  ds_read_b64_tr_b16 v[160:161], v26 offset:12344
  ds_read_b64_tr_b16 v[162:163], v26 offset:13112
  v_mfma_f32_32x32x16_bf16 v[72:87], v[120:123], v[140:143], v[72:87]
  ds_read_b64_tr_b16 v[164:165], v26 offset:12400
  ds_read_b64_tr_b16 v[166:167], v26 offset:13168
  s_waitcnt lgkmcnt(15)
  v_mfma_f32_16x16x32_bf16 v[100:103], v[168:171], v[168:171], v[100:103]
  v_mfma_f32_16x16x32_bf16 v[100:103], v[172:175], v[172:175], v[100:103]
  v_mfma_f32_16x16x32_bf16 v[104:107], v[176:179], v[176:179], v[104:107]
  v_mfma_f32_16x16x32_bf16 v[104:107], v[180:183], v[180:183], v[104:107]
  s_waitcnt lgkmcnt(13)
  v_mfma_f32_32x32x16_bf16 v[40:55], v[124:127], v[144:147], v[40:55]
  ds_read_b128 v[120:123], v13 offset:4096
  ds_read_b64_tr_b16 v[132:133], v32 offset:0
  ds_read_b64_tr_b16 v[134:135], v32 offset:768
  v_mfma_f32_32x32x16_bf16 v[56:71], v[124:127], v[148:151], v[56:71]
  v_add_u32 v32, v33, v32
  ds_read_b64_tr_b16 v[136:137], v26 offset:15416
  ds_read_b64_tr_b16 v[138:139], v26 offset:16184
  v_mfma_f32_32x32x16_bf16 v[72:87], v[124:127], v[152:155], v[72:87]
  ds_read_b64_tr_b16 v[140:141], v26 offset:15472
  ds_read_b64_tr_b16 v[142:143], v26 offset:16240
  s_waitcnt lgkmcnt(14)
  v_mfma_f32_16x16x32_bf16 v[88:91], v[28:31], v[184:187], v[88:91]
  v_mfma_f32_16x16x32_bf16 v[92:95], v[28:31], v[188:191], v[92:95]
  v_mfma_f32_16x16x32_bf16 v[96:99], v[28:31], v[192:195], v[96:99]
  s_waitcnt lgkmcnt(7)
  v_mfma_f32_32x32x16_bf16 v[40:55], v[128:131], v[156:159], v[40:55]
  ds_read_b128 v[124:127], v14 offset:4096
  ds_read_b64_tr_b16 v[144:145], v32 offset:0
  ds_read_b64_tr_b16 v[146:147], v32 offset:768
  v_add_u32 v32, v33, v32
  v_mfma_f32_32x32x16_bf16 v[56:71], v[128:131], v[160:163], v[56:71]
  ds_read_b64_tr_b16 v[148:149], v26 offset:18488
  ds_read_b64_tr_b16 v[150:151], v26 offset:19256
  ds_read_b64_tr_b16 v[152:153], v26 offset:18544
  ds_read_b64_tr_b16 v[154:155], v26 offset:19312
  v_mfma_f32_32x32x16_bf16 v[72:87], v[128:131], v[164:167], v[72:87]
  ds_read_b128 v[168:171], v20 offset:4096
  ds_read_b128 v[172:175], v21 offset:4096
  ds_read_b128 v[176:179], v22 offset:4096
  ds_read_b128 v[180:183], v23 offset:4096
  s_waitcnt lgkmcnt(11)
  v_mfma_f32_32x32x16_bf16 v[40:55], v[120:123], v[132:135], v[40:55]
  ds_read_b128 v[128:131], v15 offset:4096
  ds_read_b64_tr_b16 v[156:157], v32 offset:0
  ds_read_b64_tr_b16 v[158:159], v32 offset:768
  v_add_u32 v32, v33, v32
  ds_read_b64_tr_b16 v[160:161], v26 offset:21560
  v_mfma_f32_32x32x16_bf16 v[56:71], v[120:123], v[136:139], v[56:71]
  ds_read_b64_tr_b16 v[162:163], v26 offset:22328
  ds_read_b64_tr_b16 v[164:165], v26 offset:21616
  ds_read_b64_tr_b16 v[166:167], v26 offset:22384
  ds_read_b64_tr_b16 v[184:185], v27 offset:12288
  ds_read_b64_tr_b16 v[186:187], v27 offset:13056
  v_mfma_f32_32x32x16_bf16 v[72:87], v[120:123], v[140:143], v[72:87]
  ds_read_b64_tr_b16 v[188:189], v27 offset:12320
  ds_read_b64_tr_b16 v[190:191], v27 offset:13088
  ds_read_b64_tr_b16 v[192:193], v27 offset:12352
  ds_read_b64_tr_b16 v[194:195], v27 offset:13120
  s_barrier
  s_waitcnt lgkmcnt(15)
  v_mfma_f32_32x32x16_bf16 v[40:55], v[124:127], v[144:147], v[40:55]
  ds_read_b128 v[120:123], v12 offset:8192
  ds_read_b64_tr_b16 v[132:133], v32 offset:0
  ds_read_b64_tr_b16 v[134:135], v32 offset:768
  v_mfma_f32_32x32x16_bf16 v[56:71], v[124:127], v[148:151], v[56:71]
  v_add_u32 v32, v33, v32
  ds_read_b64_tr_b16 v[136:137], v26 offset:24632
  ds_read_b64_tr_b16 v[138:139], v26 offset:25400
  v_mfma_f32_32x32x16_bf16 v[72:87], v[124:127], v[152:155], v[72:87]
  ds_read_b64_tr_b16 v[140:141], v26 offset:24688
  ds_read_b64_tr_b16 v[142:143], v26 offset:25456
  s_waitcnt lgkmcnt(15)
  v_mfma_f32_16x16x32_bf16 v[100:103], v[168:171], v[168:171], v[100:103]
  v_mfma_f32_16x16x32_bf16 v[100:103], v[172:175], v[172:175], v[100:103]
  v_mfma_f32_16x16x32_bf16 v[104:107], v[176:179], v[176:179], v[104:107]
  v_mfma_f32_16x16x32_bf16 v[104:107], v[180:183], v[180:183], v[104:107]
  s_waitcnt lgkmcnt(13)
  v_mfma_f32_32x32x16_bf16 v[40:55], v[128:131], v[156:159], v[40:55]
  ds_read_b128 v[124:127], v13 offset:8192
  ds_read_b64_tr_b16 v[144:145], v32 offset:0
  ds_read_b64_tr_b16 v[146:147], v32 offset:768
  v_mfma_f32_32x32x16_bf16 v[56:71], v[128:131], v[160:163], v[56:71]
  v_add_u32 v32, v33, v32
  ds_read_b64_tr_b16 v[148:149], v26 offset:27704
  ds_read_b64_tr_b16 v[150:151], v26 offset:28472
  v_mfma_f32_32x32x16_bf16 v[72:87], v[128:131], v[164:167], v[72:87]
  ds_read_b64_tr_b16 v[152:153], v26 offset:27760
  ds_read_b64_tr_b16 v[154:155], v26 offset:28528
  s_waitcnt lgkmcnt(14)
  v_mfma_f32_16x16x32_bf16 v[88:91], v[28:31], v[184:187], v[88:91]
  v_mfma_f32_16x16x32_bf16 v[92:95], v[28:31], v[188:191], v[92:95]
  v_mfma_f32_16x16x32_bf16 v[96:99], v[28:31], v[192:195], v[96:99]
  s_waitcnt lgkmcnt(7)
  v_mfma_f32_32x32x16_bf16 v[40:55], v[120:123], v[132:135], v[40:55]
  ds_read_b128 v[128:131], v14 offset:8192
  ds_read_b64_tr_b16 v[156:157], v32 offset:0
  ds_read_b64_tr_b16 v[158:159], v32 offset:768
  v_add_u32 v32, v33, v32
  v_mfma_f32_32x32x16_bf16 v[56:71], v[120:123], v[136:139], v[56:71]
  ds_read_b64_tr_b16 v[160:161], v26 offset:30776
  ds_read_b64_tr_b16 v[162:163], v26 offset:31544
  ds_read_b64_tr_b16 v[164:165], v26 offset:30832
  ds_read_b64_tr_b16 v[166:167], v26 offset:31600
  v_mfma_f32_32x32x16_bf16 v[72:87], v[120:123], v[140:143], v[72:87]
  ds_read_b128 v[168:171], v20 offset:8192
  ds_read_b128 v[172:175], v21 offset:8192
  ds_read_b128 v[176:179], v22 offset:8192
  ds_read_b128 v[180:183], v23 offset:8192
  s_waitcnt lgkmcnt(11)
  v_mfma_f32_32x32x16_bf16 v[40:55], v[124:127], v[144:147], v[40:55]
  ds_read_b128 v[120:123], v15 offset:8192
  ds_read_b64_tr_b16 v[132:133], v32 offset:0
  ds_read_b64_tr_b16 v[134:135], v32 offset:768
  v_add_u32 v32, v33, v32
  ds_read_b64_tr_b16 v[136:137], v26 offset:33848
  v_mfma_f32_32x32x16_bf16 v[56:71], v[124:127], v[148:151], v[56:71]
  ds_read_b64_tr_b16 v[138:139], v26 offset:34616
  ds_read_b64_tr_b16 v[140:141], v26 offset:33904
  ds_read_b64_tr_b16 v[142:143], v26 offset:34672
  ds_read_b64_tr_b16 v[184:185], v27 offset:24576
  ds_read_b64_tr_b16 v[186:187], v27 offset:25344
  v_mfma_f32_32x32x16_bf16 v[72:87], v[124:127], v[152:155], v[72:87]
  ds_read_b64_tr_b16 v[188:189], v27 offset:24608
  ds_read_b64_tr_b16 v[190:191], v27 offset:25376
  ds_read_b64_tr_b16 v[192:193], v27 offset:24640
  ds_read_b64_tr_b16 v[194:195], v27 offset:25408
  s_waitcnt lgkmcnt(13)
  v_mfma_f32_16x16x32_bf16 v[100:103], v[168:171], v[168:171], v[100:103]
  v_mfma_f32_16x16x32_bf16 v[100:103], v[172:175], v[172:175], v[100:103]
  v_mfma_f32_16x16x32_bf16 v[104:107], v[176:179], v[176:179], v[104:107]
  v_mfma_f32_16x16x32_bf16 v[104:107], v[180:183], v[180:183], v[104:107]
  v_mfma_f32_32x32x16_bf16 v[40:55], v[128:131], v[156:159], v[40:55]
  v_mfma_f32_32x32x16_bf16 v[56:71], v[128:131], v[160:163], v[56:71]
  v_mfma_f32_32x32x16_bf16 v[72:87], v[128:131], v[164:167], v[72:87]
  s_waitcnt lgkmcnt(0)
  v_mfma_f32_16x16x32_bf16 v[88:91], v[28:31], v[184:187], v[88:91]
  v_mfma_f32_16x16x32_bf16 v[92:95], v[28:31], v[188:191], v[92:95]
  v_mfma_f32_16x16x32_bf16 v[96:99], v[28:31], v[192:195], v[96:99]
  v_mfma_f32_32x32x16_bf16 v[40:55], v[120:123], v[132:135], v[40:55]
  s_mov_b32 exec_lo, 0xffff
  s_mov_b32 exec_hi, 0
  s_nop 2
  ds_add_f32 v109, v88 offset:0
  ds_add_f32 v109, v92 offset:64
  ds_add_f32 v109, v96 offset:128
  s_mov_b64 exec, -1
  v_mfma_f32_32x32x16_bf16 v[56:71], v[120:123], v[136:139], v[56:71]
  v_cndmask_b32 v100, v100, v101, s[50:51]
  v_cndmask_b32 v100, v100, v102, s[52:53]
  v_cndmask_b32 v100, v100, v103, s[54:55]
  v_cndmask_b32 v104, v104, v105, s[50:51]
  v_cndmask_b32 v104, v104, v106, s[52:53]
  v_cndmask_b32 v104, v104, v107, s[54:55]
  s_mov_b32 exec_lo, 0x00f0000f
  s_mov_b32 exec_hi, 0xf0000f00
  ds_write_b32 v110, v100 offset:0
  ds_write_b32 v110, v104 offset:64
  s_mov_b64 exec, -1
  v_mfma_f32_32x32x16_bf16 v[72:87], v[120:123], v[140:143], v[72:87]
  ds_read_b32 v118, v111 offset:1536
  s_mov_b32 exec_lo, 0x10000000
  s_mov_b32 exec_hi, 0x10000000
  ds_write_b128 v113, v[40:43] offset:1024
  ds_write_b128 v113, v[44:47] offset:1056
  ds_write_b128 v113, v[48:51] offset:1088
  ds_write_b128 v113, v[52:55] offset:1120
  s_mov_b64 exec, -1
  ds_read_b32 v123, v111 offset:1024
  s_waitcnt lgkmcnt(6)
  s_barrier
  ds_read_b32 v124, v114 offset:0
  ds_read_b32 v140, v114 offset:112
  ds_read_b32 v156, v114 offset:224
  s_waitcnt lgkmcnt(3)
  v_mul_f32 v122, 0xbb124925, v123
  v_mul_f32 v118, 0x3b124925, v118
  v_fma_f32 v118, -v122, v122, v118
  v_max_f32 v118, 0, v118
  v_cvt_pk_bf16_f32 v122, v122, v122
  v_lshlrev_b32 v122, 16, v122
  v_cvt_pk_bf16_f32 v118, v118, v118
  v_lshlrev_b32 v118, 16, v118
  v_add_f32 v118, 0x3727c5ac, v118
  v_cvt_pk_bf16_f32 v118, v118, v118
  v_lshlrev_b32 v118, 16, v118
  v_sqrt_f32 v118, v118
  s_nop 0
  v_cvt_pk_bf16_f32 v118, v118, v118
  v_lshlrev_b32 v118, 16, v118
  v_rcp_f32 v120, v118
  ds_write_b32 v111, v122 offset:1024
  ds_write_b32 v111, v120 offset:512
  ds_read_b128 v[172:175], v113 offset:512
  ds_read_b128 v[188:191], v113 offset:1024
  ds_read_b128 v[176:179], v113 offset:544
  ds_read_b128 v[192:195], v113 offset:1056
  ds_read_b128 v[180:183], v113 offset:576
  ds_read_b128 v[196:199], v113 offset:1088
  ds_read_b128 v[184:187], v113 offset:608
  ds_read_b128 v[200:203], v113 offset:1120
  v_cmp_eq_u32 s[56:57], 0, v3
  v_cmp_gt_u32 s[58:59], 28, v2
  v_mov_b32 v204, 0x3f803f80
  v_cmp_eq_u32 vcc, 28, v2
  s_nop 1
  v_cndmask_b32 v204, 0, v204, vcc
  s_waitcnt lgkmcnt(12)
  s_waitcnt lgkmcnt(0)
  v_pk_fma_f32 v[40:41], v[188:189], v[124:125], v[40:41] op_sel_hi:[1,0,1]
  v_pk_fma_f32 v[42:43], v[190:191], v[124:125], v[42:43] op_sel_hi:[1,0,1]
  v_pk_fma_f32 v[44:45], v[192:193], v[124:125], v[44:45] op_sel_hi:[1,0,1]
  v_pk_fma_f32 v[46:47], v[194:195], v[124:125], v[46:47] op_sel_hi:[1,0,1]
  v_pk_fma_f32 v[48:49], v[196:197], v[124:125], v[48:49] op_sel_hi:[1,0,1]
  v_pk_fma_f32 v[50:51], v[198:199], v[124:125], v[50:51] op_sel_hi:[1,0,1]
  v_pk_fma_f32 v[52:53], v[200:201], v[124:125], v[52:53] op_sel_hi:[1,0,1]
  v_pk_fma_f32 v[54:55], v[202:203], v[124:125], v[54:55] op_sel_hi:[1,0,1]
  v_pk_mul_f32 v[40:41], v[40:41], v[172:173]
  v_pk_mul_f32 v[42:43], v[42:43], v[174:175]
  v_pk_mul_f32 v[44:45], v[44:45], v[176:177]
  v_pk_mul_f32 v[46:47], v[46:47], v[178:179]
  v_pk_mul_f32 v[48:49], v[48:49], v[180:181]
  v_pk_mul_f32 v[50:51], v[50:51], v[182:183]
  v_pk_mul_f32 v[52:53], v[52:53], v[184:185]
  v_pk_mul_f32 v[54:55], v[54:55], v[186:187]
  v_cvt_pk_bf16_f32 v208, v40, v41
  v_cvt_pk_bf16_f32 v209, v42, v43
  v_cvt_pk_bf16_f32 v210, v44, v45
  v_cvt_pk_bf16_f32 v211, v46, v47
  v_cvt_pk_bf16_f32 v212, v48, v49
  v_cvt_pk_bf16_f32 v213, v50, v51
  v_cvt_pk_bf16_f32 v214, v52, v53
  v_cvt_pk_bf16_f32 v215, v54, v55
  v_cndmask_b32 v208, v204, v208, s[58:59]
  v_cndmask_b32 v209, v204, v209, s[58:59]
  v_cndmask_b32 v210, v204, v210, s[58:59]
  v_cndmask_b32 v211, v204, v211, s[58:59]
  v_cndmask_b32 v212, v204, v212, s[58:59]
  v_cndmask_b32 v213, v204, v213, s[58:59]
  v_cndmask_b32 v214, v204, v214, s[58:59]
  v_cndmask_b32 v215, v204, v215, s[58:59]
  s_add_u32 s29, s49, 0x0
  buffer_store_dwordx2 v[208:209], v116, s[20:23], s29 offen offset:0 sc1
  buffer_store_dwordx2 v[210:211], v116, s[20:23], s29 offen offset:256 sc1
  buffer_store_dwordx2 v[212:213], v116, s[20:23], s29 offen offset:1024 sc1
  buffer_store_dwordx2 v[214:215], v116, s[20:23], s29 offen offset:1280 sc1
  v_pk_fma_f32 v[56:57], v[188:189], v[140:141], v[56:57] op_sel_hi:[1,0,1]
  v_pk_fma_f32 v[58:59], v[190:191], v[140:141], v[58:59] op_sel_hi:[1,0,1]
  v_pk_fma_f32 v[60:61], v[192:193], v[140:141], v[60:61] op_sel_hi:[1,0,1]
  v_pk_fma_f32 v[62:63], v[194:195], v[140:141], v[62:63] op_sel_hi:[1,0,1]
  v_pk_fma_f32 v[64:65], v[196:197], v[140:141], v[64:65] op_sel_hi:[1,0,1]
  v_pk_fma_f32 v[66:67], v[198:199], v[140:141], v[66:67] op_sel_hi:[1,0,1]
  v_pk_fma_f32 v[68:69], v[200:201], v[140:141], v[68:69] op_sel_hi:[1,0,1]
  v_pk_fma_f32 v[70:71], v[202:203], v[140:141], v[70:71] op_sel_hi:[1,0,1]
  v_pk_mul_f32 v[56:57], v[56:57], v[172:173]
  v_pk_mul_f32 v[58:59], v[58:59], v[174:175]
  v_pk_mul_f32 v[60:61], v[60:61], v[176:177]
  v_pk_mul_f32 v[62:63], v[62:63], v[178:179]
  v_pk_mul_f32 v[64:65], v[64:65], v[180:181]
  v_pk_mul_f32 v[66:67], v[66:67], v[182:183]
  v_pk_mul_f32 v[68:69], v[68:69], v[184:185]
  v_pk_mul_f32 v[70:71], v[70:71], v[186:187]
  v_cvt_pk_bf16_f32 v216, v56, v57
  v_cvt_pk_bf16_f32 v217, v58, v59
  v_cvt_pk_bf16_f32 v218, v60, v61
  v_cvt_pk_bf16_f32 v219, v62, v63
  v_cvt_pk_bf16_f32 v220, v64, v65
  v_cvt_pk_bf16_f32 v221, v66, v67
  v_cvt_pk_bf16_f32 v222, v68, v69
  v_cvt_pk_bf16_f32 v223, v70, v71
  v_cndmask_b32 v216, v204, v216, s[58:59]
  v_cndmask_b32 v217, v204, v217, s[58:59]
  v_cndmask_b32 v218, v204, v218, s[58:59]
  v_cndmask_b32 v219, v204, v219, s[58:59]
  v_cndmask_b32 v220, v204, v220, s[58:59]
  v_cndmask_b32 v221, v204, v221, s[58:59]
  v_cndmask_b32 v222, v204, v222, s[58:59]
  v_cndmask_b32 v223, v204, v223, s[58:59]
  s_add_u32 s29, s49, 0x20000
  buffer_store_dwordx2 v[216:217], v116, s[20:23], s29 offen offset:0 sc1
  buffer_store_dwordx2 v[218:219], v116, s[20:23], s29 offen offset:256 sc1
  buffer_store_dwordx2 v[220:221], v116, s[20:23], s29 offen offset:1024 sc1
  buffer_store_dwordx2 v[222:223], v116, s[20:23], s29 offen offset:1280 sc1
  v_pk_fma_f32 v[72:73], v[188:189], v[156:157], v[72:73] op_sel_hi:[1,0,1]
  v_pk_fma_f32 v[74:75], v[190:191], v[156:157], v[74:75] op_sel_hi:[1,0,1]
  v_pk_fma_f32 v[76:77], v[192:193], v[156:157], v[76:77] op_sel_hi:[1,0,1]
  v_pk_fma_f32 v[78:79], v[194:195], v[156:157], v[78:79] op_sel_hi:[1,0,1]
  v_pk_fma_f32 v[80:81], v[196:197], v[156:157], v[80:81] op_sel_hi:[1,0,1]
  v_pk_fma_f32 v[82:83], v[198:199], v[156:157], v[82:83] op_sel_hi:[1,0,1]
  v_pk_fma_f32 v[84:85], v[200:201], v[156:157], v[84:85] op_sel_hi:[1,0,1]
  v_pk_fma_f32 v[86:87], v[202:203], v[156:157], v[86:87] op_sel_hi:[1,0,1]
  v_pk_mul_f32 v[72:73], v[72:73], v[172:173]
  v_pk_mul_f32 v[74:75], v[74:75], v[174:175]
  v_pk_mul_f32 v[76:77], v[76:77], v[176:177]
  v_pk_mul_f32 v[78:79], v[78:79], v[178:179]
  v_pk_mul_f32 v[80:81], v[80:81], v[180:181]
  v_pk_mul_f32 v[82:83], v[82:83], v[182:183]
  v_pk_mul_f32 v[84:85], v[84:85], v[184:185]
  v_pk_mul_f32 v[86:87], v[86:87], v[186:187]
  v_cvt_pk_bf16_f32 v208, v72, v73
  v_cvt_pk_bf16_f32 v209, v74, v75
  v_cvt_pk_bf16_f32 v210, v76, v77
  v_cvt_pk_bf16_f32 v211, v78, v79
  v_cvt_pk_bf16_f32 v212, v80, v81
  v_cvt_pk_bf16_f32 v213, v82, v83
  v_cvt_pk_bf16_f32 v214, v84, v85
  v_cvt_pk_bf16_f32 v215, v86, v87
  v_cndmask_b32 v208, v204, v208, s[58:59]
  v_cndmask_b32 v209, v204, v209, s[58:59]
  v_cndmask_b32 v210, v204, v210, s[58:59]
  v_cndmask_b32 v211, v204, v211, s[58:59]
  v_cndmask_b32 v212, v204, v212, s[58:59]
  v_cndmask_b32 v213, v204, v213, s[58:59]
  v_cndmask_b32 v214, v204, v214, s[58:59]
  v_cndmask_b32 v215, v204, v215, s[58:59]
  s_add_u32 s29, s49, 0x40000
  buffer_store_dwordx2 v[208:209], v116, s[20:23], s29 offen offset:0 sc1
  buffer_store_dwordx2 v[210:211], v116, s[20:23], s29 offen offset:256 sc1
  buffer_store_dwordx2 v[212:213], v116, s[20:23], s29 offen offset:1024 sc1
  buffer_store_dwordx2 v[214:215], v116, s[20:23], s29 offen offset:1280 sc1
  s_endpgm
k1_qkv_kernel_done_1:
  s_endpgm
k1_qkv_kernel_end:
.globl k2_attn_kernel
.p2align 8
.type k2_attn_kernel,@function
k2_attn_kernel:
  s_cmp_ge_u32 s2, 256
  s_cbranch_scc1 k2_attn_kernel_done_1
  s_load_dwordx2 s[4:5], s[0:1], 80
  s_load_dwordx2 s[6:7], s[0:1], 16
  s_load_dwordx2 s[8:9], s[0:1], 32
  v_lshrrev_b32 v2, 6, v0
  v_and_b32 v1, 63, v0
  v_readfirstlane_b32 s24, v2
  s_and_b32 s27, s2, 7
  s_lshr_b32 s28, s2, 3
  s_and_b32 s26, s28, 7
  s_lshr_b32 s28, s28, 3
  s_lshr_b32 s25, s27, 1
  s_lshl_b32 s25, s25, 2
  s_add_u32 s25, s25, s28
  s_and_b32 s27, s27, 1
  s_lshl_b32 s27, s27, 3
  s_add_u32 s26, s26, s27
  v_lshlrev_b32 v6, 4, v1
  s_lshl_b32 s30, s26, 17
  s_lshl_b32 s27, s25, 13
  s_add_u32 s30, s30, s27
  s_mul_i32 s31, s24, 3072
  s_lshl_b32 s32, s25, 3
  s_add_u32 s32, s32, s24
  s_waitcnt lgkmcnt(0)
  s_mov_b32 s12, s4
  s_and_b32 s13, s5, 0xffff
  s_mov_b32 s14, 0x10000000
  s_mov_b32 s15, 0x20000
  s_mov_b32 s16, s6
  s_and_b32 s17, s7, 0xffff
  s_mov_b32 s18, 0x62000
  s_mov_b32 s19, 0x20000
  s_mov_b32 s20, s8
  s_and_b32 s21, s9, 0xffff
  s_mov_b32 s22, 0x188000
  s_mov_b32 s23, 0x20000
  s_lshl_b32 s27, s24, 10
  s_add_u32 s27, s27, s30
  s_add_u32 s29, s27, 0x0
  buffer_load_dwordx4 v[8:11], v6, s[12:15], s29 offen
  s_add_u32 s28, s30, s31
  s_add_u32 s29, s28, 0x1fc000
  s_add_u32 m0, s31, 0x0
  s_nop 0
  buffer_load_dwordx4 v6, s[12:15], s29 offen lds
  s_add_u32 s29, s28, 0x1fc400
  s_add_u32 m0, s31, 0x400
  s_nop 0
  buffer_load_dwordx4 v6, s[12:15], s29 offen lds
  s_add_u32 s29, s28, 0x1fc800
  s_add_u32 m0, s31, 0x800
  s_nop 0
  buffer_load_dwordx4 v6, s[12:15], s29 offen lds
  s_add_u32 s29, s28, 0x3fc000
  s_add_u32 m0, s31, 0x6000
  s_nop 0
  buffer_load_dwordx4 v6, s[12:15], s29 offen lds
  s_add_u32 s29, s28, 0x3fc400
  s_add_u32 m0, s31, 0x6400
  s_nop 0
  buffer_load_dwordx4 v6, s[12:15], s29 offen lds
  s_add_u32 s29, s28, 0x3fc800
  s_add_u32 m0, s31, 0x6800
  s_nop 0
  buffer_load_dwordx4 v6, s[12:15], s29 offen lds
  s_lshr_b32 s33, s2, 3
  s_getpc_b64 s[34:35]
k2_attn_kernel_pc_2:
  s_add_u32 s34, s34, k3_wo_kernel-k2_attn_kernel_pc_2
  s_addc_u32 s35, s35, 0
  s_mov_b32 s36, s34
  s_and_b32 s37, s35, 0xffff
  s_mov_b32 s38, k3_wo_kernel_end-k3_wo_kernel
  s_mov_b32 s39, 0x20000
  s_lshl_b32 s27, s33, 8
  v_add_u32 v12, s27, v0
  v_lshlrev_b32 v12, 7, v12
  buffer_load_dword v13, v12, s[36:39], 0 offen
  v_and_b32 v4, 15, v1
  v_lshrrev_b32 v5, 4, v1
  v_lshlrev_b32 v2, 2, v5
  v_add_u32 v3, 0, v2
  v_cmp_gt_u32 s[40:41], v3, v4
  v_add_u32 v3, 1, v2
  v_cmp_gt_u32 s[42:43], v3, v4
  v_add_u32 v3, 2, v2
  v_cmp_gt_u32 s[44:45], v3, v4
  v_add_u32 v3, 3, v2
  v_cmp_gt_u32 s[46:47], v3, v4
  s_lshl_b32 s27, s24, 10
  v_add_u32 v14, s27, v6
  v_lshlrev_b32 v15, 3, v1
  s_add_u32 s27, s27, 24576
  v_add_u32 v15, s27, v15
  v_mov_b32 v108, 0xf149f2ca
  s_waitcnt vmcnt(4)
  s_barrier
  ds_read_b128 v[84:87], v14 offset:0
  ds_read_b128 v[88:91], v14 offset:1024
  ds_read_b128 v[92:95], v14 offset:2048
  ds_read_b128 v[96:99], v14 offset:3072
  ds_read_b128 v[100:103], v14 offset:4096
  ds_read_b128 v[104:107], v14 offset:5120
  s_waitcnt lgkmcnt(5)
  v_mfma_f32_16x16x32_bf16 v[16:19], v[84:87], v[8:11], 0
  ds_read_b128 v[84:87], v14 offset:6144
  s_waitcnt lgkmcnt(5)
  v_mfma_f32_16x16x32_bf16 v[20:23], v[88:91], v[8:11], 0
  ds_read_b128 v[88:91], v14 offset:7168
  s_waitcnt lgkmcnt(5)
  v_mfma_f32_16x16x32_bf16 v[24:27], v[92:95], v[8:11], 0
  ds_read_b128 v[92:95], v14 offset:8192
  s_waitcnt lgkmcnt(5)
  v_mfma_f32_16x16x32_bf16 v[28:31], v[96:99], v[8:11], 0
  ds_read_b128 v[96:99], v14 offset:9216
  s_waitcnt lgkmcnt(5)
  v_mfma_f32_16x16x32_bf16 v[32:35], v[100:103], v[8:11], 0
  ds_read_b128 v[100:103], v14 offset:10240
  s_waitcnt lgkmcnt(5)
  v_mfma_f32_16x16x32_bf16 v[36:39], v[104:107], v[8:11], 0
  ds_read_b128 v[104:107], v14 offset:11264
  s_waitcnt lgkmcnt(5)
  v_mfma_f32_16x16x32_bf16 v[40:43], v[84:87], v[8:11], 0
  ds_read_b128 v[84:87], v14 offset:12288
  s_waitcnt lgkmcnt(5)
  v_mfma_f32_16x16x32_bf16 v[44:47], v[88:91], v[8:11], 0
  ds_read_b128 v[88:91], v14 offset:13312
  s_waitcnt lgkmcnt(5)
  v_mfma_f32_16x16x32_bf16 v[48:51], v[92:95], v[8:11], 0
  ds_read_b128 v[92:95], v14 offset:14336
  s_waitcnt lgkmcnt(5)
  v_mfma_f32_16x16x32_bf16 v[52:55], v[96:99], v[8:11], 0
  ds_read_b128 v[96:99], v14 offset:15360
  s_waitcnt lgkmcnt(5)
  v_mfma_f32_16x16x32_bf16 v[56:59], v[100:103], v[8:11], 0
  ds_read_b128 v[100:103], v14 offset:16384
  s_waitcnt lgkmcnt(5)
  v_mfma_f32_16x16x32_bf16 v[60:63], v[104:107], v[8:11], 0
  s_waitcnt lgkmcnt(4)
  v_mfma_f32_16x16x32_bf16 v[64:67], v[84:87], v[8:11], 0
  s_waitcnt lgkmcnt(3)
  v_mfma_f32_16x16x32_bf16 v[68:71], v[88:91], v[8:11], 0
  s_waitcnt lgkmcnt(2)
  v_mfma_f32_16x16x32_bf16 v[72:75], v[92:95], v[8:11], 0
  s_waitcnt lgkmcnt(1)
  v_mfma_f32_16x16x32_bf16 v[76:79], v[96:99], v[8:11], 0
  s_waitcnt lgkmcnt(0)
  v_mfma_f32_16x16x32_bf16 v[80:83], v[100:103], v[8:11], 0
  s_lshl_b32 s27, s33, 3
  s_add_u32 s27, s27, s24
  s_mul_i32 s28, s27, 1664
  v_lshlrev_b32 v2, 7, v1
  v_mov_b32 v3, 0x7fffff00
  v_cmp_gt_u32 vcc, 13, v1
  s_nop 1
  v_cndmask_b32 v2, v3, v2, vcc
  buffer_load_dword v110, v2, s[16:19], s28 offen
  s_mul_i32 s28, s27, 25
  v_add_u32 v2, s28, v1
  v_mul_u32_u24 v3, 37450, v2
  v_lshrrev_b32 v3, 19, v3
  v_mul_u32_u24 v111, 14, v3
  v_sub_u32 v2, v2, v111
  v_mul_u32_u24 v3, 3584, v3
  v_lshl_add_u32 v3, v2, 7, v3
  v_add_u32 v111, 896, v3
  v_cmp_le_u32 vcc, 7, v2
  s_nop 1
  v_cndmask_b32 v3, v3, v111, vcc
  v_mov_b32 v2, 0x7fffff00
  v_cmp_gt_u32 vcc, 25, v1
  s_nop 1
  v_cndmask_b32 v3, v2, v3, vcc
  s_and_b32 s28, s2, 1
  s_mul_i32 s28, s28, 896
  buffer_load_dword v111, v3, s[20:23], s28 offen
  v_cndmask_b32 v16, v108, v16, s[40:41]
  v_cndmask_b32 v80, v80, v108, s[40:41]
  v_cndmask_b32 v17, v108, v17, s[42:43]
  v_cndmask_b32 v81, v81, v108, s[42:43]
  v_cndmask_b32 v18, v108, v18, s[44:45]
  v_cndmask_b32 v82, v82, v108, s[44:45]
  v_cndmask_b32 v19, v108, v19, s[46:47]
  v_cndmask_b32 v83, v83, v108, s[46:47]
  s_cmp_ge_u32 s32, 16
  s_cbranch_scc1 k2_attn_kernel_nofix_3
  s_sub_u32 s27, 16, s32
  s_cmp_le_u32 s27, 0
  s_cbranch_scc1 k2_attn_kernel_sk_4
  v_mov_b32 v16, v108
  v_mov_b32 v17, v108
  v_mov_b32 v18, v108
  v_mov_b32 v19, v108
k2_attn_kernel_sk_4:
  s_cmp_le_u32 s27, 1
  s_cbranch_scc1 k2_attn_kernel_sk_5
  v_mov_b32 v20, v108
  v_mov_b32 v21, v108
  v_mov_b32 v22, v108
  v_mov_b32 v23, v108
k2_attn_kernel_sk_5:
  s_cmp_le_u32 s27, 2
  s_cbranch_scc1 k2_attn_kernel_sk_6
  v_mov_b32 v24, v108
  v_mov_b32 v25, v108
  v_mov_b32 v26, v108
  v_mov_b32 v27, v108
k2_attn_kernel_sk_6:
  s_cmp_le_u32 s27, 3
  s_cbranch_scc1 k2_attn_kernel_sk_7
  v_mov_b32 v28, v108
  v_mov_b32 v29, v108
  v_mov_b32 v30, v108
  v_mov_b32 v31, v108
k2_attn_kernel_sk_7:
  s_cmp_le_u32 s27, 4
  s_cbranch_scc1 k2_attn_kernel_sk_8
  v_mov_b32 v32, v108
  v_mov_b32 v33, v108
  v_mov_b32 v34, v108
  v_mov_b32 v35, v108
k2_attn_kernel_sk_8:
  s_cmp_le_u32 s27, 5
  s_cbranch_scc1 k2_attn_kernel_sk_9
  v_mov_b32 v36, v108
  v_mov_b32 v37, v108
  v_mov_b32 v38, v108
  v_mov_b32 v39, v108
k2_attn_kernel_sk_9:
  s_cmp_le_u32 s27, 6
  s_cbranch_scc1 k2_attn_kernel_sk_10
  v_mov_b32 v40, v108
  v_mov_b32 v41, v108
  v_mov_b32 v42, v108
  v_mov_b32 v43, v108
k2_attn_kernel_sk_10:
  s_cmp_le_u32 s27, 7
  s_cbranch_scc1 k2_attn_kernel_sk_11
  v_mov_b32 v44, v108
  v_mov_b32 v45, v108
  v_mov_b32 v46, v108
  v_mov_b32 v47, v108
k2_attn_kernel_sk_11:
  s_cmp_le_u32 s27, 8
  s_cbranch_scc1 k2_attn_kernel_sk_12
  v_mov_b32 v48, v108
  v_mov_b32 v49, v108
  v_mov_b32 v50, v108
  v_mov_b32 v51, v108
k2_attn_kernel_sk_12:
  s_cmp_le_u32 s27, 9
  s_cbranch_scc1 k2_attn_kernel_sk_13
  v_mov_b32 v52, v108
  v_mov_b32 v53, v108
  v_mov_b32 v54, v108
  v_mov_b32 v55, v108
k2_attn_kernel_sk_13:
  s_cmp_le_u32 s27, 10
  s_cbranch_scc1 k2_attn_kernel_sk_14
  v_mov_b32 v56, v108
  v_mov_b32 v57, v108
  v_mov_b32 v58, v108
  v_mov_b32 v59, v108
k2_attn_kernel_sk_14:
  s_cmp_le_u32 s27, 11
  s_cbranch_scc1 k2_attn_kernel_sk_15
  v_mov_b32 v60, v108
  v_mov_b32 v61, v108
  v_mov_b32 v62, v108
  v_mov_b32 v63, v108
k2_attn_kernel_sk_15:
  s_cmp_le_u32 s27, 12
  s_cbranch_scc1 k2_attn_kernel_sk_16
  v_mov_b32 v64, v108
  v_mov_b32 v65, v108
  v_mov_b32 v66, v108
  v_mov_b32 v67, v108
k2_attn_kernel_sk_16:
  s_cmp_le_u32 s27, 13
  s_cbranch_scc1 k2_attn_kernel_sk_17
  v_mov_b32 v68, v108
  v_mov_b32 v69, v108
  v_mov_b32 v70, v108
  v_mov_b32 v71, v108
k2_attn_kernel_sk_17:
  s_cmp_le_u32 s27, 14
  s_cbranch_scc1 k2_attn_kernel_sk_18
  v_mov_b32 v72, v108
  v_mov_b32 v73, v108
  v_mov_b32 v74, v108
  v_mov_b32 v75, v108
k2_attn_kernel_sk_18:
  s_cmp_le_u32 s27, 15
  s_cbranch_scc1 k2_attn_kernel_sk_19
  v_mov_b32 v76, v108
  v_mov_b32 v77, v108
  v_mov_b32 v78, v108
  v_mov_b32 v79, v108
k2_attn_kernel_sk_19:
k2_attn_kernel_nofix_3:
  v_max3_f32 v184, v16, v17, v18
  v_max3_f32 v185, v33, v34, v35
  v_max3_f32 v186, v50, v51, v52
  v_max3_f32 v187, v67, v68, v69
  v_max3_f32 v184, v184, v19, v20
  v_max3_f32 v185, v185, v36, v37
  v_max3_f32 v186, v186, v53, v54
  v_max3_f32 v187, v187, v70, v71
  v_max3_f32 v184, v184, v21, v22
  v_max3_f32 v185, v185, v38, v39
  v_max3_f32 v186, v186, v55, v56
  v_max3_f32 v187, v187, v72, v73
  v_max3_f32 v184, v184, v23, v24
  v_max3_f32 v185, v185, v40, v41
  v_max3_f32 v186, v186, v57, v58
  v_max3_f32 v187, v187, v74, v75
  v_max3_f32 v184, v184, v25, v26
  v_max3_f32 v185, v185, v42, v43
  v_max3_f32 v186, v186, v59, v60
  v_max3_f32 v187, v187, v76, v77
  v_max3_f32 v184, v184, v27, v28
  v_max3_f32 v185, v185, v44, v45
  v_max3_f32 v186, v186, v61, v62
  v_max3_f32 v187, v187, v78, v79
  v_max3_f32 v184, v184, v29, v30
  v_max3_f32 v185, v185, v46, v47
  v_max3_f32 v186, v186, v63, v64
  v_max3_f32 v187, v187, v80, v81
  v_max3_f32 v184, v184, v31, v32
  v_max3_f32 v185, v185, v48, v49
  v_max3_f32 v186, v186, v65, v66
  v_max3_f32 v187, v187, v82, v83
  v_max3_f32 v184, v184, v185, v186
  v_max_f32 v184, v184, v187
  v_mov_b32 v185, v184
  s_nop 1
  v_permlane16_swap_b32 v184, v185
  v_max_f32 v184, v184, v185
  v_mov_b32 v185, v184
  s_nop 1
  v_permlane32_swap_b32 v184, v185
  v_max_f32 v184, v184, v185
  s_mov_b32 s48, 0x3e8b97f6
  v_mul_f32 v184, 0xbe8b97f6, v184
  s_waitcnt vmcnt(3)
  s_barrier
  ds_read_b64 v[112:113], v15 offset:0
  ds_read_b64 v[114:115], v15 offset:1024
  ds_read_b64 v[116:117], v15 offset:512
  ds_read_b64 v[118:119], v15 offset:1536
  ds_read_b64 v[120:121], v15 offset:2048
  ds_read_b64 v[122:123], v15 offset:3072
  ds_read_b64 v[124:125], v15 offset:2560
  ds_read_b64 v[126:127], v15 offset:3584
  ds_read_b64 v[128:129], v15 offset:4096
  ds_read_b64 v[130:131], v15 offset:5120
  ds_read_b64 v[132:133], v15 offset:4608
  ds_read_b64 v[134:135], v15 offset:5632
  ds_read_b64 v[136:137], v15 offset:6144
  ds_read_b64 v[138:139], v15 offset:7168
  ds_read_b64 v[140:141], v15 offset:6656
  ds_read_b64 v[142:143], v15 offset:7680
  v_mov_b32 v222, 0
  v_mov_b32 v223, 0
  v_fma_f32 v16, v16, s48, v184
  v_fma_f32 v17, v17, s48, v184
  v_fma_f32 v18, v18, s48, v184
  v_fma_f32 v19, v19, s48, v184
  v_exp_f32 v16, v16
  v_exp_f32 v17, v17
  v_exp_f32 v18, v18
  v_exp_f32 v19, v19
  v_fma_f32 v20, v20, s48, v184
  v_fma_f32 v21, v21, s48, v184
  v_fma_f32 v22, v22, s48, v184
  v_fma_f32 v23, v23, s48, v184
  v_exp_f32 v20, v20
  v_exp_f32 v21, v21
  v_exp_f32 v22, v22
  v_exp_f32 v23, v23
  v_cvt_pk_bf16_f32 v188, v16, v17
  v_cvt_pk_bf16_f32 v189, v18, v19
  v_cvt_pk_bf16_f32 v190, v20, v21
  v_cvt_pk_bf16_f32 v191, v22, v23
  v_fma_f32 v24, v24, s48, v184
  v_fma_f32 v25, v25, s48, v184
  v_fma_f32 v26, v26, s48, v184
  v_fma_f32 v27, v27, s48, v184
  v_exp_f32 v24, v24
  v_exp_f32 v25, v25
  v_exp_f32 v26, v26
  v_exp_f32 v27, v27
  v_fma_f32 v28, v28, s48, v184
  v_fma_f32 v29, v29, s48, v184
  v_fma_f32 v30, v30, s48, v184
  v_fma_f32 v31, v31, s48, v184
  v_exp_f32 v28, v28
  v_exp_f32 v29, v29
  v_exp_f32 v30, v30
  v_exp_f32 v31, v31
  v_cvt_pk_bf16_f32 v192, v24, v25
  v_cvt_pk_bf16_f32 v193, v26, v27
  v_cvt_pk_bf16_f32 v194, v28, v29
  v_cvt_pk_bf16_f32 v195, v30, v31
  ds_read_b64 v[144:145], v15 offset:8192
  ds_read_b64 v[146:147], v15 offset:9216
  ds_read_b64 v[148:149], v15 offset:8704
  ds_read_b64 v[150:151], v15 offset:9728
  ds_read_b64 v[152:153], v15 offset:10240
  ds_read_b64 v[154:155], v15 offset:11264
  ds_read_b64 v[156:157], v15 offset:10752
  ds_read_b64 v[158:159], v15 offset:11776
  ds_read_b64 v[160:161], v15 offset:12288
  ds_read_b64 v[162:163], v15 offset:13312
  ds_read_b64 v[164:165], v15 offset:12800
  ds_read_b64 v[166:167], v15 offset:13824
  s_waitcnt lgkmcnt(15)
  v_mfma_f32_16x16x32_bf16 v[224:227], v[112:115], v[188:191], 0
  v_mfma_f32_16x16x32_bf16 v[228:231], v[116:119], v[188:191], 0
  v_fma_f32 v32, v32, s48, v184
  v_fma_f32 v33, v33, s48, v184
  v_fma_f32 v34, v34, s48, v184
  v_fma_f32 v35, v35, s48, v184
  v_exp_f32 v32, v32
  v_exp_f32 v33, v33
  v_exp_f32 v34, v34
  v_exp_f32 v35, v35
  v_fma_f32 v36, v36, s48, v184
  v_fma_f32 v37, v37, s48, v184
  v_fma_f32 v38, v38, s48, v184
  v_fma_f32 v39, v39, s48, v184
  v_exp_f32 v36, v36
  v_exp_f32 v37, v37
  v_exp_f32 v38, v38
  v_exp_f32 v39, v39
  v_cvt_pk_bf16_f32 v196, v32, v33
  v_cvt_pk_bf16_f32 v197, v34, v35
  v_cvt_pk_bf16_f32 v198, v36, v37
  v_cvt_pk_bf16_f32 v199, v38, v39
  s_waitcnt lgkmcnt(15)
  v_mfma_f32_16x16x32_bf16 v[224:227], v[120:123], v[192:195], v[224:227]
  v_mfma_f32_16x16x32_bf16 v[228:231], v[124:127], v[192:195], v[228:231]
  v_fma_f32 v40, v40, s48, v184
  v_fma_f32 v41, v41, s48, v184
  v_fma_f32 v42, v42, s48, v184
  v_fma_f32 v43, v43, s48, v184
  v_exp_f32 v40, v40
  v_exp_f32 v41, v41
  v_exp_f32 v42, v42
  v_exp_f32 v43, v43
  v_fma_f32 v44, v44, s48, v184
  v_fma_f32 v45, v45, s48, v184
  v_fma_f32 v46, v46, s48, v184
  v_fma_f32 v47, v47, s48, v184
  v_exp_f32 v44, v44
  v_exp_f32 v45, v45
  v_exp_f32 v46, v46
  v_exp_f32 v47, v47
  v_cvt_pk_bf16_f32 v200, v40, v41
  v_cvt_pk_bf16_f32 v201, v42, v43
  v_cvt_pk_bf16_f32 v202, v44, v45
  v_cvt_pk_bf16_f32 v203, v46, v47
  s_waitcnt lgkmcnt(15)
  v_mfma_f32_16x16x32_bf16 v[224:227], v[128:131], v[196:199], v[224:227]
  v_mfma_f32_16x16x32_bf16 v[228:231], v[132:135], v[196:199], v[228:231]
  v_fma_f32 v48, v48, s48, v184
  v_fma_f32 v49, v49, s48, v184
  v_fma_f32 v50, v50, s48, v184
  v_fma_f32 v51, v51, s48, v184
  v_exp_f32 v48, v48
  v_exp_f32 v49, v49
  v_exp_f32 v50, v50
  v_exp_f32 v51, v51
  v_fma_f32 v52, v52, s48, v184
  v_fma_f32 v53, v53, s48, v184
  v_fma_f32 v54, v54, s48, v184
  v_fma_f32 v55, v55, s48, v184
  v_exp_f32 v52, v52
  v_exp_f32 v53, v53
  v_exp_f32 v54, v54
  v_exp_f32 v55, v55
  v_cvt_pk_bf16_f32 v204, v48, v49
  v_cvt_pk_bf16_f32 v205, v50, v51
  v_cvt_pk_bf16_f32 v206, v52, v53
  v_cvt_pk_bf16_f32 v207, v54, v55
  ds_read_b64 v[168:169], v15 offset:14336
  ds_read_b64 v[170:171], v15 offset:15360
  ds_read_b64 v[172:173], v15 offset:14848
  ds_read_b64 v[174:175], v15 offset:15872
  ds_read_b64 v[176:177], v15 offset:16384
  ds_read_b64 v[178:179], v15 offset:16384
  ds_read_b64 v[180:181], v15 offset:16896
  ds_read_b64 v[182:183], v15 offset:16896
  s_waitcnt lgkmcnt(15)
  v_mfma_f32_16x16x32_bf16 v[224:227], v[136:139], v[200:203], v[224:227]
  v_mfma_f32_16x16x32_bf16 v[228:231], v[140:143], v[200:203], v[228:231]
  v_fma_f32 v56, v56, s48, v184
  v_fma_f32 v57, v57, s48, v184
  v_fma_f32 v58, v58, s48, v184
  v_fma_f32 v59, v59, s48, v184
  v_exp_f32 v56, v56
  v_exp_f32 v57, v57
  v_exp_f32 v58, v58
  v_exp_f32 v59, v59
  v_fma_f32 v60, v60, s48, v184
  v_fma_f32 v61, v61, s48, v184
  v_fma_f32 v62, v62, s48, v184
  v_fma_f32 v63, v63, s48, v184
  v_exp_f32 v60, v60
  v_exp_f32 v61, v61
  v_exp_f32 v62, v62
  v_exp_f32 v63, v63
  v_cvt_pk_bf16_f32 v208, v56, v57
  v_cvt_pk_bf16_f32 v209, v58, v59
  v_cvt_pk_bf16_f32 v210, v60, v61
  v_cvt_pk_bf16_f32 v211, v62, v63
  s_waitcnt lgkmcnt(15)
  v_mfma_f32_16x16x32_bf16 v[224:227], v[144:147], v[204:207], v[224:227]
  v_mfma_f32_16x16x32_bf16 v[228:231], v[148:151], v[204:207], v[228:231]
  v_fma_f32 v64, v64, s48, v184
  v_fma_f32 v65, v65, s48, v184
  v_fma_f32 v66, v66, s48, v184
  v_fma_f32 v67, v67, s48, v184
  v_exp_f32 v64, v64
  v_exp_f32 v65, v65
  v_exp_f32 v66, v66
  v_exp_f32 v67, v67
  v_fma_f32 v68, v68, s48, v184
  v_fma_f32 v69, v69, s48, v184
  v_fma_f32 v70, v70, s48, v184
  v_fma_f32 v71, v71, s48, v184
  v_exp_f32 v68, v68
  v_exp_f32 v69, v69
  v_exp_f32 v70, v70
  v_exp_f32 v71, v71
  v_cvt_pk_bf16_f32 v212, v64, v65
  v_cvt_pk_bf16_f32 v213, v66, v67
  v_cvt_pk_bf16_f32 v214, v68, v69
  v_cvt_pk_bf16_f32 v215, v70, v71
  s_waitcnt lgkmcnt(12)
  v_mfma_f32_16x16x32_bf16 v[224:227], v[152:155], v[208:211], v[224:227]
  v_mfma_f32_16x16x32_bf16 v[228:231], v[156:159], v[208:211], v[228:231]
  v_fma_f32 v72, v72, s48, v184
  v_fma_f32 v73, v73, s48, v184
  v_fma_f32 v74, v74, s48, v184
  v_fma_f32 v75, v75, s48, v184
  v_exp_f32 v72, v72
  v_exp_f32 v73, v73
  v_exp_f32 v74, v74
  v_exp_f32 v75, v75
  v_fma_f32 v76, v76, s48, v184
  v_fma_f32 v77, v77, s48, v184
  v_fma_f32 v78, v78, s48, v184
  v_fma_f32 v79, v79, s48, v184
  v_exp_f32 v76, v76
  v_exp_f32 v77, v77
  v_exp_f32 v78, v78
  v_exp_f32 v79, v79
  v_cvt_pk_bf16_f32 v216, v72, v73
  v_cvt_pk_bf16_f32 v217, v74, v75
  v_cvt_pk_bf16_f32 v218, v76, v77
  v_cvt_pk_bf16_f32 v219, v78, v79
  s_waitcnt lgkmcnt(8)
  v_mfma_f32_16x16x32_bf16 v[224:227], v[160:163], v[212:215], v[224:227]
  v_mfma_f32_16x16x32_bf16 v[228:231], v[164:167], v[212:215], v[228:231]
  v_fma_f32 v80, v80, s48, v184
  v_fma_f32 v81, v81, s48, v184
  v_fma_f32 v82, v82, s48, v184
  v_fma_f32 v83, v83, s48, v184
  v_exp_f32 v80, v80
  v_exp_f32 v81, v81
  v_exp_f32 v82, v82
  v_exp_f32 v83, v83
  v_cvt_pk_bf16_f32 v220, v80, v81
  v_cvt_pk_bf16_f32 v221, v82, v83
  s_waitcnt lgkmcnt(4)
  v_mfma_f32_16x16x32_bf16 v[224:227], v[168:171], v[216:219], v[224:227]
  v_mfma_f32_16x16x32_bf16 v[228:231], v[172:175], v[216:219], v[228:231]
  s_waitcnt lgkmcnt(0)
  v_mfma_f32_16x16x32_bf16 v[224:227], v[176:179], v[220:223], v[224:227]
  v_mfma_f32_16x16x32_bf16 v[228:231], v[180:183], v[220:223], v[228:231]
  s_nop 7
  v_mov_b32 v232, v228
  v_mov_b32 v233, v228
  s_nop 1
  v_permlane32_swap_b32 v232, v233
  v_mov_b32 v232, v233
  s_nop 1
  v_permlane16_swap_b32 v232, v233
  v_rcp_f32 v233, v233
  s_nop 0
  v_mul_f32 v224, v224, v233
  v_mul_f32 v225, v225, v233
  v_mul_f32 v226, v226, v233
  v_mul_f32 v227, v227, v233
  v_mul_f32 v228, v228, v233
  v_mul_f32 v229, v229, v233
  v_mul_f32 v230, v230, v233
  v_mul_f32 v231, v231, v233
  v_cvt_pk_bf16_f32 v236, v224, v225
  v_cvt_pk_bf16_f32 v237, v226, v227
  v_cvt_pk_bf16_f32 v238, v228, v229
  v_cvt_pk_bf16_f32 v239, v230, v231
  v_cmp_gt_u32 vcc, 3, v5
  s_nop 1
  v_cndmask_b32 v238, 0, v238, vcc
  v_cndmask_b32 v239, 0, v239, vcc
  s_and_b32 s27, s24, 1
  s_lshl_b32 s27, s27, 8
  v_lshlrev_b32 v240, 4, v4
  v_add_u32 v240, s27, v240
  v_lshrrev_b32 v2, 1, v5
  v_lshl_add_u32 v240, v2, 9, v240
  v_and_b32 v2, 1, v5
  v_lshl_add_u32 v240, v2, 3, v240
  s_lshl_b32 s27, s25, 2
  s_lshr_b32 s28, s24, 1
  s_add_u32 s27, s27, s28
  s_lshl_b32 s27, s27, 15
  s_lshl_b32 s28, s26, 11
  s_add_u32 s27, s27, s28
  s_add_u32 s29, s27, 0x600000
  buffer_store_dwordx2 v[236:237], v240, s[12:15], s29 offen offset:0 sc1
  buffer_store_dwordx2 v[238:239], v240, s[12:15], s29 offen offset:1024 sc1
k2_attn_kernel_done_1:
  s_endpgm
k2_attn_kernel_end:
.globl k3_wo_kernel
.p2align 8
.type k3_wo_kernel,@function
k3_wo_kernel:
  s_cmp_ge_u32 s2, 256
  s_cbranch_scc1 k3_wo_kernel_done_1
  v_lshrrev_b32 v2, 6, v0
  v_and_b32 v1, 63, v0
  v_readfirstlane_b32 s4, v2
  s_load_dwordx2 s[8:9], s[0:1], 0
  s_load_dwordx2 s[10:11], s[0:1], 16
  s_load_dwordx2 s[12:13], s[0:1], 32
  s_load_dwordx2 s[14:15], s[0:1], 80
  s_and_b32 s28, s2, 7
  s_lshr_b32 s29, s2, 3
  s_and_b32 s32, s4, 3
  s_cmp_ge_u32 s29, 28
  s_cbranch_scc1 k3_wo_kernel_aux_2
  s_mul_i32 s5, s29, 37
  s_lshr_b32 s5, s5, 8
  s_mul_i32 s6, s5, 7
  s_sub_u32 s31, s29, s6
  s_lshl_b32 s30, s28, 2
  s_add_u32 s30, s30, s5
  s_cmp_lt_u32 s4, 4
  s_cbranch_scc1 k3_wo_kernel_compute_3
  v_lshlrev_b32 v5, 4, v1
  v_lshrrev_b32 v2, 3, v1
  v_mul_u32_u24 v2, 896, v2
  v_bfe_u32 v3, v1, 4, 1
  v_lshlrev_b32 v3, 2, v3
  v_and_b32 v4, 7, v1
  v_xor_b32 v3, v3, v4
  v_lshl_add_u32 v6, v3, 4, v2
  s_lshl_b32 s33, s30, 16
  s_lshl_b32 s5, s32, 10
  s_add_u32 s33, s33, s5
  s_add_u32 s33, s33, 0x600000
  s_add_u32 s35, s5, 58368
  s_mul_i32 s34, s32, 7168
  s_lshl_b32 s6, s31, 7
  s_add_u32 s34, s34, s6
  s_add_u32 s36, s5, 0
  s_waitcnt lgkmcnt(0)
  s_mov_b32 s16, s14
  s_and_b32 s17, s15, 0xffff
  s_mov_b32 s18, 0x10000000
  s_mov_b32 s19, 0x20000
  s_mov_b32 s20, s10
  s_and_b32 s21, s11, 0xffff
  s_mov_b32 s22, 0x62000
  s_mov_b32 s23, 0x20000
  v_lshrrev_b32 v2, 3, v1
  v_and_b32 v3, 7, v1
  v_xor_b32 v3, v3, v2
  v_mul_u32_u24 v2, 896, v2
  v_lshl_add_u32 v7, v3, 4, v2
  s_lshl_b32 s5, s30, 6
  s_lshl_b32 s6, s32, 4
  s_add_u32 s5, s5, s6
  s_mul_i32 s37, s5, 896
  s_lshl_b32 s6, s31, 7
  s_add_u32 s37, s37, s6
  s_lshl_b32 s38, s32, 11
  s_add_u32 s38, s38, 123904
  s_mov_b32 s24, s8
  s_and_b32 s25, s9, 0xffff
  s_mov_b32 s26, 0x1c0000
  s_mov_b32 s27, 0x20000
  s_add_u32 s7, s33, 0x0
  s_add_u32 m0, s35, 0x0
  s_nop 0
  buffer_load_dwordx4 v5, s[16:19], s7 offen lds
  s_add_u32 s7, s33, 0x8000
  s_add_u32 m0, s35, 0x8000
  s_nop 0
  buffer_load_dwordx4 v5, s[16:19], s7 offen lds
  s_add_u32 s7, s34, 0x0
  s_add_u32 m0, s36, 0x0
  s_nop 0
  buffer_load_dwordx4 v6, s[20:23], s7 offen lds
  s_add_u32 s7, s34, 0x7000
  s_add_u32 m0, s36, 0x1000
  s_nop 0
  buffer_load_dwordx4 v6, s[20:23], s7 offen lds
  s_add_u32 s7, s33, 0x1000
  s_add_u32 m0, s35, 0x1000
  s_nop 0
  buffer_load_dwordx4 v5, s[16:19], s7 offen lds
  s_add_u32 s7, s33, 0x9000
  s_add_u32 m0, s35, 0x9000
  s_nop 0
  buffer_load_dwordx4 v5, s[16:19], s7 offen lds
  s_add_u32 s7, s34, 0xc400
  s_add_u32 m0, s36, 0x1c00
  s_nop 0
  buffer_load_dwordx4 v6, s[20:23], s7 offen lds
  s_add_u32 s7, s34, 0x13400
  s_add_u32 m0, s36, 0x2c00
  s_nop 0
  buffer_load_dwordx4 v6, s[20:23], s7 offen lds
  s_add_u32 s7, s33, 0x2000
  s_add_u32 m0, s35, 0x2000
  s_nop 0
  buffer_load_dwordx4 v5, s[16:19], s7 offen lds
  s_add_u32 s7, s33, 0xa000
  s_add_u32 m0, s35, 0xa000
  s_nop 0
  buffer_load_dwordx4 v5, s[16:19], s7 offen lds
  s_add_u32 s7, s34, 0x18800
  s_add_u32 m0, s36, 0x3800
  s_nop 0
  buffer_load_dwordx4 v6, s[20:23], s7 offen lds
  s_add_u32 s7, s34, 0x1f800
  s_add_u32 m0, s36, 0x4800
  s_nop 0
  buffer_load_dwordx4 v6, s[20:23], s7 offen lds
  s_waitcnt vmcnt(8)
  s_barrier
  s_add_u32 s7, s33, 0x3000
  s_add_u32 m0, s35, 0x3000
  s_nop 0
  buffer_load_dwordx4 v5, s[16:19], s7 offen lds
  s_add_u32 s7, s33, 0xb000
  s_add_u32 m0, s35, 0xb000
  s_nop 0
  buffer_load_dwordx4 v5, s[16:19], s7 offen lds
  s_add_u32 s7, s34, 0x24c00
  s_add_u32 m0, s36, 0x5400
  s_nop 0
  buffer_load_dwordx4 v6, s[20:23], s7 offen lds
  s_add_u32 s7, s34, 0x2bc00
  s_add_u32 m0, s36, 0x6400
  s_nop 0
  buffer_load_dwordx4 v6, s[20:23], s7 offen lds
  s_add_u32 s7, s33, 0x4000
  s_add_u32 m0, s35, 0x4000
  s_nop 0
  buffer_load_dwordx4 v5, s[16:19], s7 offen lds
  s_add_u32 s7, s33, 0xc000
  s_add_u32 m0, s35, 0xc000
  s_nop 0
  buffer_load_dwordx4 v5, s[16:19], s7 offen lds
  s_add_u32 s7, s34, 0x31000
  s_add_u32 m0, s36, 0x7000
  s_nop 0
  buffer_load_dwordx4 v6, s[20:23], s7 offen lds
  s_add_u32 s7, s34, 0x38000
  s_add_u32 m0, s36, 0x8000
  s_nop 0
  buffer_load_dwordx4 v6, s[20:23], s7 offen lds
  s_add_u32 s7, s33, 0x5000
  s_add_u32 m0, s35, 0x5000
  s_nop 0
  buffer_load_dwordx4 v5, s[16:19], s7 offen lds
  s_add_u32 s7, s33, 0xd000
  s_add_u32 m0, s35, 0xd000
  s_nop 0
  buffer_load_dwordx4 v5, s[16:19], s7 offen lds
  s_add_u32 s7, s34, 0x3d400
  s_add_u32 m0, s36, 0x8c00
  s_nop 0
  buffer_load_dwordx4 v6, s[20:23], s7 offen lds
  s_add_u32 s7, s34, 0x44400
  s_add_u32 m0, s36, 0x9c00
  s_nop 0
  buffer_load_dwordx4 v6, s[20:23], s7 offen lds
  s_waitcnt vmcnt(16)
  s_barrier
  s_add_u32 s7, s33, 0x6000
  s_add_u32 m0, s35, 0x6000
  s_nop 0
  buffer_load_dwordx4 v5, s[16:19], s7 offen lds
  s_add_u32 s7, s33, 0xe000
  s_add_u32 m0, s35, 0xe000
  s_nop 0
  buffer_load_dwordx4 v5, s[16:19], s7 offen lds
  s_add_u32 s7, s34, 0x49800
  s_add_u32 m0, s36, 0xa800
  s_nop 0
  buffer_load_dwordx4 v6, s[20:23], s7 offen lds
  s_add_u32 s7, s34, 0x50800
  s_add_u32 m0, s36, 0xb800
  s_nop 0
  buffer_load_dwordx4 v6, s[20:23], s7 offen lds
  s_waitcnt vmcnt(16)
  s_barrier
  s_add_u32 s7, s33, 0x7000
  s_add_u32 m0, s35, 0x7000
  s_nop 0
  buffer_load_dwordx4 v5, s[16:19], s7 offen lds
  s_add_u32 s7, s33, 0xf000
  s_add_u32 m0, s35, 0xf000
  s_nop 0
  buffer_load_dwordx4 v5, s[16:19], s7 offen lds
  s_add_u32 s7, s34, 0x55c00
  s_add_u32 m0, s36, 0xc400
  s_nop 0
  buffer_load_dwordx4 v6, s[20:23], s7 offen lds
  s_add_u32 s7, s34, 0x5cc00
  s_add_u32 m0, s36, 0xd400
  s_nop 0
  buffer_load_dwordx4 v6, s[20:23], s7 offen lds
  s_add_u32 s7, s37, 0x0
  s_add_u32 m0, s38, 0x0
  s_nop 0
  buffer_load_dwordx4 v7, s[24:27], s7 offen lds
  s_add_u32 s7, s37, 0x1c00
  s_add_u32 m0, s38, 0x400
  s_nop 0
  buffer_load_dwordx4 v7, s[24:27], s7 offen lds
  s_waitcnt vmcnt(18)
  s_barrier
  s_waitcnt vmcnt(14)
  s_barrier
  s_waitcnt vmcnt(10)
  s_barrier
  s_waitcnt vmcnt(6)
  s_barrier
  s_waitcnt vmcnt(0)
  s_barrier
  s_endpgm
k3_wo_kernel_compute_3:
  v_and_b32 v5, 31, v1
  v_lshrrev_b32 v6, 5, v1
  s_and_b32 s39, s4, 1
  s_lshr_b32 s40, s4, 1
  s_lshl_b32 s41, s30, 1
  s_add_u32 s41, s41, s39
  s_lshl_b32 s42, s31, 1
  s_add_u32 s42, s42, s40
  s_lshl_b32 s5, s39, 5
  v_add_u32 v2, s5, v5
  v_and_b32 v3, 7, v2
  v_lshlrev_b32 v2, 7, v2
  v_lshl_add_u32 v2, v6, 3, v2
  v_add_u32 v2, 123904, v2
  s_lshl_b32 s5, s40, 2
  s_add_u32 s6, s5, 0
  v_xor_b32 v4, s6, v3
  v_lshl_add_u32 v16, v4, 4, v2
  s_add_u32 s6, s5, 1
  v_xor_b32 v4, s6, v3
  v_lshl_add_u32 v17, v4, 4, v2
  s_add_u32 s6, s5, 2
  v_xor_b32 v4, s6, v3
  v_lshl_add_u32 v18, v4, 4, v2
  s_add_u32 s6, s5, 3
  v_xor_b32 v4, s6, v3
  v_lshl_add_u32 v19, v4, 4, v2
  s_waitcnt lgkmcnt(0)
  s_mov_b32 s16, s14
  s_and_b32 s17, s15, 0xffff
  s_mov_b32 s18, 0x10000000
  s_mov_b32 s19, 0x20000
  s_getpc_b64 s[44:45]
k3_wo_kernel_pc_4:
  s_add_u32 s44, s44, k4_win_kernel-k3_wo_kernel_pc_4
  s_addc_u32 s45, s45, 0
  s_mov_b32 s48, s44
  s_and_b32 s49, s45, 0xffff
  s_mov_b32 s50, k4_win_kernel_end-k4_win_kernel
  s_mov_b32 s51, 0x20000
  s_lshl_b32 s5, s29, 8
  v_add_u32 v20, s5, v0
  v_lshlrev_b32 v20, 7, v20
  buffer_load_dword v21, v20, s[48:51], 0 offen
  v_lshlrev_b32 v22, 4, v1
  s_lshl_b32 s5, s39, 15
  s_add_u32 s5, s5, 58368
  v_add_u32 v22, s5, v22
  v_bfe_u32 v2, v1, 2, 2
  v_lshl_add_u32 v2, v6, 3, v2
  v_lshlrev_b32 v23, 7, v2
  v_bfe_u32 v2, v1, 4, 1
  v_lshlrev_b32 v2, 1, v2
  v_bfe_u32 v3, v1, 1, 1
  v_add_u32 v2, v2, v3
  s_lshl_b32 s5, s40, 2
  v_add_u32 v2, s5, v2
  v_bfe_u32 v3, v1, 3, 1
  v_lshlrev_b32 v3, 2, v3
  v_xor_b32 v2, v2, v3
  v_lshl_add_u32 v23, v2, 4, v23
  v_and_b32 v2, 1, v1
  v_lshl_add_u32 v23, v2, 3, v23
  s_barrier
  ds_read_b128 v[40:43], v22 offset:0
  ds_read_b64_tr_b16 v[52:53], v23 offset:0
  ds_read_b64_tr_b16 v[54:55], v23 offset:512
  ds_read_b128 v[44:47], v22 offset:1024
  ds_read_b64_tr_b16 v[56:57], v23 offset:2048
  ds_read_b64_tr_b16 v[58:59], v23 offset:2560
  s_waitcnt lgkmcnt(3)
  v_mfma_f32_32x32x16_bf16 v[24:39], v[52:55], v[40:43], 0
  ds_read_b128 v[48:51], v22 offset:2048
  ds_read_b64_tr_b16 v[60:61], v23 offset:3584
  ds_read_b64_tr_b16 v[62:63], v23 offset:4096
  s_waitcnt lgkmcnt(3)
  v_mfma_f32_32x32x16_bf16 v[24:39], v[56:59], v[44:47], v[24:39]
  s_barrier
  ds_read_b128 v[40:43], v22 offset:3072
  ds_read_b64_tr_b16 v[52:53], v23 offset:5632
  ds_read_b64_tr_b16 v[54:55], v23 offset:6144
  s_waitcnt lgkmcnt(3)
  v_mfma_f32_32x32x16_bf16 v[24:39], v[60:63], v[48:51], v[24:39]
  ds_read_b128 v[44:47], v22 offset:4096
  ds_read_b64_tr_b16 v[56:57], v23 offset:7168
  ds_read_b64_tr_b16 v[58:59], v23 offset:7680
  s_waitcnt lgkmcnt(3)
  v_mfma_f32_32x32x16_bf16 v[24:39], v[52:55], v[40:43], v[24:39]
  ds_read_b128 v[48:51], v22 offset:5120
  ds_read_b64_tr_b16 v[60:61], v23 offset:9216
  ds_read_b64_tr_b16 v[62:63], v23 offset:9728
  s_waitcnt lgkmcnt(3)
  v_mfma_f32_32x32x16_bf16 v[24:39], v[56:59], v[44:47], v[24:39]
  ds_read_b128 v[40:43], v22 offset:6144
  ds_read_b64_tr_b16 v[52:53], v23 offset:10752
  ds_read_b64_tr_b16 v[54:55], v23 offset:11264
  s_waitcnt lgkmcnt(3)
  v_mfma_f32_32x32x16_bf16 v[24:39], v[60:63], v[48:51], v[24:39]
  s_barrier
  ds_read_b128 v[44:47], v22 offset:7168
  ds_read_b64_tr_b16 v[56:57], v23 offset:12800
  ds_read_b64_tr_b16 v[58:59], v23 offset:13312
  s_waitcnt lgkmcnt(3)
  v_mfma_f32_32x32x16_bf16 v[24:39], v[52:55], v[40:43], v[24:39]
  ds_read_b128 v[48:51], v22 offset:8192
  ds_read_b64_tr_b16 v[60:61], v23 offset:14336
  ds_read_b64_tr_b16 v[62:63], v23 offset:14848
  s_waitcnt lgkmcnt(3)
  v_mfma_f32_32x32x16_bf16 v[24:39], v[56:59], v[44:47], v[24:39]
  ds_read_b128 v[40:43], v22 offset:9216
  ds_read_b64_tr_b16 v[52:53], v23 offset:16384
  ds_read_b64_tr_b16 v[54:55], v23 offset:16896
  s_waitcnt lgkmcnt(3)
  v_mfma_f32_32x32x16_bf16 v[24:39], v[60:63], v[48:51], v[24:39]
  ds_read_b128 v[44:47], v22 offset:10240
  ds_read_b64_tr_b16 v[56:57], v23 offset:17920
  ds_read_b64_tr_b16 v[58:59], v23 offset:18432
  s_waitcnt lgkmcnt(3)
  v_mfma_f32_32x32x16_bf16 v[24:39], v[52:55], v[40:43], v[24:39]
  s_barrier
  ds_read_b128 v[48:51], v22 offset:11264
  ds_read_b64_tr_b16 v[60:61], v23 offset:19968
  ds_read_b64_tr_b16 v[62:63], v23 offset:20480
  s_waitcnt lgkmcnt(3)
  v_mfma_f32_32x32x16_bf16 v[24:39], v[56:59], v[44:47], v[24:39]
  ds_read_b128 v[40:43], v22 offset:12288
  ds_read_b64_tr_b16 v[52:53], v23 offset:21504
  ds_read_b64_tr_b16 v[54:55], v23 offset:22016
  s_waitcnt lgkmcnt(3)
  v_mfma_f32_32x32x16_bf16 v[24:39], v[60:63], v[48:51], v[24:39]
  ds_read_b128 v[44:47], v22 offset:13312
  ds_read_b64_tr_b16 v[56:57], v23 offset:23552
  ds_read_b64_tr_b16 v[58:59], v23 offset:24064
  s_waitcnt lgkmcnt(3)
  v_mfma_f32_32x32x16_bf16 v[24:39], v[52:55], v[40:43], v[24:39]
  ds_read_b128 v[48:51], v22 offset:14336
  ds_read_b64_tr_b16 v[60:61], v23 offset:25088
  ds_read_b64_tr_b16 v[62:63], v23 offset:25600
  s_waitcnt lgkmcnt(3)
  v_mfma_f32_32x32x16_bf16 v[24:39], v[56:59], v[44:47], v[24:39]
  s_barrier
  ds_read_b128 v[40:43], v22 offset:15360
  ds_read_b64_tr_b16 v[52:53], v23 offset:27136
  ds_read_b64_tr_b16 v[54:55], v23 offset:27648
  s_waitcnt lgkmcnt(3)
  v_mfma_f32_32x32x16_bf16 v[24:39], v[60:63], v[48:51], v[24:39]
  ds_read_b128 v[44:47], v22 offset:16384
  ds_read_b64_tr_b16 v[56:57], v23 offset:28672
  ds_read_b64_tr_b16 v[58:59], v23 offset:29184
  s_waitcnt lgkmcnt(3)
  v_mfma_f32_32x32x16_bf16 v[24:39], v[52:55], v[40:43], v[24:39]
  ds_read_b128 v[48:51], v22 offset:17408
  ds_read_b64_tr_b16 v[60:61], v23 offset:30720
  ds_read_b64_tr_b16 v[62:63], v23 offset:31232
  s_waitcnt lgkmcnt(3)
  v_mfma_f32_32x32x16_bf16 v[24:39], v[56:59], v[44:47], v[24:39]
  ds_read_b128 v[40:43], v22 offset:18432
  ds_read_b64_tr_b16 v[52:53], v23 offset:32256
  ds_read_b64_tr_b16 v[54:55], v23 offset:32768
  s_waitcnt lgkmcnt(3)
  v_mfma_f32_32x32x16_bf16 v[24:39], v[60:63], v[48:51], v[24:39]
  s_barrier
  ds_read_b128 v[44:47], v22 offset:19456
  ds_read_b64_tr_b16 v[56:57], v23 offset:34304
  ds_read_b64_tr_b16 v[58:59], v23 offset:34816
  s_waitcnt lgkmcnt(3)
  v_mfma_f32_32x32x16_bf16 v[24:39], v[52:55], v[40:43], v[24:39]
  ds_read_b128 v[48:51], v22 offset:20480
  ds_read_b64_tr_b16 v[60:61], v23 offset:35840
  ds_read_b64_tr_b16 v[62:63], v23 offset:36352
  s_waitcnt lgkmcnt(3)
  v_mfma_f32_32x32x16_bf16 v[24:39], v[56:59], v[44:47], v[24:39]
  ds_read_b128 v[40:43], v22 offset:21504
  ds_read_b64_tr_b16 v[52:53], v23 offset:37888
  ds_read_b64_tr_b16 v[54:55], v23 offset:38400
  s_waitcnt lgkmcnt(3)
  v_mfma_f32_32x32x16_bf16 v[24:39], v[60:63], v[48:51], v[24:39]
  ds_read_b128 v[44:47], v22 offset:22528
  ds_read_b64_tr_b16 v[56:57], v23 offset:39424
  ds_read_b64_tr_b16 v[58:59], v23 offset:39936
  s_waitcnt lgkmcnt(3)
  v_mfma_f32_32x32x16_bf16 v[24:39], v[52:55], v[40:43], v[24:39]
  s_barrier
  ds_read_b128 v[48:51], v22 offset:23552
  ds_read_b64_tr_b16 v[60:61], v23 offset:41472
  ds_read_b64_tr_b16 v[62:63], v23 offset:41984
  s_waitcnt lgkmcnt(3)
  v_mfma_f32_32x32x16_bf16 v[24:39], v[56:59], v[44:47], v[24:39]
  ds_read_b128 v[40:43], v22 offset:24576
  ds_read_b64_tr_b16 v[52:53], v23 offset:43008
  ds_read_b64_tr_b16 v[54:55], v23 offset:43520
  s_waitcnt lgkmcnt(3)
  v_mfma_f32_32x32x16_bf16 v[24:39], v[60:63], v[48:51], v[24:39]
  ds_read_b128 v[44:47], v22 offset:25600
  ds_read_b64_tr_b16 v[56:57], v23 offset:45056
  ds_read_b64_tr_b16 v[58:59], v23 offset:45568
  s_waitcnt lgkmcnt(3)
  v_mfma_f32_32x32x16_bf16 v[24:39], v[52:55], v[40:43], v[24:39]
  ds_read_b128 v[48:51], v22 offset:26624
  ds_read_b64_tr_b16 v[60:61], v23 offset:46592
  ds_read_b64_tr_b16 v[62:63], v23 offset:47104
  s_waitcnt lgkmcnt(3)
  v_mfma_f32_32x32x16_bf16 v[24:39], v[56:59], v[44:47], v[24:39]
  s_barrier
  ds_read_b128 v[40:43], v22 offset:27648
  ds_read_b64_tr_b16 v[52:53], v23 offset:48640
  ds_read_b64_tr_b16 v[54:55], v23 offset:49152
  s_waitcnt lgkmcnt(3)
  v_mfma_f32_32x32x16_bf16 v[24:39], v[60:63], v[48:51], v[24:39]
  ds_read_b128 v[44:47], v22 offset:28672
  ds_read_b64_tr_b16 v[56:57], v23 offset:50176
  ds_read_b64_tr_b16 v[58:59], v23 offset:50688
  s_waitcnt lgkmcnt(3)
  v_mfma_f32_32x32x16_bf16 v[24:39], v[52:55], v[40:43], v[24:39]
  ds_read_b128 v[48:51], v22 offset:29696
  ds_read_b64_tr_b16 v[60:61], v23 offset:52224
  ds_read_b64_tr_b16 v[62:63], v23 offset:52736
  s_waitcnt lgkmcnt(3)
  v_mfma_f32_32x32x16_bf16 v[24:39], v[56:59], v[44:47], v[24:39]
  ds_read_b128 v[40:43], v22 offset:30720
  ds_read_b64_tr_b16 v[52:53], v23 offset:53760
  ds_read_b64_tr_b16 v[54:55], v23 offset:54272
  s_waitcnt lgkmcnt(3)
  v_mfma_f32_32x32x16_bf16 v[24:39], v[60:63], v[48:51], v[24:39]
  ds_read_b128 v[44:47], v22 offset:31744
  ds_read_b64_tr_b16 v[56:57], v23 offset:55808
  ds_read_b64_tr_b16 v[58:59], v23 offset:56320
  s_waitcnt lgkmcnt(3)
  v_mfma_f32_32x32x16_bf16 v[24:39], v[52:55], v[40:43], v[24:39]
  s_waitcnt lgkmcnt(0)
  v_mfma_f32_32x32x16_bf16 v[24:39], v[56:59], v[44:47], v[24:39]
  ds_read_b64 v[8:9], v16
  ds_read_b64 v[10:11], v17
  ds_read_b64 v[12:13], v18
  ds_read_b64 v[14:15], v19
  s_waitcnt lgkmcnt(0)
  v_lshlrev_b32 v64, 16, v8
  v_and_b32 v65, 0xffff0000, v8
  s_nop 4
  v_pk_add_f32 v[24:25], v[24:25], v[64:65]
  v_lshlrev_b32 v66, 16, v9
  v_and_b32 v67, 0xffff0000, v9
  v_pk_add_f32 v[26:27], v[26:27], v[66:67]
  v_lshlrev_b32 v68, 16, v10
  v_and_b32 v69, 0xffff0000, v10
  v_pk_add_f32 v[28:29], v[28:29], v[68:69]
  v_lshlrev_b32 v70, 16, v11
  v_and_b32 v71, 0xffff0000, v11
  v_pk_add_f32 v[30:31], v[30:31], v[70:71]
  v_lshlrev_b32 v64, 16, v12
  v_and_b32 v65, 0xffff0000, v12
  v_pk_add_f32 v[32:33], v[32:33], v[64:65]
  v_lshlrev_b32 v66, 16, v13
  v_and_b32 v67, 0xffff0000, v13
  v_pk_add_f32 v[34:35], v[34:35], v[66:67]
  v_lshlrev_b32 v68, 16, v14
  v_and_b32 v69, 0xffff0000, v14
  v_pk_add_f32 v[36:37], v[36:37], v[68:69]
  v_lshlrev_b32 v70, 16, v15
  v_and_b32 v71, 0xffff0000, v15
  v_pk_add_f32 v[38:39], v[38:39], v[70:71]
  v_cvt_pk_bf16_f32 v72, v24, v25
  v_cvt_pk_bf16_f32 v73, v26, v27
  v_cvt_pk_bf16_f32 v74, v28, v29
  v_cvt_pk_bf16_f32 v75, v30, v31
  v_cvt_pk_bf16_f32 v76, v32, v33
  v_cvt_pk_bf16_f32 v77, v34, v35
  v_cvt_pk_bf16_f32 v78, v36, v37
  v_cvt_pk_bf16_f32 v79, v38, v39
  v_lshlrev_b32 v80, 4, v1
  s_mul_i32 s7, s41, 28672
  s_lshl_b32 s5, s42, 11
  s_add_u32 s7, s7, s5
  s_add_u32 s7, s7, 0x800000
  buffer_store_dwordx4 v[72:75], v80, s[16:19], s7 offen sc1
  buffer_store_dwordx4 v[76:79], v80, s[16:19], s7 offen offset:1024 sc1
  v_lshlrev_b32 v64, 16, v72
  v_and_b32 v65, 0xffff0000, v72
  v_pk_mul_f32 v[84:85], v[64:65], v[64:65]
  v_mov_b32 v82, v64
  v_mov_b32 v83, v65
  v_lshlrev_b32 v66, 16, v73
  v_and_b32 v67, 0xffff0000, v73
  v_pk_add_f32 v[82:83], v[82:83], v[66:67]
  v_pk_fma_f32 v[84:85], v[66:67], v[66:67], v[84:85]
  v_lshlrev_b32 v68, 16, v74
  v_and_b32 v69, 0xffff0000, v74
  v_pk_add_f32 v[82:83], v[82:83], v[68:69]
  v_pk_fma_f32 v[84:85], v[68:69], v[68:69], v[84:85]
  v_lshlrev_b32 v70, 16, v75
  v_and_b32 v71, 0xffff0000, v75
  v_pk_add_f32 v[82:83], v[82:83], v[70:71]
  v_pk_fma_f32 v[84:85], v[70:71], v[70:71], v[84:85]
  v_lshlrev_b32 v64, 16, v76
  v_and_b32 v65, 0xffff0000, v76
  v_pk_add_f32 v[82:83], v[82:83], v[64:65]
  v_pk_fma_f32 v[84:85], v[64:65], v[64:65], v[84:85]
  v_lshlrev_b32 v66, 16, v77
  v_and_b32 v67, 0xffff0000, v77
  v_pk_add_f32 v[82:83], v[82:83], v[66:67]
  v_pk_fma_f32 v[84:85], v[66:67], v[66:67], v[84:85]
  v_lshlrev_b32 v68, 16, v78
  v_and_b32 v69, 0xffff0000, v78
  v_pk_add_f32 v[82:83], v[82:83], v[68:69]
  v_pk_fma_f32 v[84:85], v[68:69], v[68:69], v[84:85]
  v_lshlrev_b32 v70, 16, v79
  v_and_b32 v71, 0xffff0000, v79
  v_pk_add_f32 v[82:83], v[82:83], v[70:71]
  v_pk_fma_f32 v[84:85], v[70:71], v[70:71], v[84:85]
  v_add_f32 v82, v82, v83
  v_add_f32 v84, v84, v85
  v_mov_b32 v83, v82
  s_nop 1
  v_permlane32_swap_b32 v82, v83
  v_add_f32 v82, v82, v83
  v_mov_b32 v85, v84
  s_nop 1
  v_permlane32_swap_b32 v84, v85
  v_add_f32 v84, v84, v85
  v_mov_b32 v83, v84
  v_lshlrev_b32 v86, 3, v5
  s_mul_i32 s7, s41, 3584
  s_lshl_b32 s5, s42, 8
  s_add_u32 s7, s7, s5
  s_add_u32 s7, s7, 0xa00000
  s_mov_b32 exec_hi, 0
  buffer_store_dwordx2 v[82:83], v86, s[16:19], s7 offen sc1
  s_endpgm
k3_wo_kernel_aux_2:
  s_sub_u32 s52, s29, 28
  s_lshl_b32 s52, s52, 3
  s_add_u32 s52, s52, s28
  s_waitcnt lgkmcnt(0)
  s_mov_b32 s16, s14
  s_and_b32 s17, s15, 0xffff
  s_mov_b32 s18, 0x10000000
  s_mov_b32 s19, 0x20000
  v_mov_b32 v8, -1
  v_mov_b32 v9, -1
  v_mov_b32 v10, -1
  v_mov_b32 v11, -1
  v_lshlrev_b32 v3, 4, v0
  v_mov_b32 v4, 0x7fffff00
  v_cmp_gt_u32 vcc, 448, v0
  s_nop 1
  v_cndmask_b32 v3, v4, v3, vcc
  s_mul_i32 s5, s52, 7168
  s_add_u32 s5, s5, 0xa50000
  buffer_store_dwordx4 v[8:11], v3, s[16:19], s5 offen sc1
  v_mov_b32 v12, 0
  v_mov_b32 v13, 0
  v_mov_b32 v14, 0
  v_mov_b32 v15, 0
  v_lshlrev_b32 v3, 4, v0
  v_mov_b32 v4, 0x7fffff00
  v_cmp_gt_u32 vcc, 32, v0
  s_nop 1
  v_cndmask_b32 v3, v4, v3, vcc
  s_lshl_b32 s5, s52, 9
  s_add_u32 s5, s5, 0xa90000
  buffer_store_dwordx4 v[12:15], v3, s[16:19], s5 offen sc1
  s_mov_b32 s56, s12
  s_and_b32 s57, s13, 0xffff
  s_mov_b32 s58, 0x188000
  s_mov_b32 s59, 0x20000
  s_cmp_ge_u32 s52, 28
  s_cbranch_scc1 k3_wo_kernel_nocs_5
  v_lshrrev_b32 v2, 3, v1
  v_mul_u32_u24 v2, 3584, v2
  v_bfe_u32 v3, v1, 4, 1
  v_lshlrev_b32 v3, 2, v3
  v_and_b32 v4, 7, v1
  v_xor_b32 v3, v3, v4
  v_lshl_add_u32 v16, v3, 4, v2
  s_mul_i32 s60, s4, 200704
  s_lshl_b32 s5, s52, 7
  s_add_u32 s60, s60, s5
  s_mul_i32 s61, s4, 7168
  s_add_u32 s7, s60, 0x0
  s_add_u32 m0, s61, 0x0
  s_nop 0
  buffer_load_dwordx4 v16, s[56:59], s7 offen lds
  s_add_u32 s7, s60, 0x7000
  s_add_u32 m0, s61, 0x400
  s_nop 0
  buffer_load_dwordx4 v16, s[56:59], s7 offen lds
  s_add_u32 s7, s60, 0xe000
  s_add_u32 m0, s61, 0x800
  s_nop 0
  buffer_load_dwordx4 v16, s[56:59], s7 offen lds
  s_add_u32 s7, s60, 0x15000
  s_add_u32 m0, s61, 0xc00
  s_nop 0
  buffer_load_dwordx4 v16, s[56:59], s7 offen lds
  s_add_u32 s7, s60, 0x1c000
  s_add_u32 m0, s61, 0x1000
  s_nop 0
  buffer_load_dwordx4 v16, s[56:59], s7 offen lds
  s_add_u32 s7, s60, 0x23000
  s_add_u32 m0, s61, 0x1400
  s_nop 0
  buffer_load_dwordx4 v16, s[56:59], s7 offen lds
  s_add_u32 s7, s60, 0x2a000
  s_add_u32 m0, s61, 0x1800
  s_nop 0
  buffer_load_dwordx4 v16, s[56:59], s7 offen lds
  v_mov_b32 v17, 0
  v_lshlrev_b32 v2, 2, v1
  v_add_u32 v2, 57344, v2
  ds_write_b32 v2, v17
  v_lshrrev_b32 v18, 4, v1
  v_bfe_u32 v2, v1, 2, 2
  v_lshl_add_u32 v2, v18, 3, v2
  v_lshlrev_b32 v19, 7, v2
  v_bfe_u32 v2, v1, 1, 1
  s_lshl_b32 s5, s32, 1
  v_add_u32 v2, s5, v2
  v_bfe_u32 v3, v1, 3, 1
  v_lshlrev_b32 v3, 2, v3
  v_xor_b32 v2, v2, v3
  v_lshl_add_u32 v19, v2, 4, v19
  v_and_b32 v2, 1, v1
  v_lshl_add_u32 v19, v2, 3, v19
  s_lshr_b32 s5, s4, 2
  s_mul_i32 s5, s5, 28672
  v_add_u32 v19, s5, v19
  v_mov_b32 v20, 0x3f803f80
  v_mov_b32 v21, 0x3f803f80
  v_mov_b32 v22, 0x3f803f80
  v_mov_b32 v23, 0x3f803f80
  s_waitcnt vmcnt(0) lgkmcnt(0)
  s_barrier
  ds_read_b64_tr_b16 v[24:25], v19 offset:0
  ds_read_b64_tr_b16 v[26:27], v19 offset:512
  ds_read_b64_tr_b16 v[28:29], v19 offset:4096
  ds_read_b64_tr_b16 v[30:31], v19 offset:4608
  ds_read_b64_tr_b16 v[32:33], v19 offset:8192
  ds_read_b64_tr_b16 v[34:35], v19 offset:8704
  ds_read_b64_tr_b16 v[36:37], v19 offset:12288
  ds_read_b64_tr_b16 v[38:39], v19 offset:12800
  ds_read_b64_tr_b16 v[40:41], v19 offset:16384
  ds_read_b64_tr_b16 v[42:43], v19 offset:16896
  ds_read_b64_tr_b16 v[44:45], v19 offset:20480
  ds_read_b64_tr_b16 v[46:47], v19 offset:20992
  ds_read_b64_tr_b16 v[48:49], v19 offset:24576
  ds_read_b64_tr_b16 v[50:51], v19 offset:25088
  s_waitcnt lgkmcnt(0)
  v_mfma_f32_16x16x32_bf16 v[52:55], v[20:23], v[24:27], 0
  v_mfma_f32_16x16x32_bf16 v[52:55], v[20:23], v[28:31], v[52:55]
  v_mfma_f32_16x16x32_bf16 v[52:55], v[20:23], v[32:35], v[52:55]
  v_mfma_f32_16x16x32_bf16 v[52:55], v[20:23], v[36:39], v[52:55]
  v_mfma_f32_16x16x32_bf16 v[52:55], v[20:23], v[40:43], v[52:55]
  v_mfma_f32_16x16x32_bf16 v[52:55], v[20:23], v[44:47], v[52:55]
  v_mfma_f32_16x16x32_bf16 v[52:55], v[20:23], v[48:51], v[52:55]
  v_and_b32 v2, 15, v1
  s_lshl_b32 s5, s32, 6
  s_add_u32 s5, s5, 57344
  v_lshlrev_b32 v2, 2, v2
  v_add_u32 v2, s5, v2
  s_mov_b32 exec_lo, 0xffff
  s_mov_b32 exec_hi, 0
  s_nop 0
  ds_add_f32 v2, v52
  s_mov_b64 exec, -1
  s_waitcnt lgkmcnt(0)
  s_barrier
  s_cmp_lg_u32 s4, 0
  s_cbranch_scc1 k3_wo_kernel_done_1
  v_lshlrev_b32 v2, 2, v1
  v_add_u32 v3, 57344, v2
  ds_read_b32 v17, v3
  s_lshl_b32 s5, s52, 8
  s_add_u32 s5, s5, 0xa40000
  s_waitcnt lgkmcnt(0)
  buffer_store_dword v17, v2, s[16:19], s5 offen sc1
  s_endpgm
k3_wo_kernel_nocs_5:
k3_wo_kernel_done_1:
  s_endpgm
k3_wo_kernel_end:
.globl k4_win_kernel
.p2align 8
.type k4_win_kernel,@function
k4_win_kernel:
  s_cmp_ge_u32 s2, 256
  s_cbranch_scc1 k4_win_kernel_done_1
  v_lshrrev_b32 v2, 6, v0
  v_and_b32 v1, 63, v0
  v_readfirstlane_b32 s4, v2
  s_load_dwordx2 s[8:9], s[0:1], 32
  s_load_dwordx2 s[10:11], s[0:1], 80
  s_and_b32 s20, s2, 7
  s_lshr_b32 s21, s2, 3
  s_and_b32 s24, s4, 3
  s_cmp_ge_u32 s21, 28
  s_cbranch_scc1 k4_win_kernel_pfrole_2
  s_mul_i32 s5, s21, 37
  s_lshr_b32 s5, s5, 8
  s_mul_i32 s6, s5, 7
  s_sub_u32 s23, s21, s6
  s_and_b32 s6, s20, 1
  s_mul_i32 s6, s6, 7
  s_add_u32 s23, s23, s6
  s_lshr_b32 s22, s20, 1
  s_lshl_b32 s22, s22, 2
  s_add_u32 s22, s22, s5
  s_lshl_b32 s25, s22, 2
  s_add_u32 s25, s25, s24
  s_cmp_lt_u32 s4, 4
  s_cbranch_scc1 k4_win_kernel_compute_3
  v_lshlrev_b32 v5, 4, v1
  v_lshrrev_b32 v2, 3, v1
  v_mul_u32_u24 v2, 3584, v2
  v_bfe_u32 v3, v1, 4, 1
  v_lshlrev_b32 v3, 2, v3
  v_and_b32 v4, 7, v1
  v_xor_b32 v3, v3, v4
  v_lshl_add_u32 v6, v3, 4, v2
  s_mul_i32 s26, s25, 28672
  s_add_u32 s26, s26, 0x800000
  s_mul_i32 s28, s24, 28672
  s_mul_i32 s27, s24, 57344
  s_lshl_b32 s6, s23, 7
  s_add_u32 s27, s27, s6
  s_lshl_b32 s29, s24, 11
  s_add_u32 s29, s29, 114688
  s_lshl_b32 s5, s22, 1
  s_add_u32 s5, s5, s23
  s_mul_i32 s6, s5, 37
  s_lshr_b32 s6, s6, 8
  s_mul_i32 s6, s6, 7
  s_sub_u32 s30, s5, s6
  s_mov_b32 s30, 0
  s_waitcnt lgkmcnt(0)
  s_mov_b32 s12, s10
  s_and_b32 s13, s11, 0xffff
  s_mov_b32 s14, 0x10000000
  s_mov_b32 s15, 0x20000
  s_mov_b32 s16, s8
  s_and_b32 s17, s9, 0xffff
  s_mov_b32 s18, 0x188000
  s_mov_b32 s19, 0x20000
  s_add_u32 s31, s30, 0
  s_cmp_ge_u32 s31, 7
  s_cselect_b32 s3, 7, 0
  s_sub_u32 s31, s31, s3
  s_lshl_b32 s32, s31, 12
  s_add_u32 s32, s32, s26
  s_add_u32 s7, s32, 0x0
  s_add_u32 m0, s28, 0x0
  s_nop 0
  buffer_load_dwordx4 v5, s[12:15], s7 offen lds
  s_add_u32 s7, s32, 0x400
  s_add_u32 m0, s28, 0x400
  s_nop 0
  buffer_load_dwordx4 v5, s[12:15], s7 offen lds
  s_add_u32 s7, s32, 0x800
  s_add_u32 m0, s28, 0x800
  s_nop 0
  buffer_load_dwordx4 v5, s[12:15], s7 offen lds
  s_add_u32 s7, s32, 0xc00
  s_add_u32 m0, s28, 0xc00
  s_nop 0
  buffer_load_dwordx4 v5, s[12:15], s7 offen lds
  s_mul_i32 s33, s31, 229376
  s_add_u32 s33, s33, s27
  s_add_u32 s7, s33, 0x700
  s_add_u32 m0, s29, 0x0
  s_nop 0
  buffer_load_dwordx4 v6, s[16:19], s7 offen lds
  s_add_u32 s7, s33, 0x7700
  s_add_u32 m0, s29, 0x400
  s_nop 0
  buffer_load_dwordx4 v6, s[16:19], s7 offen lds
  s_cmp_ge_u32 s24, 2
  s_cbranch_scc1 k4_win_kernel_nocw_4
  v_lshlrev_b32 v2, 2, v1
  s_lshl_b32 s5, s23, 8
  s_xor_b32 s6, s24, 1
  s_mul_i32 s6, s6, 3584
  s_add_u32 s5, s5, s6
  s_add_u32 s7, s5, 0xa40000
  s_lshl_b32 s6, s24, 8
  s_add_u32 m0, s6, 155648
  s_nop 0
  buffer_load_dword v2, s[12:15], s7 offen lds
k4_win_kernel_nocw_4:
  s_add_u32 s31, s30, 1
  s_cmp_ge_u32 s31, 7
  s_cselect_b32 s3, 7, 0
  s_sub_u32 s31, s31, s3
  s_lshl_b32 s32, s31, 12
  s_add_u32 s32, s32, s26
  s_add_u32 s7, s32, 0x0
  s_add_u32 m0, s28, 0x1000
  s_nop 0
  buffer_load_dwordx4 v5, s[12:15], s7 offen lds
  s_add_u32 s7, s32, 0x400
  s_add_u32 m0, s28, 0x1400
  s_nop 0
  buffer_load_dwordx4 v5, s[12:15], s7 offen lds
  s_add_u32 s7, s32, 0x800
  s_add_u32 m0, s28, 0x1800
  s_nop 0
  buffer_load_dwordx4 v5, s[12:15], s7 offen lds
  s_add_u32 s7, s32, 0xc00
  s_add_u32 m0, s28, 0x1c00
  s_nop 0
  buffer_load_dwordx4 v5, s[12:15], s7 offen lds
  s_mul_i32 s33, s31, 229376
  s_add_u32 s33, s33, s27
  s_add_u32 s7, s33, 0x700
  s_add_u32 m0, s29, 0x2000
  s_nop 0
  buffer_load_dwordx4 v6, s[16:19], s7 offen lds
  s_add_u32 s7, s33, 0x7700
  s_add_u32 m0, s29, 0x2400
  s_nop 0
  buffer_load_dwordx4 v6, s[16:19], s7 offen lds
  s_add_u32 s31, s30, 2
  s_cmp_ge_u32 s31, 7
  s_cselect_b32 s3, 7, 0
  s_sub_u32 s31, s31, s3
  s_lshl_b32 s32, s31, 12
  s_add_u32 s32, s32, s26
  s_add_u32 s7, s32, 0x0
  s_add_u32 m0, s28, 0x2000
  s_nop 0
  buffer_load_dwordx4 v5, s[12:15], s7 offen lds
  s_add_u32 s7, s32, 0x400
  s_add_u32 m0, s28, 0x2400
  s_nop 0
  buffer_load_dwordx4 v5, s[12:15], s7 offen lds
  s_add_u32 s7, s32, 0x800
  s_add_u32 m0, s28, 0x2800
  s_nop 0
  buffer_load_dwordx4 v5, s[12:15], s7 offen lds
  s_add_u32 s7, s32, 0xc00
  s_add_u32 m0, s28, 0x2c00
  s_nop 0
  buffer_load_dwordx4 v5, s[12:15], s7 offen lds
  s_mul_i32 s33, s31, 229376
  s_add_u32 s33, s33, s27
  s_add_u32 s7, s33, 0x700
  s_add_u32 m0, s29, 0x4000
  s_nop 0
  buffer_load_dwordx4 v6, s[16:19], s7 offen lds
  s_add_u32 s7, s33, 0x7700
  s_add_u32 m0, s29, 0x4400
  s_nop 0
  buffer_load_dwordx4 v6, s[16:19], s7 offen lds
  s_waitcnt vmcnt(12)
  s_barrier
  s_add_u32 s31, s30, 3
  s_cmp_ge_u32 s31, 7
  s_cselect_b32 s3, 7, 0
  s_sub_u32 s31, s31, s3
  s_lshl_b32 s32, s31, 12
  s_add_u32 s32, s32, s26
  s_add_u32 s7, s32, 0x0
  s_add_u32 m0, s28, 0x3000
  s_nop 0
  buffer_load_dwordx4 v5, s[12:15], s7 offen lds
  s_add_u32 s7, s32, 0x400
  s_add_u32 m0, s28, 0x3400
  s_nop 0
  buffer_load_dwordx4 v5, s[12:15], s7 offen lds
  s_add_u32 s7, s32, 0x800
  s_add_u32 m0, s28, 0x3800
  s_nop 0
  buffer_load_dwordx4 v5, s[12:15], s7 offen lds
  s_add_u32 s7, s32, 0xc00
  s_add_u32 m0, s28, 0x3c00
  s_nop 0
  buffer_load_dwordx4 v5, s[12:15], s7 offen lds
  s_mul_i32 s33, s31, 229376
  s_add_u32 s33, s33, s27
  s_add_u32 s7, s33, 0x700
  s_add_u32 m0, s29, 0x6000
  s_nop 0
  buffer_load_dwordx4 v6, s[16:19], s7 offen lds
  s_add_u32 s7, s33, 0x7700
  s_add_u32 m0, s29, 0x6400
  s_nop 0
  buffer_load_dwordx4 v6, s[16:19], s7 offen lds
  s_add_u32 s31, s30, 4
  s_cmp_ge_u32 s31, 7
  s_cselect_b32 s3, 7, 0
  s_sub_u32 s31, s31, s3
  s_lshl_b32 s32, s31, 12
  s_add_u32 s32, s32, s26
  s_add_u32 s7, s32, 0x0
  s_add_u32 m0, s28, 0x4000
  s_nop 0
  buffer_load_dwordx4 v5, s[12:15], s7 offen lds
  s_add_u32 s7, s32, 0x400
  s_add_u32 m0, s28, 0x4400
  s_nop 0
  buffer_load_dwordx4 v5, s[12:15], s7 offen lds
  s_add_u32 s7, s32, 0x800
  s_add_u32 m0, s28, 0x4800
  s_nop 0
  buffer_load_dwordx4 v5, s[12:15], s7 offen lds
  s_add_u32 s7, s32, 0xc00
  s_add_u32 m0, s28, 0x4c00
  s_nop 0
  buffer_load_dwordx4 v5, s[12:15], s7 offen lds
  s_mul_i32 s33, s31, 229376
  s_add_u32 s33, s33, s27
  s_add_u32 s7, s33, 0x700
  s_add_u32 m0, s29, 0x8000
  s_nop 0
  buffer_load_dwordx4 v6, s[16:19], s7 offen lds
  s_add_u32 s7, s33, 0x7700
  s_add_u32 m0, s29, 0x8400
  s_nop 0
  buffer_load_dwordx4 v6, s[16:19], s7 offen lds
  s_waitcnt vmcnt(18)
  s_barrier
  s_waitcnt vmcnt(12)
  s_barrier
  s_add_u32 s31, s30, 5
  s_cmp_ge_u32 s31, 7
  s_cselect_b32 s3, 7, 0
  s_sub_u32 s31, s31, s3
  s_lshl_b32 s32, s31, 12
  s_add_u32 s32, s32, s26
  s_add_u32 s7, s32, 0x0
  s_add_u32 m0, s28, 0x5000
  s_nop 0
  buffer_load_dwordx4 v5, s[12:15], s7 offen lds
  s_add_u32 s7, s32, 0x400
  s_add_u32 m0, s28, 0x5400
  s_nop 0
  buffer_load_dwordx4 v5, s[12:15], s7 offen lds
  s_add_u32 s7, s32, 0x800
  s_add_u32 m0, s28, 0x5800
  s_nop 0
  buffer_load_dwordx4 v5, s[12:15], s7 offen lds
  s_add_u32 s7, s32, 0xc00
  s_add_u32 m0, s28, 0x5c00
  s_nop 0
  buffer_load_dwordx4 v5, s[12:15], s7 offen lds
  s_mul_i32 s33, s31, 229376
  s_add_u32 s33, s33, s27
  s_add_u32 s7, s33, 0x700
  s_add_u32 m0, s29, 0x0
  s_nop 0
  buffer_load_dwordx4 v6, s[16:19], s7 offen lds
  s_add_u32 s7, s33, 0x7700
  s_add_u32 m0, s29, 0x400
  s_nop 0
  buffer_load_dwordx4 v6, s[16:19], s7 offen lds
  s_waitcnt vmcnt(12)
  s_barrier
  s_add_u32 s31, s30, 6
  s_cmp_ge_u32 s31, 7
  s_cselect_b32 s3, 7, 0
  s_sub_u32 s31, s31, s3
  s_lshl_b32 s32, s31, 12
  s_add_u32 s32, s32, s26
  s_add_u32 s7, s32, 0x0
  s_add_u32 m0, s28, 0x6000
  s_nop 0
  buffer_load_dwordx4 v5, s[12:15], s7 offen lds
  s_add_u32 s7, s32, 0x400
  s_add_u32 m0, s28, 0x6400
  s_nop 0
  buffer_load_dwordx4 v5, s[12:15], s7 offen lds
  s_add_u32 s7, s32, 0x800
  s_add_u32 m0, s28, 0x6800
  s_nop 0
  buffer_load_dwordx4 v5, s[12:15], s7 offen lds
  s_add_u32 s7, s32, 0xc00
  s_add_u32 m0, s28, 0x6c00
  s_nop 0
  buffer_load_dwordx4 v5, s[12:15], s7 offen lds
  s_mul_i32 s33, s31, 229376
  s_add_u32 s33, s33, s27
  s_add_u32 s7, s33, 0x700
  s_add_u32 m0, s29, 0x2000
  s_nop 0
  buffer_load_dwordx4 v6, s[16:19], s7 offen lds
  s_add_u32 s7, s33, 0x7700
  s_add_u32 m0, s29, 0x2400
  s_nop 0
  buffer_load_dwordx4 v6, s[16:19], s7 offen lds
  s_waitcnt vmcnt(12)
  s_barrier
  s_add_u32 s31, s30, 0
  s_cmp_ge_u32 s31, 7
  s_cselect_b32 s3, 7, 0
  s_sub_u32 s31, s31, s3
  s_mul_i32 s33, s31, 229376
  s_add_u32 s33, s33, s27
  s_add_u32 s7, s33, 0x0
  s_add_u32 m0, s29, 0x4000
  s_nop 0
  buffer_load_dwordx4 v6, s[16:19], s7 offen lds
  s_add_u32 s7, s33, 0x7000
  s_add_u32 m0, s29, 0x4400
  s_nop 0
  buffer_load_dwordx4 v6, s[16:19], s7 offen lds
  s_waitcnt vmcnt(8)
  s_barrier
  s_add_u32 s31, s30, 1
  s_cmp_ge_u32 s31, 7
  s_cselect_b32 s3, 7, 0
  s_sub_u32 s31, s31, s3
  s_mul_i32 s33, s31, 229376
  s_add_u32 s33, s33, s27
  s_add_u32 s7, s33, 0x0
  s_add_u32 m0, s29, 0x6000
  s_nop 0
  buffer_load_dwordx4 v6, s[16:19], s7 offen lds
  s_add_u32 s7, s33, 0x7000
  s_add_u32 m0, s29, 0x6400
  s_nop 0
  buffer_load_dwordx4 v6, s[16:19], s7 offen lds
  s_waitcnt vmcnt(4)
  s_barrier
  s_add_u32 s31, s30, 2
  s_cmp_ge_u32 s31, 7
  s_cselect_b32 s3, 7, 0
  s_sub_u32 s31, s31, s3
  s_mul_i32 s33, s31, 229376
  s_add_u32 s33, s33, s27
  s_add_u32 s7, s33, 0x0
  s_add_u32 m0, s29, 0x8000
  s_nop 0
  buffer_load_dwordx4 v6, s[16:19], s7 offen lds
  s_add_u32 s7, s33, 0x7000
  s_add_u32 m0, s29, 0x8400
  s_nop 0
  buffer_load_dwordx4 v6, s[16:19], s7 offen lds
  s_waitcnt vmcnt(4)
  s_barrier
  s_add_u32 s31, s30, 3
  s_cmp_ge_u32 s31, 7
  s_cselect_b32 s3, 7, 0
  s_sub_u32 s31, s31, s3
  s_mul_i32 s33, s31, 229376
  s_add_u32 s33, s33, s27
  s_add_u32 s7, s33, 0x0
  s_add_u32 m0, s29, 0x0
  s_nop 0
  buffer_load_dwordx4 v6, s[16:19], s7 offen lds
  s_add_u32 s7, s33, 0x7000
  s_add_u32 m0, s29, 0x400
  s_nop 0
  buffer_load_dwordx4 v6, s[16:19], s7 offen lds
  s_waitcnt vmcnt(4)
  s_barrier
  s_add_u32 s31, s30, 4
  s_cmp_ge_u32 s31, 7
  s_cselect_b32 s3, 7, 0
  s_sub_u32 s31, s31, s3
  s_mul_i32 s33, s31, 229376
  s_add_u32 s33, s33, s27
  s_add_u32 s7, s33, 0x0
  s_add_u32 m0, s29, 0x2000
  s_nop 0
  buffer_load_dwordx4 v6, s[16:19], s7 offen lds
  s_add_u32 s7, s33, 0x7000
  s_add_u32 m0, s29, 0x2400
  s_nop 0
  buffer_load_dwordx4 v6, s[16:19], s7 offen lds
  s_waitcnt vmcnt(4)
  s_barrier
  s_add_u32 s31, s30, 5
  s_cmp_ge_u32 s31, 7
  s_cselect_b32 s3, 7, 0
  s_sub_u32 s31, s31, s3
  s_mul_i32 s33, s31, 229376
  s_add_u32 s33, s33, s27
  s_add_u32 s7, s33, 0x0
  s_add_u32 m0, s29, 0x4000
  s_nop 0
  buffer_load_dwordx4 v6, s[16:19], s7 offen lds
  s_add_u32 s7, s33, 0x7000
  s_add_u32 m0, s29, 0x4400
  s_nop 0
  buffer_load_dwordx4 v6, s[16:19], s7 offen lds
  s_waitcnt vmcnt(4)
  s_barrier
  s_add_u32 s31, s30, 6
  s_cmp_ge_u32 s31, 7
  s_cselect_b32 s3, 7, 0
  s_sub_u32 s31, s31, s3
  s_mul_i32 s33, s31, 229376
  s_add_u32 s33, s33, s27
  s_add_u32 s7, s33, 0x0
  s_add_u32 m0, s29, 0x6000
  s_nop 0
  buffer_load_dwordx4 v6, s[16:19], s7 offen lds
  s_add_u32 s7, s33, 0x7000
  s_add_u32 m0, s29, 0x6400
  s_nop 0
  buffer_load_dwordx4 v6, s[16:19], s7 offen lds
  s_waitcnt vmcnt(4)
  s_barrier
  s_waitcnt vmcnt(2)
  s_barrier
  s_waitcnt vmcnt(0)
  s_barrier
  s_endpgm
k4_win_kernel_compute_3:
  v_and_b32 v5, 31, v1
  v_lshrrev_b32 v6, 5, v1
  v_lshlrev_b32 v24, 3, v1
  s_mul_i32 s7, s25, 3584
  s_add_u32 s34, s7, 0xa50000
  s_add_u32 s7, s7, 0xa00000
  s_waitcnt lgkmcnt(0)
  s_mov_b32 s12, s10
  s_and_b32 s13, s11, 0xffff
  s_mov_b32 s14, 0x10000000
  s_mov_b32 s15, 0x20000
  buffer_load_dwordx2 v[8:9], v24, s[12:15], s7 offen offset:0
  buffer_load_dwordx2 v[10:11], v24, s[12:15], s7 offen offset:512
  buffer_load_dwordx2 v[12:13], v24, s[12:15], s7 offen offset:1024
  buffer_load_dwordx2 v[14:15], v24, s[12:15], s7 offen offset:1536
  buffer_load_dwordx2 v[16:17], v24, s[12:15], s7 offen offset:2048
  buffer_load_dwordx2 v[18:19], v24, s[12:15], s7 offen offset:2560
  buffer_load_dwordx2 v[20:21], v24, s[12:15], s7 offen offset:3072
  s_getpc_b64 s[36:37]
k4_win_kernel_pc_5:
  s_add_u32 s36, s36, k5_sp_kernel-k4_win_kernel_pc_5
  s_addc_u32 s37, s37, 0
  s_mov_b32 s40, s36
  s_and_b32 s41, s37, 0xffff
  s_mov_b32 s42, k5_sp_kernel_end-k5_sp_kernel
  s_mov_b32 s43, 0x20000
  s_lshl_b32 s5, s21, 8
  v_add_u32 v25, s5, v0
  v_lshlrev_b32 v25, 7, v25
  buffer_load_dword v26, v25, s[40:43], 0 offen
  v_lshlrev_b32 v28, 4, v1
  s_mul_i32 s5, s4, 28672
  v_add_u32 v27, s5, v28
  v_bfe_u32 v2, v1, 2, 2
  v_lshl_add_u32 v2, v6, 2, v2
  v_lshlrev_b32 v2, 7, v2
  v_add_u32 v2, 114688, v2
  v_bfe_u32 v3, v1, 4, 1
  v_lshlrev_b32 v3, 1, v3
  v_bfe_u32 v4, v1, 1, 1
  v_add_u32 v3, v3, v4
  v_bfe_u32 v4, v1, 3, 1
  v_lshlrev_b32 v4, 2, v4
  v_add_u32 v29, 0, v3
  v_xor_b32 v29, v29, v4
  v_lshl_add_u32 v29, v29, 4, v2
  v_add_u32 v30, 4, v3
  v_xor_b32 v30, v30, v4
  v_lshl_add_u32 v30, v30, 4, v2
  v_and_b32 v3, 1, v1
  v_lshl_add_u32 v29, v3, 3, v29
  v_lshl_add_u32 v30, v3, 3, v30
  s_waitcnt vmcnt(1)
  v_pk_add_f32 v[8:9], v[8:9], v[14:15]
  v_pk_add_f32 v[10:11], v[10:11], v[16:17]
  v_pk_add_f32 v[12:13], v[12:13], v[18:19]
  v_pk_add_f32 v[8:9], v[8:9], v[20:21]
  v_pk_add_f32 v[10:11], v[10:11], v[12:13]
  v_pk_add_f32 v[8:9], v[8:9], v[10:11]
  v_mov_b32 v10, v8
  s_nop 1
  v_permlane32_swap_b32 v8, v10
  v_add_f32 v8, v8, v10
  v_mov_b32 v10, v9
  s_nop 1
  v_permlane32_swap_b32 v9, v10
  v_add_f32 v9, v9, v10
  v_mul_f32 v34, 0xbb124925, v8
  v_mul_f32 v9, 0x3b124925, v9
  v_fma_f32 v9, -v34, v34, v9
  v_max_f32 v9, 0, v9
  v_add_f32 v9, 0x3727c5ac, v9
  v_rsq_f32 v32, v9
  s_nop 0
  v_mul_f32 v36, 0xc0135761, v32
  v_mul_f32 v38, v32, v32
  v_mul_f32 v38, v38, v32
  v_mul_f32 v38, 0xbdd2d3e8, v38
  s_cmp_lg_u32 s23, 0
  s_cbranch_scc1 k4_win_kernel_norh_6
  v_lshlrev_b32 v2, 2, v5
  s_lshl_b32 s5, s25, 7
  s_add_u32 s5, s5, 0xac0000
  buffer_store_dword v32, v2, s[12:15], s5 offen sc1
k4_win_kernel_norh_6:
  v_lshlrev_b32 v148, 4, v6
  v_add_u32 v148, 155648, v148
  s_barrier
  ds_read_b128 v[112:115], v27 offset:0
  ds_read_b64_tr_b16 v[124:125], v29 offset:0
  ds_read_b64_tr_b16 v[126:127], v29 offset:1024
  ds_read_b64_tr_b16 v[128:129], v30 offset:0
  ds_read_b64_tr_b16 v[130:131], v30 offset:1024
  ds_read_b128 v[116:119], v27 offset:1024
  ds_read_b64_tr_b16 v[132:133], v29 offset:2048
  ds_read_b64_tr_b16 v[134:135], v29 offset:3072
  ds_read_b64_tr_b16 v[136:137], v30 offset:2048
  ds_read_b64_tr_b16 v[138:139], v30 offset:3072
  s_waitcnt lgkmcnt(5)
  v_mfma_f32_32x32x16_bf16 v[40:55], v[124:127], v[112:115], 0
  ds_read_b128 v[120:123], v27 offset:2048
  ds_read_b64_tr_b16 v[140:141], v29 offset:4096
  ds_read_b64_tr_b16 v[142:143], v29 offset:5120
  v_mfma_f32_32x32x16_bf16 v[56:71], v[128:131], v[112:115], 0
  ds_read_b64_tr_b16 v[144:145], v30 offset:4096
  ds_read_b64_tr_b16 v[146:147], v30 offset:5120
  s_waitcnt lgkmcnt(5)
  v_mfma_f32_32x32x16_bf16 v[40:55], v[132:135], v[116:119], v[40:55]
  ds_read_b128 v[112:115], v27 offset:3072
  ds_read_b64_tr_b16 v[124:125], v29 offset:6144
  ds_read_b64_tr_b16 v[126:127], v29 offset:7168
  v_mfma_f32_32x32x16_bf16 v[56:71], v[136:139], v[116:119], v[56:71]
  ds_read_b64_tr_b16 v[128:129], v30 offset:6144
  ds_read_b64_tr_b16 v[130:131], v30 offset:7168
  s_waitcnt lgkmcnt(5)
  s_barrier
  v_mfma_f32_32x32x16_bf16 v[40:55], v[140:143], v[120:123], v[40:55]
  ds_read_b128 v[116:119], v27 offset:4096
  ds_read_b64_tr_b16 v[132:133], v29 offset:8192
  ds_read_b64_tr_b16 v[134:135], v29 offset:9216
  v_mfma_f32_32x32x16_bf16 v[56:71], v[144:147], v[120:123], v[56:71]
  ds_read_b64_tr_b16 v[136:137], v30 offset:8192
  ds_read_b64_tr_b16 v[138:139], v30 offset:9216
  s_waitcnt lgkmcnt(5)
  v_mfma_f32_32x32x16_bf16 v[40:55], v[124:127], v[112:115], v[40:55]
  ds_read_b128 v[120:123], v27 offset:5120
  ds_read_b64_tr_b16 v[140:141], v29 offset:10240
  ds_read_b64_tr_b16 v[142:143], v29 offset:11264
  v_mfma_f32_32x32x16_bf16 v[56:71], v[128:131], v[112:115], v[56:71]
  ds_read_b64_tr_b16 v[144:145], v30 offset:10240
  ds_read_b64_tr_b16 v[146:147], v30 offset:11264
  s_waitcnt lgkmcnt(5)
  v_mfma_f32_32x32x16_bf16 v[40:55], v[132:135], v[116:119], v[40:55]
  ds_read_b128 v[112:115], v27 offset:6144
  ds_read_b64_tr_b16 v[124:125], v29 offset:12288
  ds_read_b64_tr_b16 v[126:127], v29 offset:13312
  v_mfma_f32_32x32x16_bf16 v[56:71], v[136:139], v[116:119], v[56:71]
  ds_read_b64_tr_b16 v[128:129], v30 offset:12288
  ds_read_b64_tr_b16 v[130:131], v30 offset:13312
  s_waitcnt lgkmcnt(5)
  v_mfma_f32_32x32x16_bf16 v[40:55], v[140:143], v[120:123], v[40:55]
  ds_read_b128 v[116:119], v27 offset:7168
  ds_read_b64_tr_b16 v[132:133], v29 offset:14336
  ds_read_b64_tr_b16 v[134:135], v29 offset:15360
  v_mfma_f32_32x32x16_bf16 v[56:71], v[144:147], v[120:123], v[56:71]
  ds_read_b64_tr_b16 v[136:137], v30 offset:14336
  ds_read_b64_tr_b16 v[138:139], v30 offset:15360
  s_waitcnt lgkmcnt(5)
  s_barrier
  v_mfma_f32_32x32x16_bf16 v[40:55], v[124:127], v[112:115], v[40:55]
  ds_read_b128 v[120:123], v27 offset:8192
  ds_read_b64_tr_b16 v[140:141], v29 offset:16384
  ds_read_b64_tr_b16 v[142:143], v29 offset:17408
  v_mfma_f32_32x32x16_bf16 v[56:71], v[128:131], v[112:115], v[56:71]
  ds_read_b64_tr_b16 v[144:145], v30 offset:16384
  ds_read_b64_tr_b16 v[146:147], v30 offset:17408
  s_waitcnt lgkmcnt(5)
  v_mfma_f32_32x32x16_bf16 v[40:55], v[132:135], v[116:119], v[40:55]
  ds_read_b128 v[112:115], v27 offset:9216
  ds_read_b64_tr_b16 v[124:125], v29 offset:18432
  ds_read_b64_tr_b16 v[126:127], v29 offset:19456
  v_mfma_f32_32x32x16_bf16 v[56:71], v[136:139], v[116:119], v[56:71]
  ds_read_b64_tr_b16 v[128:129], v30 offset:18432
  ds_read_b64_tr_b16 v[130:131], v30 offset:19456
  s_waitcnt lgkmcnt(5)
  v_mfma_f32_32x32x16_bf16 v[40:55], v[140:143], v[120:123], v[40:55]
  ds_read_b128 v[116:119], v27 offset:10240
  ds_read_b64_tr_b16 v[132:133], v29 offset:20480
  ds_read_b64_tr_b16 v[134:135], v29 offset:21504
  v_mfma_f32_32x32x16_bf16 v[56:71], v[144:147], v[120:123], v[56:71]
  ds_read_b64_tr_b16 v[136:137], v30 offset:20480
  ds_read_b64_tr_b16 v[138:139], v30 offset:21504
  s_waitcnt lgkmcnt(5)
  v_mfma_f32_32x32x16_bf16 v[40:55], v[124:127], v[112:115], v[40:55]
  ds_read_b128 v[120:123], v27 offset:11264
  ds_read_b64_tr_b16 v[140:141], v29 offset:22528
  ds_read_b64_tr_b16 v[142:143], v29 offset:23552
  v_mfma_f32_32x32x16_bf16 v[56:71], v[128:131], v[112:115], v[56:71]
  ds_read_b64_tr_b16 v[144:145], v30 offset:22528
  ds_read_b64_tr_b16 v[146:147], v30 offset:23552
  s_waitcnt lgkmcnt(5)
  s_barrier
  v_mfma_f32_32x32x16_bf16 v[40:55], v[132:135], v[116:119], v[40:55]
  ds_read_b128 v[112:115], v27 offset:12288
  ds_read_b64_tr_b16 v[124:125], v29 offset:24576
  ds_read_b64_tr_b16 v[126:127], v29 offset:25600
  v_mfma_f32_32x32x16_bf16 v[56:71], v[136:139], v[116:119], v[56:71]
  ds_read_b64_tr_b16 v[128:129], v30 offset:24576
  ds_read_b64_tr_b16 v[130:131], v30 offset:25600
  s_waitcnt lgkmcnt(5)
  v_mfma_f32_32x32x16_bf16 v[40:55], v[140:143], v[120:123], v[40:55]
  ds_read_b128 v[116:119], v27 offset:13312
  ds_read_b64_tr_b16 v[132:133], v29 offset:26624
  ds_read_b64_tr_b16 v[134:135], v29 offset:27648
  v_mfma_f32_32x32x16_bf16 v[56:71], v[144:147], v[120:123], v[56:71]
  ds_read_b64_tr_b16 v[136:137], v30 offset:26624
  ds_read_b64_tr_b16 v[138:139], v30 offset:27648
  s_waitcnt lgkmcnt(5)
  v_mfma_f32_32x32x16_bf16 v[40:55], v[124:127], v[112:115], v[40:55]
  ds_read_b128 v[120:123], v27 offset:14336
  ds_read_b64_tr_b16 v[140:141], v29 offset:28672
  ds_read_b64_tr_b16 v[142:143], v29 offset:29696
  v_mfma_f32_32x32x16_bf16 v[56:71], v[128:131], v[112:115], v[56:71]
  ds_read_b64_tr_b16 v[144:145], v30 offset:28672
  ds_read_b64_tr_b16 v[146:147], v30 offset:29696
  s_waitcnt lgkmcnt(5)
  v_mfma_f32_32x32x16_bf16 v[40:55], v[132:135], v[116:119], v[40:55]
  ds_read_b128 v[112:115], v27 offset:15360
  ds_read_b64_tr_b16 v[124:125], v29 offset:30720
  ds_read_b64_tr_b16 v[126:127], v29 offset:31744
  v_mfma_f32_32x32x16_bf16 v[56:71], v[136:139], v[116:119], v[56:71]
  ds_read_b64_tr_b16 v[128:129], v30 offset:30720
  ds_read_b64_tr_b16 v[130:131], v30 offset:31744
  s_waitcnt lgkmcnt(5)
  s_barrier
  v_mfma_f32_32x32x16_bf16 v[40:55], v[140:143], v[120:123], v[40:55]
  ds_read_b128 v[116:119], v27 offset:16384
  ds_read_b64_tr_b16 v[132:133], v29 offset:32768
  ds_read_b64_tr_b16 v[134:135], v29 offset:33792
  v_mfma_f32_32x32x16_bf16 v[56:71], v[144:147], v[120:123], v[56:71]
  ds_read_b64_tr_b16 v[136:137], v30 offset:32768
  ds_read_b64_tr_b16 v[138:139], v30 offset:33792
  s_waitcnt lgkmcnt(5)
  v_mfma_f32_32x32x16_bf16 v[40:55], v[124:127], v[112:115], v[40:55]
  ds_read_b128 v[120:123], v27 offset:17408
  ds_read_b64_tr_b16 v[140:141], v29 offset:34816
  ds_read_b64_tr_b16 v[142:143], v29 offset:35840
  v_mfma_f32_32x32x16_bf16 v[56:71], v[128:131], v[112:115], v[56:71]
  ds_read_b64_tr_b16 v[144:145], v30 offset:34816
  ds_read_b64_tr_b16 v[146:147], v30 offset:35840
  s_waitcnt lgkmcnt(5)
  v_mfma_f32_32x32x16_bf16 v[40:55], v[132:135], v[116:119], v[40:55]
  ds_read_b128 v[112:115], v27 offset:18432
  ds_read_b64_tr_b16 v[124:125], v29 offset:36864
  ds_read_b64_tr_b16 v[126:127], v29 offset:37888
  v_mfma_f32_32x32x16_bf16 v[56:71], v[136:139], v[116:119], v[56:71]
  ds_read_b64_tr_b16 v[128:129], v30 offset:36864
  ds_read_b64_tr_b16 v[130:131], v30 offset:37888
  s_waitcnt lgkmcnt(5)
  v_mfma_f32_32x32x16_bf16 v[40:55], v[140:143], v[120:123], v[40:55]
  ds_read_b128 v[116:119], v27 offset:19456
  ds_read_b64_tr_b16 v[132:133], v29 offset:38912
  ds_read_b64_tr_b16 v[134:135], v29 offset:39936
  v_mfma_f32_32x32x16_bf16 v[56:71], v[144:147], v[120:123], v[56:71]
  ds_read_b64_tr_b16 v[136:137], v30 offset:38912
  ds_read_b64_tr_b16 v[138:139], v30 offset:39936
  s_waitcnt lgkmcnt(5)
  s_barrier
  v_mfma_f32_32x32x16_bf16 v[40:55], v[124:127], v[112:115], v[40:55]
  ds_read_b128 v[120:123], v27 offset:20480
  ds_read_b64_tr_b16 v[140:141], v29 offset:0
  ds_read_b64_tr_b16 v[142:143], v29 offset:1024
  v_mfma_f32_32x32x16_bf16 v[56:71], v[128:131], v[112:115], v[56:71]
  ds_read_b64_tr_b16 v[144:145], v30 offset:0
  ds_read_b64_tr_b16 v[146:147], v30 offset:1024
  s_waitcnt lgkmcnt(5)
  v_mfma_f32_32x32x16_bf16 v[40:55], v[132:135], v[116:119], v[40:55]
  ds_read_b128 v[112:115], v27 offset:21504
  ds_read_b64_tr_b16 v[124:125], v29 offset:2048
  ds_read_b64_tr_b16 v[126:127], v29 offset:3072
  v_mfma_f32_32x32x16_bf16 v[56:71], v[136:139], v[116:119], v[56:71]
  ds_read_b64_tr_b16 v[128:129], v30 offset:2048
  ds_read_b64_tr_b16 v[130:131], v30 offset:3072
  s_waitcnt lgkmcnt(5)
  v_mfma_f32_32x32x16_bf16 v[40:55], v[140:143], v[120:123], v[40:55]
  ds_read_b128 v[116:119], v27 offset:22528
  ds_read_b64_tr_b16 v[132:133], v29 offset:4096
  ds_read_b64_tr_b16 v[134:135], v29 offset:5120
  v_mfma_f32_32x32x16_bf16 v[56:71], v[144:147], v[120:123], v[56:71]
  ds_read_b64_tr_b16 v[136:137], v30 offset:4096
  ds_read_b64_tr_b16 v[138:139], v30 offset:5120
  s_waitcnt lgkmcnt(5)
  v_mfma_f32_32x32x16_bf16 v[40:55], v[124:127], v[112:115], v[40:55]
  ds_read_b128 v[120:123], v27 offset:23552
  ds_read_b64_tr_b16 v[140:141], v29 offset:6144
  ds_read_b64_tr_b16 v[142:143], v29 offset:7168
  v_mfma_f32_32x32x16_bf16 v[56:71], v[128:131], v[112:115], v[56:71]
  ds_read_b64_tr_b16 v[144:145], v30 offset:6144
  ds_read_b64_tr_b16 v[146:147], v30 offset:7168
  s_waitcnt lgkmcnt(5)
  s_barrier
  v_mfma_f32_32x32x16_bf16 v[40:55], v[132:135], v[116:119], v[40:55]
  ds_read_b128 v[112:115], v27 offset:24576
  ds_read_b64_tr_b16 v[124:125], v29 offset:8192
  ds_read_b64_tr_b16 v[126:127], v29 offset:9216
  v_mfma_f32_32x32x16_bf16 v[56:71], v[136:139], v[116:119], v[56:71]
  ds_read_b64_tr_b16 v[128:129], v30 offset:8192
  ds_read_b64_tr_b16 v[130:131], v30 offset:9216
  s_waitcnt lgkmcnt(5)
  v_mfma_f32_32x32x16_bf16 v[40:55], v[140:143], v[120:123], v[40:55]
  ds_read_b128 v[116:119], v27 offset:25600
  ds_read_b64_tr_b16 v[132:133], v29 offset:10240
  ds_read_b64_tr_b16 v[134:135], v29 offset:11264
  v_mfma_f32_32x32x16_bf16 v[56:71], v[144:147], v[120:123], v[56:71]
  ds_read_b64_tr_b16 v[136:137], v30 offset:10240
  ds_read_b64_tr_b16 v[138:139], v30 offset:11264
  s_waitcnt lgkmcnt(5)
  v_mfma_f32_32x32x16_bf16 v[40:55], v[124:127], v[112:115], v[40:55]
  ds_read_b128 v[120:123], v27 offset:26624
  ds_read_b64_tr_b16 v[140:141], v29 offset:12288
  ds_read_b64_tr_b16 v[142:143], v29 offset:13312
  v_mfma_f32_32x32x16_bf16 v[56:71], v[128:131], v[112:115], v[56:71]
  ds_read_b64_tr_b16 v[144:145], v30 offset:12288
  ds_read_b64_tr_b16 v[146:147], v30 offset:13312
  s_waitcnt lgkmcnt(5)
  v_mfma_f32_32x32x16_bf16 v[40:55], v[132:135], v[116:119], v[40:55]
  ds_read_b128 v[112:115], v27 offset:27648
  ds_read_b64_tr_b16 v[124:125], v29 offset:14336
  ds_read_b64_tr_b16 v[126:127], v29 offset:15360
  v_mfma_f32_32x32x16_bf16 v[56:71], v[136:139], v[116:119], v[56:71]
  ds_read_b64_tr_b16 v[128:129], v30 offset:14336
  ds_read_b64_tr_b16 v[130:131], v30 offset:15360
  s_waitcnt lgkmcnt(5)
  s_barrier
  v_mfma_f32_32x32x16_bf16 v[40:55], v[140:143], v[120:123], v[40:55]
  v_mfma_f32_32x32x16_bf16 v[56:71], v[144:147], v[120:123], v[56:71]
  s_waitcnt lgkmcnt(0)
  v_mfma_f32_32x32x16_bf16 v[40:55], v[124:127], v[112:115], v[40:55]
  v_mfma_f32_32x32x16_bf16 v[56:71], v[128:131], v[112:115], v[56:71]
  ds_read_b128 v[116:119], v27 offset:0
  ds_read_b64_tr_b16 v[132:133], v29 offset:16384
  ds_read_b64_tr_b16 v[134:135], v29 offset:17408
  ds_read_b64_tr_b16 v[136:137], v30 offset:16384
  ds_read_b64_tr_b16 v[138:139], v30 offset:17408
  ds_read_b128 v[120:123], v27 offset:1024
  ds_read_b64_tr_b16 v[140:141], v29 offset:18432
  ds_read_b64_tr_b16 v[142:143], v29 offset:19456
  ds_read_b64_tr_b16 v[144:145], v30 offset:18432
  ds_read_b64_tr_b16 v[146:147], v30 offset:19456
  ds_read_b128 v[8:11], v148 offset:0
  ds_read_b128 v[12:15], v148 offset:32
  ds_read_b128 v[16:19], v148 offset:64
  ds_read_b128 v[20:23], v148 offset:96
  s_waitcnt lgkmcnt(0)
  v_pk_fma_f32 v[40:41], v[8:9], v[34:35], v[40:41] op_sel_hi:[1,0,1]
  v_pk_fma_f32 v[42:43], v[10:11], v[34:35], v[42:43] op_sel_hi:[1,0,1]
  v_pk_fma_f32 v[44:45], v[12:13], v[34:35], v[44:45] op_sel_hi:[1,0,1]
  v_pk_fma_f32 v[46:47], v[14:15], v[34:35], v[46:47] op_sel_hi:[1,0,1]
  v_pk_fma_f32 v[48:49], v[16:17], v[34:35], v[48:49] op_sel_hi:[1,0,1]
  v_pk_fma_f32 v[50:51], v[18:19], v[34:35], v[50:51] op_sel_hi:[1,0,1]
  v_pk_fma_f32 v[52:53], v[20:21], v[34:35], v[52:53] op_sel_hi:[1,0,1]
  v_pk_fma_f32 v[54:55], v[22:23], v[34:35], v[54:55] op_sel_hi:[1,0,1]
  v_pk_mul_f32 v[104:105], v[40:41], v[40:41]
  v_pk_mul_f32 v[106:107], v[42:43], v[42:43]
  v_pk_mul_f32 v[108:109], v[44:45], v[44:45]
  v_pk_mul_f32 v[110:111], v[46:47], v[46:47]
  v_pk_fma_f32 v[104:105], v[104:105], v[38:39], v[36:37] op_sel_hi:[1,0,0]
  v_pk_fma_f32 v[106:107], v[106:107], v[38:39], v[36:37] op_sel_hi:[1,0,0]
  v_pk_fma_f32 v[108:109], v[108:109], v[38:39], v[36:37] op_sel_hi:[1,0,0]
  v_pk_fma_f32 v[110:111], v[110:111], v[38:39], v[36:37] op_sel_hi:[1,0,0]
  v_pk_mul_f32 v[104:105], v[104:105], v[40:41]
  v_pk_mul_f32 v[106:107], v[106:107], v[42:43]
  v_pk_mul_f32 v[108:109], v[108:109], v[44:45]
  v_pk_mul_f32 v[110:111], v[110:111], v[46:47]
  v_exp_f32 v104, v104
  v_exp_f32 v105, v105
  v_exp_f32 v106, v106
  v_exp_f32 v107, v107
  v_exp_f32 v108, v108
  v_exp_f32 v109, v109
  v_exp_f32 v110, v110
  v_exp_f32 v111, v111
  v_pk_add_f32 v[104:105], v[104:105], 1.0 op_sel_hi:[1,0]
  v_pk_add_f32 v[106:107], v[106:107], 1.0 op_sel_hi:[1,0]
  v_pk_add_f32 v[108:109], v[108:109], 1.0 op_sel_hi:[1,0]
  v_pk_add_f32 v[110:111], v[110:111], 1.0 op_sel_hi:[1,0]
  v_rcp_f32 v104, v104
  v_rcp_f32 v105, v105
  v_rcp_f32 v106, v106
  v_rcp_f32 v107, v107
  v_rcp_f32 v108, v108
  v_rcp_f32 v109, v109
  v_rcp_f32 v110, v110
  v_rcp_f32 v111, v111
  v_pk_mul_f32 v[40:41], v[40:41], v[104:105]
  v_pk_mul_f32 v[42:43], v[42:43], v[106:107]
  v_pk_mul_f32 v[44:45], v[44:45], v[108:109]
  v_pk_mul_f32 v[46:47], v[46:47], v[110:111]
  v_pk_mul_f32 v[104:105], v[48:49], v[48:49]
  v_pk_mul_f32 v[106:107], v[50:51], v[50:51]
  v_pk_mul_f32 v[108:109], v[52:53], v[52:53]
  v_pk_mul_f32 v[110:111], v[54:55], v[54:55]
  v_pk_fma_f32 v[104:105], v[104:105], v[38:39], v[36:37] op_sel_hi:[1,0,0]
  v_pk_fma_f32 v[106:107], v[106:107], v[38:39], v[36:37] op_sel_hi:[1,0,0]
  v_pk_fma_f32 v[108:109], v[108:109], v[38:39], v[36:37] op_sel_hi:[1,0,0]
  v_pk_fma_f32 v[110:111], v[110:111], v[38:39], v[36:37] op_sel_hi:[1,0,0]
  v_pk_mul_f32 v[104:105], v[104:105], v[48:49]
  v_pk_mul_f32 v[106:107], v[106:107], v[50:51]
  v_pk_mul_f32 v[108:109], v[108:109], v[52:53]
  v_pk_mul_f32 v[110:111], v[110:111], v[54:55]
  v_exp_f32 v104, v104
  v_exp_f32 v105, v105
  v_exp_f32 v106, v106
  v_exp_f32 v107, v107
  v_exp_f32 v108, v108
  v_exp_f32 v109, v109
  v_exp_f32 v110, v110
  v_exp_f32 v111, v111
  v_pk_add_f32 v[104:105], v[104:105], 1.0 op_sel_hi:[1,0]
  v_pk_add_f32 v[106:107], v[106:107], 1.0 op_sel_hi:[1,0]
  v_pk_add_f32 v[108:109], v[108:109], 1.0 op_sel_hi:[1,0]
  v_pk_add_f32 v[110:111], v[110:111], 1.0 op_sel_hi:[1,0]
  v_rcp_f32 v104, v104
  v_rcp_f32 v105, v105
  v_rcp_f32 v106, v106
  v_rcp_f32 v107, v107
  v_rcp_f32 v108, v108
  v_rcp_f32 v109, v109
  v_rcp_f32 v110, v110
  v_rcp_f32 v111, v111
  v_pk_mul_f32 v[48:49], v[48:49], v[104:105]
  v_pk_mul_f32 v[50:51], v[50:51], v[106:107]
  v_pk_mul_f32 v[52:53], v[52:53], v[108:109]
  v_pk_mul_f32 v[54:55], v[54:55], v[110:111]
  v_pk_mul_f32 v[40:41], v[40:41], v[32:33] op_sel_hi:[1,0]
  v_pk_mul_f32 v[42:43], v[42:43], v[32:33] op_sel_hi:[1,0]
  v_pk_mul_f32 v[44:45], v[44:45], v[32:33] op_sel_hi:[1,0]
  v_pk_mul_f32 v[46:47], v[46:47], v[32:33] op_sel_hi:[1,0]
  v_pk_mul_f32 v[48:49], v[48:49], v[32:33] op_sel_hi:[1,0]
  v_pk_mul_f32 v[50:51], v[50:51], v[32:33] op_sel_hi:[1,0]
  v_pk_mul_f32 v[52:53], v[52:53], v[32:33] op_sel_hi:[1,0]
  v_pk_mul_f32 v[54:55], v[54:55], v[32:33] op_sel_hi:[1,0]
  v_mov_b32 v150, v40
  v_mov_b32 v151, v41
  v_pk_mul_f32 v[152:153], v[40:41], v[40:41]
  v_pk_add_f32 v[150:151], v[150:151], v[42:43]
  v_pk_fma_f32 v[152:153], v[42:43], v[42:43], v[152:153]
  v_pk_add_f32 v[150:151], v[150:151], v[44:45]
  v_pk_fma_f32 v[152:153], v[44:45], v[44:45], v[152:153]
  v_pk_add_f32 v[150:151], v[150:151], v[46:47]
  v_pk_fma_f32 v[152:153], v[46:47], v[46:47], v[152:153]
  v_pk_add_f32 v[150:151], v[150:151], v[48:49]
  v_pk_fma_f32 v[152:153], v[48:49], v[48:49], v[152:153]
  v_pk_add_f32 v[150:151], v[150:151], v[50:51]
  v_pk_fma_f32 v[152:153], v[50:51], v[50:51], v[152:153]
  v_pk_add_f32 v[150:151], v[150:151], v[52:53]
  v_pk_fma_f32 v[152:153], v[52:53], v[52:53], v[152:153]
  v_pk_add_f32 v[150:151], v[150:151], v[54:55]
  v_pk_fma_f32 v[152:153], v[54:55], v[54:55], v[152:153]
  ds_read_b128 v[8:11], v148 offset:128
  ds_read_b128 v[12:15], v148 offset:160
  ds_read_b128 v[16:19], v148 offset:192
  ds_read_b128 v[20:23], v148 offset:224
  s_waitcnt lgkmcnt(0)
  v_pk_fma_f32 v[56:57], v[8:9], v[34:35], v[56:57] op_sel_hi:[1,0,1]
  v_pk_fma_f32 v[58:59], v[10:11], v[34:35], v[58:59] op_sel_hi:[1,0,1]
  v_pk_fma_f32 v[60:61], v[12:13], v[34:35], v[60:61] op_sel_hi:[1,0,1]
  v_pk_fma_f32 v[62:63], v[14:15], v[34:35], v[62:63] op_sel_hi:[1,0,1]
  v_pk_fma_f32 v[64:65], v[16:17], v[34:35], v[64:65] op_sel_hi:[1,0,1]
  v_pk_fma_f32 v[66:67], v[18:19], v[34:35], v[66:67] op_sel_hi:[1,0,1]
  v_pk_fma_f32 v[68:69], v[20:21], v[34:35], v[68:69] op_sel_hi:[1,0,1]
  v_pk_fma_f32 v[70:71], v[22:23], v[34:35], v[70:71] op_sel_hi:[1,0,1]
  v_pk_mul_f32 v[104:105], v[56:57], v[56:57]
  v_pk_mul_f32 v[106:107], v[58:59], v[58:59]
  v_pk_mul_f32 v[108:109], v[60:61], v[60:61]
  v_pk_mul_f32 v[110:111], v[62:63], v[62:63]
  v_pk_fma_f32 v[104:105], v[104:105], v[38:39], v[36:37] op_sel_hi:[1,0,0]
  v_pk_fma_f32 v[106:107], v[106:107], v[38:39], v[36:37] op_sel_hi:[1,0,0]
  v_pk_fma_f32 v[108:109], v[108:109], v[38:39], v[36:37] op_sel_hi:[1,0,0]
  v_pk_fma_f32 v[110:111], v[110:111], v[38:39], v[36:37] op_sel_hi:[1,0,0]
  v_pk_mul_f32 v[104:105], v[104:105], v[56:57]
  v_pk_mul_f32 v[106:107], v[106:107], v[58:59]
  v_pk_mul_f32 v[108:109], v[108:109], v[60:61]
  v_pk_mul_f32 v[110:111], v[110:111], v[62:63]
  v_exp_f32 v104, v104
  v_exp_f32 v105, v105
  v_exp_f32 v106, v106
  v_exp_f32 v107, v107
  v_exp_f32 v108, v108
  v_exp_f32 v109, v109
  v_exp_f32 v110, v110
  v_exp_f32 v111, v111
  v_pk_add_f32 v[104:105], v[104:105], 1.0 op_sel_hi:[1,0]
  v_pk_add_f32 v[106:107], v[106:107], 1.0 op_sel_hi:[1,0]
  v_pk_add_f32 v[108:109], v[108:109], 1.0 op_sel_hi:[1,0]
  v_pk_add_f32 v[110:111], v[110:111], 1.0 op_sel_hi:[1,0]
  v_rcp_f32 v104, v104
  v_rcp_f32 v105, v105
  v_rcp_f32 v106, v106
  v_rcp_f32 v107, v107
  v_rcp_f32 v108, v108
  v_rcp_f32 v109, v109
  v_rcp_f32 v110, v110
  v_rcp_f32 v111, v111
  v_pk_mul_f32 v[56:57], v[56:57], v[104:105]
  v_pk_mul_f32 v[58:59], v[58:59], v[106:107]
  v_pk_mul_f32 v[60:61], v[60:61], v[108:109]
  v_pk_mul_f32 v[62:63], v[62:63], v[110:111]
  v_pk_mul_f32 v[104:105], v[64:65], v[64:65]
  v_pk_mul_f32 v[106:107], v[66:67], v[66:67]
  v_pk_mul_f32 v[108:109], v[68:69], v[68:69]
  v_pk_mul_f32 v[110:111], v[70:71], v[70:71]
  v_pk_fma_f32 v[104:105], v[104:105], v[38:39], v[36:37] op_sel_hi:[1,0,0]
  v_pk_fma_f32 v[106:107], v[106:107], v[38:39], v[36:37] op_sel_hi:[1,0,0]
  v_pk_fma_f32 v[108:109], v[108:109], v[38:39], v[36:37] op_sel_hi:[1,0,0]
  v_pk_fma_f32 v[110:111], v[110:111], v[38:39], v[36:37] op_sel_hi:[1,0,0]
  v_pk_mul_f32 v[104:105], v[104:105], v[64:65]
  v_pk_mul_f32 v[106:107], v[106:107], v[66:67]
  v_pk_mul_f32 v[108:109], v[108:109], v[68:69]
  v_pk_mul_f32 v[110:111], v[110:111], v[70:71]
  v_exp_f32 v104, v104
  v_exp_f32 v105, v105
  v_exp_f32 v106, v106
  v_exp_f32 v107, v107
  v_exp_f32 v108, v108
  v_exp_f32 v109, v109
  v_exp_f32 v110, v110
  v_exp_f32 v111, v111
  v_pk_add_f32 v[104:105], v[104:105], 1.0 op_sel_hi:[1,0]
  v_pk_add_f32 v[106:107], v[106:107], 1.0 op_sel_hi:[1,0]
  v_pk_add_f32 v[108:109], v[108:109], 1.0 op_sel_hi:[1,0]
  v_pk_add_f32 v[110:111], v[110:111], 1.0 op_sel_hi:[1,0]
  v_rcp_f32 v104, v104
  v_rcp_f32 v105, v105
  v_rcp_f32 v106, v106
  v_rcp_f32 v107, v107
  v_rcp_f32 v108, v108
  v_rcp_f32 v109, v109
  v_rcp_f32 v110, v110
  v_rcp_f32 v111, v111
  v_pk_mul_f32 v[64:65], v[64:65], v[104:105]
  v_pk_mul_f32 v[66:67], v[66:67], v[106:107]
  v_pk_mul_f32 v[68:69], v[68:69], v[108:109]
  v_pk_mul_f32 v[70:71], v[70:71], v[110:111]
  v_pk_mul_f32 v[56:57], v[56:57], v[32:33] op_sel_hi:[1,0]
  v_pk_mul_f32 v[58:59], v[58:59], v[32:33] op_sel_hi:[1,0]
  v_pk_mul_f32 v[60:61], v[60:61], v[32:33] op_sel_hi:[1,0]
  v_pk_mul_f32 v[62:63], v[62:63], v[32:33] op_sel_hi:[1,0]
  v_pk_mul_f32 v[64:65], v[64:65], v[32:33] op_sel_hi:[1,0]
  v_pk_mul_f32 v[66:67], v[66:67], v[32:33] op_sel_hi:[1,0]
  v_pk_mul_f32 v[68:69], v[68:69], v[32:33] op_sel_hi:[1,0]
  v_pk_mul_f32 v[70:71], v[70:71], v[32:33] op_sel_hi:[1,0]
  v_pk_add_f32 v[150:151], v[150:151], v[56:57]
  v_pk_fma_f32 v[152:153], v[56:57], v[56:57], v[152:153]
  v_pk_add_f32 v[150:151], v[150:151], v[58:59]
  v_pk_fma_f32 v[152:153], v[58:59], v[58:59], v[152:153]
  v_pk_add_f32 v[150:151], v[150:151], v[60:61]
  v_pk_fma_f32 v[152:153], v[60:61], v[60:61], v[152:153]
  v_pk_add_f32 v[150:151], v[150:151], v[62:63]
  v_pk_fma_f32 v[152:153], v[62:63], v[62:63], v[152:153]
  v_pk_add_f32 v[150:151], v[150:151], v[64:65]
  v_pk_fma_f32 v[152:153], v[64:65], v[64:65], v[152:153]
  v_pk_add_f32 v[150:151], v[150:151], v[66:67]
  v_pk_fma_f32 v[152:153], v[66:67], v[66:67], v[152:153]
  v_pk_add_f32 v[150:151], v[150:151], v[68:69]
  v_pk_fma_f32 v[152:153], v[68:69], v[68:69], v[152:153]
  v_pk_add_f32 v[150:151], v[150:151], v[70:71]
  v_pk_fma_f32 v[152:153], v[70:71], v[70:71], v[152:153]
  v_add_f32 v150, v150, v151
  v_add_f32 v151, v152, v153
  v_mov_b32 v152, v150
  s_nop 1
  v_permlane32_swap_b32 v150, v152
  v_add_f32 v150, v150, v152
  v_mov_b32 v152, v151
  s_nop 1
  v_permlane32_swap_b32 v151, v152
  v_add_f32 v151, v151, v152
  v_mov_b32 v3, 0x7fc00000
  v_cmp_eq_u32 vcc, -1, v151
  s_nop 1
  v_cndmask_b32 v151, v151, v3, vcc
  v_lshlrev_b32 v154, 3, v5
  s_lshl_b32 s5, s23, 8
  s_add_u32 s7, s34, s5
  s_mov_b32 exec_hi, 0
  buffer_store_dwordx2 v[150:151], v154, s[12:15], s7 offen sc0 sc1
  s_mov_b64 exec, -1
  v_mfma_f32_32x32x16_bf16 v[72:87], v[132:135], v[116:119], 0
  ds_read_b128 v[112:115], v27 offset:2048
  ds_read_b64_tr_b16 v[124:125], v29 offset:20480
  ds_read_b64_tr_b16 v[126:127], v29 offset:21504
  v_mfma_f32_32x32x16_bf16 v[88:103], v[136:139], v[116:119], 0
  ds_read_b64_tr_b16 v[128:129], v30 offset:20480
  ds_read_b64_tr_b16 v[130:131], v30 offset:21504
  v_mfma_f32_32x32x16_bf16 v[72:87], v[140:143], v[120:123], v[72:87]
  ds_read_b128 v[116:119], v27 offset:3072
  ds_read_b64_tr_b16 v[132:133], v29 offset:22528
  ds_read_b64_tr_b16 v[134:135], v29 offset:23552
  v_mfma_f32_32x32x16_bf16 v[88:103], v[144:147], v[120:123], v[88:103]
  ds_read_b64_tr_b16 v[136:137], v30 offset:22528
  ds_read_b64_tr_b16 v[138:139], v30 offset:23552
  s_waitcnt lgkmcnt(5)
  s_barrier
  v_mfma_f32_32x32x16_bf16 v[72:87], v[124:127], v[112:115], v[72:87]
  ds_read_b128 v[120:123], v27 offset:4096
  ds_read_b64_tr_b16 v[140:141], v29 offset:24576
  ds_read_b64_tr_b16 v[142:143], v29 offset:25600
  v_mfma_f32_32x32x16_bf16 v[88:103], v[128:131], v[112:115], v[88:103]
  ds_read_b64_tr_b16 v[144:145], v30 offset:24576
  ds_read_b64_tr_b16 v[146:147], v30 offset:25600
  s_waitcnt lgkmcnt(5)
  v_mfma_f32_32x32x16_bf16 v[72:87], v[132:135], v[116:119], v[72:87]
  ds_read_b128 v[112:115], v27 offset:5120
  ds_read_b64_tr_b16 v[124:125], v29 offset:26624
  ds_read_b64_tr_b16 v[126:127], v29 offset:27648
  v_mfma_f32_32x32x16_bf16 v[88:103], v[136:139], v[116:119], v[88:103]
  ds_read_b64_tr_b16 v[128:129], v30 offset:26624
  ds_read_b64_tr_b16 v[130:131], v30 offset:27648
  s_waitcnt lgkmcnt(5)
  v_mfma_f32_32x32x16_bf16 v[72:87], v[140:143], v[120:123], v[72:87]
  ds_read_b128 v[116:119], v27 offset:6144
  ds_read_b64_tr_b16 v[132:133], v29 offset:28672
  ds_read_b64_tr_b16 v[134:135], v29 offset:29696
  v_mfma_f32_32x32x16_bf16 v[88:103], v[144:147], v[120:123], v[88:103]
  ds_read_b64_tr_b16 v[136:137], v30 offset:28672
  ds_read_b64_tr_b16 v[138:139], v30 offset:29696
  s_waitcnt lgkmcnt(5)
  v_mfma_f32_32x32x16_bf16 v[72:87], v[124:127], v[112:115], v[72:87]
  ds_read_b128 v[120:123], v27 offset:7168
  ds_read_b64_tr_b16 v[140:141], v29 offset:30720
  ds_read_b64_tr_b16 v[142:143], v29 offset:31744
  v_mfma_f32_32x32x16_bf16 v[88:103], v[128:131], v[112:115], v[88:103]
  ds_read_b64_tr_b16 v[144:145], v30 offset:30720
  ds_read_b64_tr_b16 v[146:147], v30 offset:31744
  s_waitcnt lgkmcnt(5)
  s_barrier
  v_mfma_f32_32x32x16_bf16 v[72:87], v[132:135], v[116:119], v[72:87]
  ds_read_b128 v[112:115], v27 offset:8192
  ds_read_b64_tr_b16 v[124:125], v29 offset:32768
  ds_read_b64_tr_b16 v[126:127], v29 offset:33792
  v_mfma_f32_32x32x16_bf16 v[88:103], v[136:139], v[116:119], v[88:103]
  ds_read_b64_tr_b16 v[128:129], v30 offset:32768
  ds_read_b64_tr_b16 v[130:131], v30 offset:33792
  s_waitcnt lgkmcnt(5)
  v_mfma_f32_32x32x16_bf16 v[72:87], v[140:143], v[120:123], v[72:87]
  ds_read_b128 v[116:119], v27 offset:9216
  ds_read_b64_tr_b16 v[132:133], v29 offset:34816
  ds_read_b64_tr_b16 v[134:135], v29 offset:35840
  v_mfma_f32_32x32x16_bf16 v[88:103], v[144:147], v[120:123], v[88:103]
  ds_read_b64_tr_b16 v[136:137], v30 offset:34816
  ds_read_b64_tr_b16 v[138:139], v30 offset:35840
  s_waitcnt lgkmcnt(5)
  v_mfma_f32_32x32x16_bf16 v[72:87], v[124:127], v[112:115], v[72:87]
  ds_read_b128 v[120:123], v27 offset:10240
  ds_read_b64_tr_b16 v[140:141], v29 offset:36864
  ds_read_b64_tr_b16 v[142:143], v29 offset:37888
  v_mfma_f32_32x32x16_bf16 v[88:103], v[128:131], v[112:115], v[88:103]
  ds_read_b64_tr_b16 v[144:145], v30 offset:36864
  ds_read_b64_tr_b16 v[146:147], v30 offset:37888
  s_waitcnt lgkmcnt(5)
  v_mfma_f32_32x32x16_bf16 v[72:87], v[132:135], v[116:119], v[72:87]
  ds_read_b128 v[112:115], v27 offset:11264
  ds_read_b64_tr_b16 v[124:125], v29 offset:38912
  ds_read_b64_tr_b16 v[126:127], v29 offset:39936
  v_mfma_f32_32x32x16_bf16 v[88:103], v[136:139], v[116:119], v[88:103]
  ds_read_b64_tr_b16 v[128:129], v30 offset:38912
  ds_read_b64_tr_b16 v[130:131], v30 offset:39936
  s_waitcnt lgkmcnt(5)
  s_barrier
  v_mfma_f32_32x32x16_bf16 v[72:87], v[140:143], v[120:123], v[72:87]
  ds_read_b128 v[116:119], v27 offset:12288
  ds_read_b64_tr_b16 v[132:133], v29 offset:0
  ds_read_b64_tr_b16 v[134:135], v29 offset:1024
  v_mfma_f32_32x32x16_bf16 v[88:103], v[144:147], v[120:123], v[88:103]
  ds_read_b64_tr_b16 v[136:137], v30 offset:0
  ds_read_b64_tr_b16 v[138:139], v30 offset:1024
  s_waitcnt lgkmcnt(5)
  v_mfma_f32_32x32x16_bf16 v[72:87], v[124:127], v[112:115], v[72:87]
  ds_read_b128 v[120:123], v27 offset:13312
  ds_read_b64_tr_b16 v[140:141], v29 offset:2048
  ds_read_b64_tr_b16 v[142:143], v29 offset:3072
  v_mfma_f32_32x32x16_bf16 v[88:103], v[128:131], v[112:115], v[88:103]
  ds_read_b64_tr_b16 v[144:145], v30 offset:2048
  ds_read_b64_tr_b16 v[146:147], v30 offset:3072
  s_waitcnt lgkmcnt(5)
  v_mfma_f32_32x32x16_bf16 v[72:87], v[132:135], v[116:119], v[72:87]
  ds_read_b128 v[112:115], v27 offset:14336
  ds_read_b64_tr_b16 v[124:125], v29 offset:4096
  ds_read_b64_tr_b16 v[126:127], v29 offset:5120
  v_mfma_f32_32x32x16_bf16 v[88:103], v[136:139], v[116:119], v[88:103]
  ds_read_b64_tr_b16 v[128:129], v30 offset:4096
  ds_read_b64_tr_b16 v[130:131], v30 offset:5120
  s_waitcnt lgkmcnt(5)
  v_mfma_f32_32x32x16_bf16 v[72:87], v[140:143], v[120:123], v[72:87]
  ds_read_b128 v[116:119], v27 offset:15360
  ds_read_b64_tr_b16 v[132:133], v29 offset:6144
  ds_read_b64_tr_b16 v[134:135], v29 offset:7168
  v_mfma_f32_32x32x16_bf16 v[88:103], v[144:147], v[120:123], v[88:103]
  ds_read_b64_tr_b16 v[136:137], v30 offset:6144
  ds_read_b64_tr_b16 v[138:139], v30 offset:7168
  s_waitcnt lgkmcnt(5)
  s_barrier
  v_mfma_f32_32x32x16_bf16 v[72:87], v[124:127], v[112:115], v[72:87]
  ds_read_b128 v[120:123], v27 offset:16384
  ds_read_b64_tr_b16 v[140:141], v29 offset:8192
  ds_read_b64_tr_b16 v[142:143], v29 offset:9216
  v_mfma_f32_32x32x16_bf16 v[88:103], v[128:131], v[112:115], v[88:103]
  ds_read_b64_tr_b16 v[144:145], v30 offset:8192
  ds_read_b64_tr_b16 v[146:147], v30 offset:9216
  s_waitcnt lgkmcnt(5)
  v_mfma_f32_32x32x16_bf16 v[72:87], v[132:135], v[116:119], v[72:87]
  ds_read_b128 v[112:115], v27 offset:17408
  ds_read_b64_tr_b16 v[124:125], v29 offset:10240
  ds_read_b64_tr_b16 v[126:127], v29 offset:11264
  v_mfma_f32_32x32x16_bf16 v[88:103], v[136:139], v[116:119], v[88:103]
  ds_read_b64_tr_b16 v[128:129], v30 offset:10240
  ds_read_b64_tr_b16 v[130:131], v30 offset:11264
  s_waitcnt lgkmcnt(5)
  v_mfma_f32_32x32x16_bf16 v[72:87], v[140:143], v[120:123], v[72:87]
  ds_read_b128 v[116:119], v27 offset:18432
  ds_read_b64_tr_b16 v[132:133], v29 offset:12288
  ds_read_b64_tr_b16 v[134:135], v29 offset:13312
  v_mfma_f32_32x32x16_bf16 v[88:103], v[144:147], v[120:123], v[88:103]
  ds_read_b64_tr_b16 v[136:137], v30 offset:12288
  ds_read_b64_tr_b16 v[138:139], v30 offset:13312
  s_waitcnt lgkmcnt(5)
  v_mfma_f32_32x32x16_bf16 v[72:87], v[124:127], v[112:115], v[72:87]
  ds_read_b128 v[120:123], v27 offset:19456
  ds_read_b64_tr_b16 v[140:141], v29 offset:14336
  ds_read_b64_tr_b16 v[142:143], v29 offset:15360
  v_mfma_f32_32x32x16_bf16 v[88:103], v[128:131], v[112:115], v[88:103]
  ds_read_b64_tr_b16 v[144:145], v30 offset:14336
  ds_read_b64_tr_b16 v[146:147], v30 offset:15360
  s_waitcnt lgkmcnt(5)
  s_barrier
  v_mfma_f32_32x32x16_bf16 v[72:87], v[132:135], v[116:119], v[72:87]
  ds_read_b128 v[112:115], v27 offset:20480
  ds_read_b64_tr_b16 v[124:125], v29 offset:16384
  ds_read_b64_tr_b16 v[126:127], v29 offset:17408
  v_mfma_f32_32x32x16_bf16 v[88:103], v[136:139], v[116:119], v[88:103]
  ds_read_b64_tr_b16 v[128:129], v30 offset:16384
  ds_read_b64_tr_b16 v[130:131], v30 offset:17408
  s_waitcnt lgkmcnt(5)
  v_mfma_f32_32x32x16_bf16 v[72:87], v[140:143], v[120:123], v[72:87]
  ds_read_b128 v[116:119], v27 offset:21504
  ds_read_b64_tr_b16 v[132:133], v29 offset:18432
  ds_read_b64_tr_b16 v[134:135], v29 offset:19456
  v_mfma_f32_32x32x16_bf16 v[88:103], v[144:147], v[120:123], v[88:103]
  ds_read_b64_tr_b16 v[136:137], v30 offset:18432
  ds_read_b64_tr_b16 v[138:139], v30 offset:19456
  s_waitcnt lgkmcnt(5)
  v_mfma_f32_32x32x16_bf16 v[72:87], v[124:127], v[112:115], v[72:87]
  ds_read_b128 v[120:123], v27 offset:22528
  ds_read_b64_tr_b16 v[140:141], v29 offset:20480
  ds_read_b64_tr_b16 v[142:143], v29 offset:21504
  v_mfma_f32_32x32x16_bf16 v[88:103], v[128:131], v[112:115], v[88:103]
  ds_read_b64_tr_b16 v[144:145], v30 offset:20480
  ds_read_b64_tr_b16 v[146:147], v30 offset:21504
  s_waitcnt lgkmcnt(5)
  v_mfma_f32_32x32x16_bf16 v[72:87], v[132:135], v[116:119], v[72:87]
  ds_read_b128 v[112:115], v27 offset:23552
  ds_read_b64_tr_b16 v[124:125], v29 offset:22528
  ds_read_b64_tr_b16 v[126:127], v29 offset:23552
  v_mfma_f32_32x32x16_bf16 v[88:103], v[136:139], v[116:119], v[88:103]
  ds_read_b64_tr_b16 v[128:129], v30 offset:22528
  ds_read_b64_tr_b16 v[130:131], v30 offset:23552
  s_waitcnt lgkmcnt(5)
  s_barrier
  v_mfma_f32_32x32x16_bf16 v[72:87], v[140:143], v[120:123], v[72:87]
  ds_read_b128 v[116:119], v27 offset:24576
  ds_read_b64_tr_b16 v[132:133], v29 offset:24576
  ds_read_b64_tr_b16 v[134:135], v29 offset:25600
  v_mfma_f32_32x32x16_bf16 v[88:103], v[144:147], v[120:123], v[88:103]
  ds_read_b64_tr_b16 v[136:137], v30 offset:24576
  ds_read_b64_tr_b16 v[138:139], v30 offset:25600
  s_waitcnt lgkmcnt(5)
  v_mfma_f32_32x32x16_bf16 v[72:87], v[124:127], v[112:115], v[72:87]
  ds_read_b128 v[120:123], v27 offset:25600
  ds_read_b64_tr_b16 v[140:141], v29 offset:26624
  ds_read_b64_tr_b16 v[142:143], v29 offset:27648
  v_mfma_f32_32x32x16_bf16 v[88:103], v[128:131], v[112:115], v[88:103]
  ds_read_b64_tr_b16 v[144:145], v30 offset:26624
  ds_read_b64_tr_b16 v[146:147], v30 offset:27648
  s_waitcnt lgkmcnt(5)
  v_mfma_f32_32x32x16_bf16 v[72:87], v[132:135], v[116:119], v[72:87]
  ds_read_b128 v[112:115], v27 offset:26624
  ds_read_b64_tr_b16 v[124:125], v29 offset:28672
  ds_read_b64_tr_b16 v[126:127], v29 offset:29696
  v_mfma_f32_32x32x16_bf16 v[88:103], v[136:139], v[116:119], v[88:103]
  ds_read_b64_tr_b16 v[128:129], v30 offset:28672
  ds_read_b64_tr_b16 v[130:131], v30 offset:29696
  s_waitcnt lgkmcnt(5)
  v_mfma_f32_32x32x16_bf16 v[72:87], v[140:143], v[120:123], v[72:87]
  ds_read_b128 v[116:119], v27 offset:27648
  ds_read_b64_tr_b16 v[132:133], v29 offset:30720
  ds_read_b64_tr_b16 v[134:135], v29 offset:31744
  v_mfma_f32_32x32x16_bf16 v[88:103], v[144:147], v[120:123], v[88:103]
  ds_read_b64_tr_b16 v[136:137], v30 offset:30720
  ds_read_b64_tr_b16 v[138:139], v30 offset:31744
  s_waitcnt lgkmcnt(5)
  v_mfma_f32_32x32x16_bf16 v[72:87], v[124:127], v[112:115], v[72:87]
  v_mfma_f32_32x32x16_bf16 v[88:103], v[128:131], v[112:115], v[88:103]
  s_waitcnt lgkmcnt(0)
  v_mfma_f32_32x32x16_bf16 v[72:87], v[132:135], v[116:119], v[72:87]
  v_mfma_f32_32x32x16_bf16 v[88:103], v[136:139], v[116:119], v[88:103]
  buffer_load_dwordx2 v[156:157], v24, s[12:15], s34 offen offset:0 sc0 sc1
  buffer_load_dwordx2 v[158:159], v24, s[12:15], s34 offen offset:512 sc0 sc1
  buffer_load_dwordx2 v[160:161], v24, s[12:15], s34 offen offset:1024 sc0 sc1
  buffer_load_dwordx2 v[162:163], v24, s[12:15], s34 offen offset:1536 sc0 sc1
  buffer_load_dwordx2 v[164:165], v24, s[12:15], s34 offen offset:2048 sc0 sc1
  buffer_load_dwordx2 v[166:167], v24, s[12:15], s34 offen offset:2560 sc0 sc1
  buffer_load_dwordx2 v[168:169], v24, s[12:15], s34 offen offset:3072 sc0 sc1
  s_lshl_b32 s44, s23, 1
  ds_read_b128 v[8:11], v148 offset:256
  ds_read_b128 v[12:15], v148 offset:288
  ds_read_b128 v[16:19], v148 offset:320
  ds_read_b128 v[20:23], v148 offset:352
  s_waitcnt lgkmcnt(0)
  v_pk_fma_f32 v[72:73], v[8:9], v[34:35], v[72:73] op_sel_hi:[1,0,1]
  v_pk_fma_f32 v[74:75], v[10:11], v[34:35], v[74:75] op_sel_hi:[1,0,1]
  v_pk_fma_f32 v[76:77], v[12:13], v[34:35], v[76:77] op_sel_hi:[1,0,1]
  v_pk_fma_f32 v[78:79], v[14:15], v[34:35], v[78:79] op_sel_hi:[1,0,1]
  v_pk_fma_f32 v[80:81], v[16:17], v[34:35], v[80:81] op_sel_hi:[1,0,1]
  v_pk_fma_f32 v[82:83], v[18:19], v[34:35], v[82:83] op_sel_hi:[1,0,1]
  v_pk_fma_f32 v[84:85], v[20:21], v[34:35], v[84:85] op_sel_hi:[1,0,1]
  v_pk_fma_f32 v[86:87], v[22:23], v[34:35], v[86:87] op_sel_hi:[1,0,1]
  v_pk_mul_f32 v[104:105], v[72:73], v[72:73]
  v_pk_mul_f32 v[106:107], v[74:75], v[74:75]
  v_pk_mul_f32 v[108:109], v[76:77], v[76:77]
  v_pk_mul_f32 v[110:111], v[78:79], v[78:79]
  v_pk_fma_f32 v[104:105], v[104:105], v[38:39], v[36:37] op_sel_hi:[1,0,0]
  v_pk_fma_f32 v[106:107], v[106:107], v[38:39], v[36:37] op_sel_hi:[1,0,0]
  v_pk_fma_f32 v[108:109], v[108:109], v[38:39], v[36:37] op_sel_hi:[1,0,0]
  v_pk_fma_f32 v[110:111], v[110:111], v[38:39], v[36:37] op_sel_hi:[1,0,0]
  v_pk_mul_f32 v[104:105], v[104:105], v[72:73]
  v_pk_mul_f32 v[106:107], v[106:107], v[74:75]
  v_pk_mul_f32 v[108:109], v[108:109], v[76:77]
  v_pk_mul_f32 v[110:111], v[110:111], v[78:79]
  v_exp_f32 v104, v104
  v_exp_f32 v105, v105
  v_exp_f32 v106, v106
  v_exp_f32 v107, v107
  v_exp_f32 v108, v108
  v_exp_f32 v109, v109
  v_exp_f32 v110, v110
  v_exp_f32 v111, v111
  v_pk_add_f32 v[104:105], v[104:105], 1.0 op_sel_hi:[1,0]
  v_pk_add_f32 v[106:107], v[106:107], 1.0 op_sel_hi:[1,0]
  v_pk_add_f32 v[108:109], v[108:109], 1.0 op_sel_hi:[1,0]
  v_pk_add_f32 v[110:111], v[110:111], 1.0 op_sel_hi:[1,0]
  v_rcp_f32 v104, v104
  v_rcp_f32 v105, v105
  v_rcp_f32 v106, v106
  v_rcp_f32 v107, v107
  v_rcp_f32 v108, v108
  v_rcp_f32 v109, v109
  v_rcp_f32 v110, v110
  v_rcp_f32 v111, v111
  v_pk_mul_f32 v[72:73], v[72:73], v[104:105]
  v_pk_mul_f32 v[74:75], v[74:75], v[106:107]
  v_pk_mul_f32 v[76:77], v[76:77], v[108:109]
  v_pk_mul_f32 v[78:79], v[78:79], v[110:111]
  v_pk_mul_f32 v[104:105], v[80:81], v[80:81]
  v_pk_mul_f32 v[106:107], v[82:83], v[82:83]
  v_pk_mul_f32 v[108:109], v[84:85], v[84:85]
  v_pk_mul_f32 v[110:111], v[86:87], v[86:87]
  v_pk_fma_f32 v[104:105], v[104:105], v[38:39], v[36:37] op_sel_hi:[1,0,0]
  v_pk_fma_f32 v[106:107], v[106:107], v[38:39], v[36:37] op_sel_hi:[1,0,0]
  v_pk_fma_f32 v[108:109], v[108:109], v[38:39], v[36:37] op_sel_hi:[1,0,0]
  v_pk_fma_f32 v[110:111], v[110:111], v[38:39], v[36:37] op_sel_hi:[1,0,0]
  v_pk_mul_f32 v[104:105], v[104:105], v[80:81]
  v_pk_mul_f32 v[106:107], v[106:107], v[82:83]
  v_pk_mul_f32 v[108:109], v[108:109], v[84:85]
  v_pk_mul_f32 v[110:111], v[110:111], v[86:87]
  v_exp_f32 v104, v104
  v_exp_f32 v105, v105
  v_exp_f32 v106, v106
  v_exp_f32 v107, v107
  v_exp_f32 v108, v108
  v_exp_f32 v109, v109
  v_exp_f32 v110, v110
  v_exp_f32 v111, v111
  v_pk_add_f32 v[104:105], v[104:105], 1.0 op_sel_hi:[1,0]
  v_pk_add_f32 v[106:107], v[106:107], 1.0 op_sel_hi:[1,0]
  v_pk_add_f32 v[108:109], v[108:109], 1.0 op_sel_hi:[1,0]
  v_pk_add_f32 v[110:111], v[110:111], 1.0 op_sel_hi:[1,0]
  v_rcp_f32 v104, v104
  v_rcp_f32 v105, v105
  v_rcp_f32 v106, v106
  v_rcp_f32 v107, v107
  v_rcp_f32 v108, v108
  v_rcp_f32 v109, v109
  v_rcp_f32 v110, v110
  v_rcp_f32 v111, v111
  v_pk_mul_f32 v[80:81], v[80:81], v[104:105]
  v_pk_mul_f32 v[82:83], v[82:83], v[106:107]
  v_pk_mul_f32 v[84:85], v[84:85], v[108:109]
  v_pk_mul_f32 v[86:87], v[86:87], v[110:111]
  v_cvt_pk_bf16_f32 v172, v72, v73
  v_cvt_pk_bf16_f32 v173, v74, v75
  v_cvt_pk_bf16_f32 v174, v76, v77
  v_cvt_pk_bf16_f32 v175, v78, v79
  v_cvt_pk_bf16_f32 v176, v80, v81
  v_cvt_pk_bf16_f32 v177, v82, v83
  v_cvt_pk_bf16_f32 v178, v84, v85
  v_cvt_pk_bf16_f32 v179, v86, v87
  s_mul_i32 s7, s25, 57344
  s_add_u32 s5, s44, 0
  s_lshl_b32 s5, s5, 11
  s_add_u32 s7, s7, s5
  s_add_u32 s7, s7, 0xb00000
  buffer_store_dwordx4 v[172:175], v28, s[12:15], s7 offen sc1
  buffer_store_dwordx4 v[176:179], v28, s[12:15], s7 offen offset:1024 sc1
  ds_read_b128 v[8:11], v148 offset:384
  ds_read_b128 v[12:15], v148 offset:416
  ds_read_b128 v[16:19], v148 offset:448
  ds_read_b128 v[20:23], v148 offset:480
  s_waitcnt lgkmcnt(0)
  v_pk_fma_f32 v[88:89], v[8:9], v[34:35], v[88:89] op_sel_hi:[1,0,1]
  v_pk_fma_f32 v[90:91], v[10:11], v[34:35], v[90:91] op_sel_hi:[1,0,1]
  v_pk_fma_f32 v[92:93], v[12:13], v[34:35], v[92:93] op_sel_hi:[1,0,1]
  v_pk_fma_f32 v[94:95], v[14:15], v[34:35], v[94:95] op_sel_hi:[1,0,1]
  v_pk_fma_f32 v[96:97], v[16:17], v[34:35], v[96:97] op_sel_hi:[1,0,1]
  v_pk_fma_f32 v[98:99], v[18:19], v[34:35], v[98:99] op_sel_hi:[1,0,1]
  v_pk_fma_f32 v[100:101], v[20:21], v[34:35], v[100:101] op_sel_hi:[1,0,1]
  v_pk_fma_f32 v[102:103], v[22:23], v[34:35], v[102:103] op_sel_hi:[1,0,1]
  v_pk_mul_f32 v[104:105], v[88:89], v[88:89]
  v_pk_mul_f32 v[106:107], v[90:91], v[90:91]
  v_pk_mul_f32 v[108:109], v[92:93], v[92:93]
  v_pk_mul_f32 v[110:111], v[94:95], v[94:95]
  v_pk_fma_f32 v[104:105], v[104:105], v[38:39], v[36:37] op_sel_hi:[1,0,0]
  v_pk_fma_f32 v[106:107], v[106:107], v[38:39], v[36:37] op_sel_hi:[1,0,0]
  v_pk_fma_f32 v[108:109], v[108:109], v[38:39], v[36:37] op_sel_hi:[1,0,0]
  v_pk_fma_f32 v[110:111], v[110:111], v[38:39], v[36:37] op_sel_hi:[1,0,0]
  v_pk_mul_f32 v[104:105], v[104:105], v[88:89]
  v_pk_mul_f32 v[106:107], v[106:107], v[90:91]
  v_pk_mul_f32 v[108:109], v[108:109], v[92:93]
  v_pk_mul_f32 v[110:111], v[110:111], v[94:95]
  v_exp_f32 v104, v104
  v_exp_f32 v105, v105
  v_exp_f32 v106, v106
  v_exp_f32 v107, v107
  v_exp_f32 v108, v108
  v_exp_f32 v109, v109
  v_exp_f32 v110, v110
  v_exp_f32 v111, v111
  v_pk_add_f32 v[104:105], v[104:105], 1.0 op_sel_hi:[1,0]
  v_pk_add_f32 v[106:107], v[106:107], 1.0 op_sel_hi:[1,0]
  v_pk_add_f32 v[108:109], v[108:109], 1.0 op_sel_hi:[1,0]
  v_pk_add_f32 v[110:111], v[110:111], 1.0 op_sel_hi:[1,0]
  v_rcp_f32 v104, v104
  v_rcp_f32 v105, v105
  v_rcp_f32 v106, v106
  v_rcp_f32 v107, v107
  v_rcp_f32 v108, v108
  v_rcp_f32 v109, v109
  v_rcp_f32 v110, v110
  v_rcp_f32 v111, v111
  v_pk_mul_f32 v[88:89], v[88:89], v[104:105]
  v_pk_mul_f32 v[90:91], v[90:91], v[106:107]
  v_pk_mul_f32 v[92:93], v[92:93], v[108:109]
  v_pk_mul_f32 v[94:95], v[94:95], v[110:111]
  v_pk_mul_f32 v[104:105], v[96:97], v[96:97]
  v_pk_mul_f32 v[106:107], v[98:99], v[98:99]
  v_pk_mul_f32 v[108:109], v[100:101], v[100:101]
  v_pk_mul_f32 v[110:111], v[102:103], v[102:103]
  v_pk_fma_f32 v[104:105], v[104:105], v[38:39], v[36:37] op_sel_hi:[1,0,0]
  v_pk_fma_f32 v[106:107], v[106:107], v[38:39], v[36:37] op_sel_hi:[1,0,0]
  v_pk_fma_f32 v[108:109], v[108:109], v[38:39], v[36:37] op_sel_hi:[1,0,0]
  v_pk_fma_f32 v[110:111], v[110:111], v[38:39], v[36:37] op_sel_hi:[1,0,0]
  v_pk_mul_f32 v[104:105], v[104:105], v[96:97]
  v_pk_mul_f32 v[106:107], v[106:107], v[98:99]
  v_pk_mul_f32 v[108:109], v[108:109], v[100:101]
  v_pk_mul_f32 v[110:111], v[110:111], v[102:103]
  v_exp_f32 v104, v104
  v_exp_f32 v105, v105
  v_exp_f32 v106, v106
  v_exp_f32 v107, v107
  v_exp_f32 v108, v108
  v_exp_f32 v109, v109
  v_exp_f32 v110, v110
  v_exp_f32 v111, v111
  v_pk_add_f32 v[104:105], v[104:105], 1.0 op_sel_hi:[1,0]
  v_pk_add_f32 v[106:107], v[106:107], 1.0 op_sel_hi:[1,0]
  v_pk_add_f32 v[108:109], v[108:109], 1.0 op_sel_hi:[1,0]
  v_pk_add_f32 v[110:111], v[110:111], 1.0 op_sel_hi:[1,0]
  v_rcp_f32 v104, v104
  v_rcp_f32 v105, v105
  v_rcp_f32 v106, v106
  v_rcp_f32 v107, v107
  v_rcp_f32 v108, v108
  v_rcp_f32 v109, v109
  v_rcp_f32 v110, v110
  v_rcp_f32 v111, v111
  v_pk_mul_f32 v[96:97], v[96:97], v[104:105]
  v_pk_mul_f32 v[98:99], v[98:99], v[106:107]
  v_pk_mul_f32 v[100:101], v[100:101], v[108:109]
  v_pk_mul_f32 v[102:103], v[102:103], v[110:111]
  v_cvt_pk_bf16_f32 v180, v88, v89
  v_cvt_pk_bf16_f32 v181, v90, v91
  v_cvt_pk_bf16_f32 v182, v92, v93
  v_cvt_pk_bf16_f32 v183, v94, v95
  v_cvt_pk_bf16_f32 v184, v96, v97
  v_cvt_pk_bf16_f32 v185, v98, v99
  v_cvt_pk_bf16_f32 v186, v100, v101
  v_cvt_pk_bf16_f32 v187, v102, v103
  s_mul_i32 s7, s25, 57344
  s_add_u32 s5, s44, 1
  s_lshl_b32 s5, s5, 11
  s_add_u32 s7, s7, s5
  s_add_u32 s7, s7, 0xb00000
  buffer_store_dwordx4 v[180:183], v28, s[12:15], s7 offen sc1
  buffer_store_dwordx4 v[184:187], v28, s[12:15], s7 offen offset:1024 sc1
  s_mov_b32 s45, 0
  s_waitcnt vmcnt(4)
  s_branch k4_win_kernel_pchk_9
k4_win_kernel_poll_7:
  buffer_load_dwordx2 v[156:157], v24, s[12:15], s34 offen offset:0 sc0 sc1
  buffer_load_dwordx2 v[158:159], v24, s[12:15], s34 offen offset:512 sc0 sc1
  buffer_load_dwordx2 v[160:161], v24, s[12:15], s34 offen offset:1024 sc0 sc1
  buffer_load_dwordx2 v[162:163], v24, s[12:15], s34 offen offset:1536 sc0 sc1
  buffer_load_dwordx2 v[164:165], v24, s[12:15], s34 offen offset:2048 sc0 sc1
  buffer_load_dwordx2 v[166:167], v24, s[12:15], s34 offen offset:2560 sc0 sc1
  buffer_load_dwordx2 v[168:169], v24, s[12:15], s34 offen offset:3072 sc0 sc1
  s_waitcnt vmcnt(0)
k4_win_kernel_pchk_9:
  v_max_u32 v2, v157, v159
  v_max_u32 v2, v2, v161
  v_max_u32 v2, v2, v163
  v_max_u32 v2, v2, v165
  v_max_u32 v2, v2, v167
  v_max_u32 v2, v2, v169
  v_cmp_eq_u32 vcc, -1, v2
  s_add_u32 s45, s45, 1
  s_nop 0
  s_cmp_eq_u64 vcc, 0
  s_cbranch_scc1 k4_win_kernel_pdone_8
  s_cmp_lt_u32 s45, 262144
  s_cbranch_scc0 k4_win_kernel_pdone_8
  s_sleep 1
  s_branch k4_win_kernel_poll_7
k4_win_kernel_pdone_8:
  v_pk_add_f32 v[156:157], v[156:157], v[162:163]
  v_pk_add_f32 v[158:159], v[158:159], v[164:165]
  v_pk_add_f32 v[160:161], v[160:161], v[166:167]
  v_pk_add_f32 v[156:157], v[156:157], v[168:169]
  v_pk_add_f32 v[158:159], v[158:159], v[160:161]
  v_pk_add_f32 v[156:157], v[156:157], v[158:159]
  v_mov_b32 v158, v156
  s_nop 1
  v_permlane32_swap_b32 v156, v158
  v_add_f32 v156, v156, v158
  v_mov_b32 v158, v157
  s_nop 1
  v_permlane32_swap_b32 v157, v158
  v_add_f32 v157, v157, v158
  v_mul_f32 v190, 0xba924925, v156
  v_mul_f32 v157, 0x3a924925, v157
  v_fma_f32 v157, -v190, v190, v157
  v_max_f32 v157, 0, v157
  v_add_f32 v157, 0x3727c5ac, v157
  v_rsq_f32 v188, v157
  s_nop 0
  v_mul_f32 v190, v190, v188
  s_mul_i32 s5, s4, 28672
  v_mul_u32_u24 v192, 136, v5
  v_lshl_add_u32 v192, v6, 3, v192
  v_add_u32 v192, s5, v192
  v_pk_fma_f32 v[40:41], v[40:41], v[188:189], v[190:191] op_sel_hi:[1,0,0]
  v_pk_fma_f32 v[42:43], v[42:43], v[188:189], v[190:191] op_sel_hi:[1,0,0]
  v_pk_fma_f32 v[44:45], v[44:45], v[188:189], v[190:191] op_sel_hi:[1,0,0]
  v_pk_fma_f32 v[46:47], v[46:47], v[188:189], v[190:191] op_sel_hi:[1,0,0]
  v_pk_fma_f32 v[48:49], v[48:49], v[188:189], v[190:191] op_sel_hi:[1,0,0]
  v_pk_fma_f32 v[50:51], v[50:51], v[188:189], v[190:191] op_sel_hi:[1,0,0]
  v_pk_fma_f32 v[52:53], v[52:53], v[188:189], v[190:191] op_sel_hi:[1,0,0]
  v_pk_fma_f32 v[54:55], v[54:55], v[188:189], v[190:191] op_sel_hi:[1,0,0]
  v_cvt_pk_bf16_f32 v172, v40, v41
  v_cvt_pk_bf16_f32 v173, v42, v43
  v_cvt_pk_bf16_f32 v174, v44, v45
  v_cvt_pk_bf16_f32 v175, v46, v47
  v_cvt_pk_bf16_f32 v176, v48, v49
  v_cvt_pk_bf16_f32 v177, v50, v51
  v_cvt_pk_bf16_f32 v178, v52, v53
  v_cvt_pk_bf16_f32 v179, v54, v55
  ds_write_b64 v192, v[172:173] offset:0
  ds_write_b64 v192, v[174:175] offset:16
  ds_write_b64 v192, v[176:177] offset:32
  ds_write_b64 v192, v[178:179] offset:48
  v_pk_fma_f32 v[56:57], v[56:57], v[188:189], v[190:191] op_sel_hi:[1,0,0]
  v_pk_fma_f32 v[58:59], v[58:59], v[188:189], v[190:191] op_sel_hi:[1,0,0]
  v_pk_fma_f32 v[60:61], v[60:61], v[188:189], v[190:191] op_sel_hi:[1,0,0]
  v_pk_fma_f32 v[62:63], v[62:63], v[188:189], v[190:191] op_sel_hi:[1,0,0]
  v_pk_fma_f32 v[64:65], v[64:65], v[188:189], v[190:191] op_sel_hi:[1,0,0]
  v_pk_fma_f32 v[66:67], v[66:67], v[188:189], v[190:191] op_sel_hi:[1,0,0]
  v_pk_fma_f32 v[68:69], v[68:69], v[188:189], v[190:191] op_sel_hi:[1,0,0]
  v_pk_fma_f32 v[70:71], v[70:71], v[188:189], v[190:191] op_sel_hi:[1,0,0]
  v_cvt_pk_bf16_f32 v180, v56, v57
  v_cvt_pk_bf16_f32 v181, v58, v59
  v_cvt_pk_bf16_f32 v182, v60, v61
  v_cvt_pk_bf16_f32 v183, v62, v63
  v_cvt_pk_bf16_f32 v184, v64, v65
  v_cvt_pk_bf16_f32 v185, v66, v67
  v_cvt_pk_bf16_f32 v186, v68, v69
  v_cvt_pk_bf16_f32 v187, v70, v71
  ds_write_b64 v192, v[180:181] offset:64
  ds_write_b64 v192, v[182:183] offset:80
  ds_write_b64 v192, v[184:185] offset:96
  ds_write_b64 v192, v[186:187] offset:112
  v_bfe_u32 v2, v1, 2, 2
  v_lshl_add_u32 v2, v6, 3, v2
  v_mul_u32_u24 v193, 136, v2
  v_bfe_u32 v2, v1, 4, 1
  v_lshl_add_u32 v193, v2, 5, v193
  v_and_b32 v2, 3, v1
  v_lshl_add_u32 v193, v2, 3, v193
  v_add_u32 v193, s5, v193
  s_waitcnt lgkmcnt(0)
  ds_read_b64_tr_b16 v[72:73], v193 offset:0
  ds_read_b64_tr_b16 v[74:75], v193 offset:544
  ds_read_b64_tr_b16 v[76:77], v193 offset:2176
  ds_read_b64_tr_b16 v[78:79], v193 offset:2720
  ds_read_b64_tr_b16 v[80:81], v193 offset:64
  ds_read_b64_tr_b16 v[82:83], v193 offset:608
  ds_read_b64_tr_b16 v[84:85], v193 offset:2240
  ds_read_b64_tr_b16 v[86:87], v193 offset:2784
  s_lshr_b32 s5, s25, 5
  s_mul_i32 s5, s5, 66816
  s_and_b32 s6, s25, 31
  s_lshl_b32 s6, s6, 11
  s_add_u32 s5, s5, s6
  s_add_u32 s5, s5, 0xf00000
  s_add_u32 s6, s44, 0
  s_mul_i32 s7, s6, 134400
  s_add_u32 s7, s7, s5
  s_waitcnt lgkmcnt(6)
  buffer_store_dwordx4 v[72:75], v28, s[12:15], s7 offen offset:0 sc1
  s_waitcnt lgkmcnt(4)
  buffer_store_dwordx4 v[76:79], v28, s[12:15], s7 offen offset:1024 sc1
  s_add_u32 s6, s44, 1
  s_mul_i32 s7, s6, 134400
  s_add_u32 s7, s7, s5
  s_waitcnt lgkmcnt(2)
  buffer_store_dwordx4 v[80:83], v28, s[12:15], s7 offen offset:0 sc1
  s_waitcnt lgkmcnt(0)
  buffer_store_dwordx4 v[84:87], v28, s[12:15], s7 offen offset:1024 sc1
  s_endpgm
k4_win_kernel_pfrole_2:
  s_load_dwordx2 s[46:47], s[0:1], 40
  s_sub_u32 s5, s21, 28
  s_lshl_b32 s5, s5, 9
  v_add_u32 v194, s5, v0
  s_lshr_b32 s5, s20, 1
  s_lshl_b32 s5, s5, 21
  s_and_b32 s6, s20, 1
  s_lshl_b32 s6, s6, 11
  s_add_u32 s5, s5, s6
  s_waitcnt lgkmcnt(0)
  s_mov_b32 s48, s46
  s_and_b32 s49, s47, 0xffff
  s_mov_b32 s50, 0x800000
  s_mov_b32 s51, 0x20000
  v_add_u32 v2, 0, v194
  v_lshrrev_b32 v3, 4, v2
  v_lshlrev_b32 v3, 12, v3
  v_and_b32 v4, 15, v2
  v_lshl_add_u32 v3, v4, 7, v3
  buffer_load_dword v196, v3, s[48:51], s5 offen
  v_add_u32 v2, 2048, v194
  v_lshrrev_b32 v3, 4, v2
  v_lshlrev_b32 v3, 12, v3
  v_and_b32 v4, 15, v2
  v_lshl_add_u32 v3, v4, 7, v3
  buffer_load_dword v197, v3, s[48:51], s5 offen
  v_add_u32 v2, 4096, v194
  v_lshrrev_b32 v3, 4, v2
  v_lshlrev_b32 v3, 12, v3
  v_and_b32 v4, 15, v2
  v_lshl_add_u32 v3, v4, 7, v3
  buffer_load_dword v198, v3, s[48:51], s5 offen
  v_add_u32 v2, 6144, v194
  v_lshrrev_b32 v3, 4, v2
  v_lshlrev_b32 v3, 12, v3
  v_and_b32 v4, 15, v2
  v_lshl_add_u32 v3, v4, 7, v3
  buffer_load_dword v199, v3, s[48:51], s5 offen
k4_win_kernel_done_1:
  s_endpgm
k4_win_kernel_end:
.globl k5_sp_kernel
.p2align 8
.type k5_sp_kernel,@function
k5_sp_kernel:
  s_cmp_ge_u32 s2, 256
  s_cbranch_scc1 k5_sp_kernel_done_1
  v_lshrrev_b32 v2, 6, v0
  v_and_b32 v1, 63, v0
  v_readfirstlane_b32 s4, v2
  s_load_dwordx2 s[8:9], s[0:1], 40
  s_load_dwordx2 s[10:11], s[0:1], 48
  s_load_dwordx2 s[12:13], s[0:1], 80
  s_and_b32 s28, s2, 7
  s_lshr_b32 s29, s2, 3
  s_cmp_ge_u32 s29, 28
  s_cbranch_scc1 k5_sp_kernel_pfrole_2
  s_and_b32 s33, s4, 3
  s_and_b32 s32, s28, 1
  s_mul_i32 s5, s29, 37
  s_lshr_b32 s5, s5, 8
  s_mul_i32 s6, s5, 7
  s_sub_u32 s31, s29, s6
  s_lshr_b32 s30, s28, 1
  s_lshl_b32 s30, s30, 2
  s_add_u32 s30, s30, s5
  s_cmp_lt_u32 s4, 4
  s_cbranch_scc1 k5_sp_kernel_compute_3
  v_lshlrev_b32 v5, 4, v1
  v_lshrrev_b32 v2, 3, v1
  v_lshlrev_b32 v2, 12, v2
  v_lshrrev_b32 v3, 4, v1
  v_and_b32 v4, 7, v1
  v_xor_b32 v3, v3, v4
  v_lshl_add_u32 v6, v3, 4, v2
  v_xor_b32 v3, 4, v3
  v_lshl_add_u32 v7, v3, 4, v2
  s_lshl_b32 s5, s31, 2
  s_add_u32 s5, s5, s33
  s_mul_i32 s34, s5, 134400
  s_mul_i32 s6, s32, 66816
  s_add_u32 s34, s34, s6
  s_add_u32 s34, s34, 0xf00000
  s_lshl_b32 s36, s33, 12
  s_lshl_b32 s5, s30, 7
  s_lshl_b32 s6, s33, 5
  s_add_u32 s5, s5, s6
  s_lshl_b32 s35, s5, 12
  s_lshl_b32 s6, s32, 11
  s_add_u32 s35, s35, s6
  s_add_u32 s37, s36, 16384
  s_lshl_b32 s5, s31, 1
  s_mul_i32 s6, s30, 5
  s_add_u32 s38, s5, s6
  s_and_b32 s38, s38, 15
  s_mov_b32 s38, 0
  s_lshl_b32 s5, s30, 2
  s_add_u32 s5, s5, s33
  s_mul_i32 s42, s5, 57344
  s_lshl_b32 s6, s31, 13
  s_add_u32 s42, s42, s6
  s_add_u32 s42, s42, 0xb00000
  s_lshl_b32 s43, s33, 13
  s_waitcnt lgkmcnt(0)
  s_mov_b32 s16, s12
  s_and_b32 s17, s13, 0xffff
  s_mov_b32 s18, 0x10000000
  s_mov_b32 s19, 0x20000
  s_mov_b32 s20, s8
  s_and_b32 s21, s9, 0xffff
  s_mov_b32 s22, 0x800000
  s_mov_b32 s23, 0x20000
  s_add_u32 s39, s38, 0
  s_and_b32 s39, s39, 15
  s_lshl_b32 s40, s39, 12
  s_add_u32 s40, s40, s34
  s_lshl_b32 s41, s39, 7
  s_add_u32 s41, s41, s35
  s_add_u32 s7, s40, 0x0
  s_add_u32 m0, s36, 0x0
  s_nop 0
  buffer_load_dwordx4 v5, s[16:19], s7 offen lds
  s_add_u32 s7, s40, 0x400
  s_add_u32 m0, s36, 0x400
  s_nop 0
  buffer_load_dwordx4 v5, s[16:19], s7 offen lds
  s_add_u32 s7, s40, 0x800
  s_add_u32 m0, s36, 0x800
  s_nop 0
  buffer_load_dwordx4 v5, s[16:19], s7 offen lds
  s_add_u32 s7, s40, 0xc00
  s_add_u32 m0, s36, 0xc00
  s_nop 0
  buffer_load_dwordx4 v5, s[16:19], s7 offen lds
  s_add_u32 s7, s41, 0x0
  s_add_u32 m0, s37, 0x0
  s_nop 0
  buffer_load_dwordx4 v6, s[20:23], s7 offen lds
  s_add_u32 s7, s41, 0x8000
  s_add_u32 m0, s37, 0x400
  s_nop 0
  buffer_load_dwordx4 v7, s[20:23], s7 offen lds
  s_add_u32 s7, s41, 0x10000
  s_add_u32 m0, s37, 0x800
  s_nop 0
  buffer_load_dwordx4 v6, s[20:23], s7 offen lds
  s_add_u32 s7, s41, 0x18000
  s_add_u32 m0, s37, 0xc00
  s_nop 0
  buffer_load_dwordx4 v7, s[20:23], s7 offen lds
  s_add_u32 s39, s38, 1
  s_and_b32 s39, s39, 15
  s_lshl_b32 s40, s39, 12
  s_add_u32 s40, s40, s34
  s_lshl_b32 s41, s39, 7
  s_add_u32 s41, s41, s35
  s_add_u32 s7, s40, 0x0
  s_add_u32 m0, s36, 0x8000
  s_nop 0
  buffer_load_dwordx4 v5, s[16:19], s7 offen lds
  s_add_u32 s7, s40, 0x400
  s_add_u32 m0, s36, 0x8400
  s_nop 0
  buffer_load_dwordx4 v5, s[16:19], s7 offen lds
  s_add_u32 s7, s40, 0x800
  s_add_u32 m0, s36, 0x8800
  s_nop 0
  buffer_load_dwordx4 v5, s[16:19], s7 offen lds
  s_add_u32 s7, s40, 0xc00
  s_add_u32 m0, s36, 0x8c00
  s_nop 0
  buffer_load_dwordx4 v5, s[16:19], s7 offen lds
  s_add_u32 s7, s41, 0x0
  s_add_u32 m0, s37, 0x8000
  s_nop 0
  buffer_load_dwordx4 v6, s[20:23], s7 offen lds
  s_add_u32 s7, s41, 0x8000
  s_add_u32 m0, s37, 0x8400
  s_nop 0
  buffer_load_dwordx4 v7, s[20:23], s7 offen lds
  s_add_u32 s7, s41, 0x10000
  s_add_u32 m0, s37, 0x8800
  s_nop 0
  buffer_load_dwordx4 v6, s[20:23], s7 offen lds
  s_add_u32 s7, s41, 0x18000
  s_add_u32 m0, s37, 0x8c00
  s_nop 0
  buffer_load_dwordx4 v7, s[20:23], s7 offen lds
  s_waitcnt vmcnt(8)
  s_barrier
  s_add_u32 s39, s38, 2
  s_and_b32 s39, s39, 15
  s_lshl_b32 s40, s39, 12
  s_add_u32 s40, s40, s34
  s_lshl_b32 s41, s39, 7
  s_add_u32 s41, s41, s35
  s_add_u32 s7, s40, 0x0
  s_add_u32 m0, s36, 0x10000
  s_nop 0
  buffer_load_dwordx4 v5, s[16:19], s7 offen lds
  s_add_u32 s7, s40, 0x400
  s_add_u32 m0, s36, 0x10400
  s_nop 0
  buffer_load_dwordx4 v5, s[16:19], s7 offen lds
  s_add_u32 s7, s40, 0x800
  s_add_u32 m0, s36, 0x10800
  s_nop 0
  buffer_load_dwordx4 v5, s[16:19], s7 offen lds
  s_add_u32 s7, s40, 0xc00
  s_add_u32 m0, s36, 0x10c00
  s_nop 0
  buffer_load_dwordx4 v5, s[16:19], s7 offen lds
  s_add_u32 s7, s41, 0x0
  s_add_u32 m0, s37, 0x10000
  s_nop 0
  buffer_load_dwordx4 v6, s[20:23], s7 offen lds
  s_add_u32 s7, s41, 0x8000
  s_add_u32 m0, s37, 0x10400
  s_nop 0
  buffer_load_dwordx4 v7, s[20:23], s7 offen lds
  s_add_u32 s7, s41, 0x10000
  s_add_u32 m0, s37, 0x10800
  s_nop 0
  buffer_load_dwordx4 v6, s[20:23], s7 offen lds
  s_add_u32 s7, s41, 0x18000
  s_add_u32 m0, s37, 0x10c00
  s_nop 0
  buffer_load_dwordx4 v7, s[20:23], s7 offen lds
  s_add_u32 s39, s38, 3
  s_and_b32 s39, s39, 15
  s_lshl_b32 s40, s39, 12
  s_add_u32 s40, s40, s34
  s_lshl_b32 s41, s39, 7
  s_add_u32 s41, s41, s35
  s_add_u32 s7, s40, 0x0
  s_add_u32 m0, s36, 0x18000
  s_nop 0
  buffer_load_dwordx4 v5, s[16:19], s7 offen lds
  s_add_u32 s7, s40, 0x400
  s_add_u32 m0, s36, 0x18400
  s_nop 0
  buffer_load_dwordx4 v5, s[16:19], s7 offen lds
  s_add_u32 s7, s40, 0x800
  s_add_u32 m0, s36, 0x18800
  s_nop 0
  buffer_load_dwordx4 v5, s[16:19], s7 offen lds
  s_add_u32 s7, s40, 0xc00
  s_add_u32 m0, s36, 0x18c00
  s_nop 0
  buffer_load_dwordx4 v5, s[16:19], s7 offen lds
  s_add_u32 s7, s41, 0x0
  s_add_u32 m0, s37, 0x18000
  s_nop 0
  buffer_load_dwordx4 v6, s[20:23], s7 offen lds
  s_add_u32 s7, s41, 0x8000
  s_add_u32 m0, s37, 0x18400
  s_nop 0
  buffer_load_dwordx4 v7, s[20:23], s7 offen lds
  s_add_u32 s7, s41, 0x10000
  s_add_u32 m0, s37, 0x18800
  s_nop 0
  buffer_load_dwordx4 v6, s[20:23], s7 offen lds
  s_add_u32 s7, s41, 0x18000
  s_add_u32 m0, s37, 0x18c00
  s_nop 0
  buffer_load_dwordx4 v7, s[20:23], s7 offen lds
  s_waitcnt vmcnt(16)
  s_barrier
  s_waitcnt vmcnt(8)
  s_barrier
  s_add_u32 s39, s38, 4
  s_and_b32 s39, s39, 15
  s_lshl_b32 s40, s39, 12
  s_add_u32 s40, s40, s34
  s_lshl_b32 s41, s39, 7
  s_add_u32 s41, s41, s35
  s_add_u32 s7, s40, 0x0
  s_add_u32 m0, s36, 0x0
  s_nop 0
  buffer_load_dwordx4 v5, s[16:19], s7 offen lds
  s_add_u32 s7, s40, 0x400
  s_add_u32 m0, s36, 0x400
  s_nop 0
  buffer_load_dwordx4 v5, s[16:19], s7 offen lds
  s_add_u32 s7, s40, 0x800
  s_add_u32 m0, s36, 0x800
  s_nop 0
  buffer_load_dwordx4 v5, s[16:19], s7 offen lds
  s_add_u32 s7, s40, 0xc00
  s_add_u32 m0, s36, 0xc00
  s_nop 0
  buffer_load_dwordx4 v5, s[16:19], s7 offen lds
  s_add_u32 s7, s41, 0x0
  s_add_u32 m0, s37, 0x0
  s_nop 0
  buffer_load_dwordx4 v6, s[20:23], s7 offen lds
  s_add_u32 s7, s41, 0x8000
  s_add_u32 m0, s37, 0x400
  s_nop 0
  buffer_load_dwordx4 v7, s[20:23], s7 offen lds
  s_add_u32 s7, s41, 0x10000
  s_add_u32 m0, s37, 0x800
  s_nop 0
  buffer_load_dwordx4 v6, s[20:23], s7 offen lds
  s_add_u32 s7, s41, 0x18000
  s_add_u32 m0, s37, 0xc00
  s_nop 0
  buffer_load_dwordx4 v7, s[20:23], s7 offen lds
  s_waitcnt vmcnt(8)
  s_barrier
  s_add_u32 s39, s38, 5
  s_and_b32 s39, s39, 15
  s_lshl_b32 s40, s39, 12
  s_add_u32 s40, s40, s34
  s_lshl_b32 s41, s39, 7
  s_add_u32 s41, s41, s35
  s_add_u32 s7, s40, 0x0
  s_add_u32 m0, s36, 0x8000
  s_nop 0
  buffer_load_dwordx4 v5, s[16:19], s7 offen lds
  s_add_u32 s7, s40, 0x400
  s_add_u32 m0, s36, 0x8400
  s_nop 0
  buffer_load_dwordx4 v5, s[16:19], s7 offen lds
  s_add_u32 s7, s40, 0x800
  s_add_u32 m0, s36, 0x8800
  s_nop 0
  buffer_load_dwordx4 v5, s[16:19], s7 offen lds
  s_add_u32 s7, s40, 0xc00
  s_add_u32 m0, s36, 0x8c00
  s_nop 0
  buffer_load_dwordx4 v5, s[16:19], s7 offen lds
  s_add_u32 s7, s41, 0x0
  s_add_u32 m0, s37, 0x8000
  s_nop 0
  buffer_load_dwordx4 v6, s[20:23], s7 offen lds
  s_add_u32 s7, s41, 0x8000
  s_add_u32 m0, s37, 0x8400
  s_nop 0
  buffer_load_dwordx4 v7, s[20:23], s7 offen lds
  s_add_u32 s7, s41, 0x10000
  s_add_u32 m0, s37, 0x8800
  s_nop 0
  buffer_load_dwordx4 v6, s[20:23], s7 offen lds
  s_add_u32 s7, s41, 0x18000
  s_add_u32 m0, s37, 0x8c00
  s_nop 0
  buffer_load_dwordx4 v7, s[20:23], s7 offen lds
  s_add_u32 s7, s42, 0x0
  s_add_u32 m0, s43, 0x20000
  s_nop 0
  buffer_load_dwordx4 v5, s[16:19], s7 offen lds
  s_waitcnt vmcnt(9)
  s_barrier
  s_add_u32 s39, s38, 6
  s_and_b32 s39, s39, 15
  s_lshl_b32 s40, s39, 12
  s_add_u32 s40, s40, s34
  s_lshl_b32 s41, s39, 7
  s_add_u32 s41, s41, s35
  s_add_u32 s7, s40, 0x0
  s_add_u32 m0, s36, 0x10000
  s_nop 0
  buffer_load_dwordx4 v5, s[16:19], s7 offen lds
  s_add_u32 s7, s40, 0x400
  s_add_u32 m0, s36, 0x10400
  s_nop 0
  buffer_load_dwordx4 v5, s[16:19], s7 offen lds
  s_add_u32 s7, s40, 0x800
  s_add_u32 m0, s36, 0x10800
  s_nop 0
  buffer_load_dwordx4 v5, s[16:19], s7 offen lds
  s_add_u32 s7, s40, 0xc00
  s_add_u32 m0, s36, 0x10c00
  s_nop 0
  buffer_load_dwordx4 v5, s[16:19], s7 offen lds
  s_add_u32 s7, s41, 0x0
  s_add_u32 m0, s37, 0x10000
  s_nop 0
  buffer_load_dwordx4 v6, s[20:23], s7 offen lds
  s_add_u32 s7, s41, 0x8000
  s_add_u32 m0, s37, 0x10400
  s_nop 0
  buffer_load_dwordx4 v7, s[20:23], s7 offen lds
  s_add_u32 s7, s41, 0x10000
  s_add_u32 m0, s37, 0x10800
  s_nop 0
  buffer_load_dwordx4 v6, s[20:23], s7 offen lds
  s_add_u32 s7, s41, 0x18000
  s_add_u32 m0, s37, 0x10c00
  s_nop 0
  buffer_load_dwordx4 v7, s[20:23], s7 offen lds
  s_add_u32 s7, s42, 0x400
  s_add_u32 m0, s43, 0x20400
  s_nop 0
  buffer_load_dwordx4 v5, s[16:19], s7 offen lds
  s_waitcnt vmcnt(9)
  s_barrier
  s_add_u32 s39, s38, 7
  s_and_b32 s39, s39, 15
  s_lshl_b32 s40, s39, 12
  s_add_u32 s40, s40, s34
  s_lshl_b32 s41, s39, 7
  s_add_u32 s41, s41, s35
  s_add_u32 s7, s40, 0x0
  s_add_u32 m0, s36, 0x18000
  s_nop 0
  buffer_load_dwordx4 v5, s[16:19], s7 offen lds
  s_add_u32 s7, s40, 0x400
  s_add_u32 m0, s36, 0x18400
  s_nop 0
  buffer_load_dwordx4 v5, s[16:19], s7 offen lds
  s_add_u32 s7, s40, 0x800
  s_add_u32 m0, s36, 0x18800
  s_nop 0
  buffer_load_dwordx4 v5, s[16:19], s7 offen lds
  s_add_u32 s7, s40, 0xc00
  s_add_u32 m0, s36, 0x18c00
  s_nop 0
  buffer_load_dwordx4 v5, s[16:19], s7 offen lds
  s_add_u32 s7, s41, 0x0
  s_add_u32 m0, s37, 0x18000
  s_nop 0
  buffer_load_dwordx4 v6, s[20:23], s7 offen lds
  s_add_u32 s7, s41, 0x8000
  s_add_u32 m0, s37, 0x18400
  s_nop 0
  buffer_load_dwordx4 v7, s[20:23], s7 offen lds
  s_add_u32 s7, s41, 0x10000
  s_add_u32 m0, s37, 0x18800
  s_nop 0
  buffer_load_dwordx4 v6, s[20:23], s7 offen lds
  s_add_u32 s7, s41, 0x18000
  s_add_u32 m0, s37, 0x18c00
  s_nop 0
  buffer_load_dwordx4 v7, s[20:23], s7 offen lds
  s_add_u32 s7, s42, 0x800
  s_add_u32 m0, s43, 0x20800
  s_nop 0
  buffer_load_dwordx4 v5, s[16:19], s7 offen lds
  s_waitcnt vmcnt(9)
  s_barrier
  s_add_u32 s39, s38, 8
  s_and_b32 s39, s39, 15
  s_lshl_b32 s40, s39, 12
  s_add_u32 s40, s40, s34
  s_lshl_b32 s41, s39, 7
  s_add_u32 s41, s41, s35
  s_add_u32 s7, s40, 0x0
  s_add_u32 m0, s36, 0x0
  s_nop 0
  buffer_load_dwordx4 v5, s[16:19], s7 offen lds
  s_add_u32 s7, s40, 0x400
  s_add_u32 m0, s36, 0x400
  s_nop 0
  buffer_load_dwordx4 v5, s[16:19], s7 offen lds
  s_add_u32 s7, s40, 0x800
  s_add_u32 m0, s36, 0x800
  s_nop 0
  buffer_load_dwordx4 v5, s[16:19], s7 offen lds
  s_add_u32 s7, s40, 0xc00
  s_add_u32 m0, s36, 0xc00
  s_nop 0
  buffer_load_dwordx4 v5, s[16:19], s7 offen lds
  s_add_u32 s7, s41, 0x0
  s_add_u32 m0, s37, 0x0
  s_nop 0
  buffer_load_dwordx4 v6, s[20:23], s7 offen lds
  s_add_u32 s7, s41, 0x8000
  s_add_u32 m0, s37, 0x400
  s_nop 0
  buffer_load_dwordx4 v7, s[20:23], s7 offen lds
  s_add_u32 s7, s41, 0x10000
  s_add_u32 m0, s37, 0x800
  s_nop 0
  buffer_load_dwordx4 v6, s[20:23], s7 offen lds
  s_add_u32 s7, s41, 0x18000
  s_add_u32 m0, s37, 0xc00
  s_nop 0
  buffer_load_dwordx4 v7, s[20:23], s7 offen lds
  s_add_u32 s7, s42, 0xc00
  s_add_u32 m0, s43, 0x20c00
  s_nop 0
  buffer_load_dwordx4 v5, s[16:19], s7 offen lds
  s_waitcnt vmcnt(9)
  s_barrier
  s_add_u32 s39, s38, 9
  s_and_b32 s39, s39, 15
  s_lshl_b32 s40, s39, 12
  s_add_u32 s40, s40, s34
  s_lshl_b32 s41, s39, 7
  s_add_u32 s41, s41, s35
  s_add_u32 s7, s40, 0x0
  s_add_u32 m0, s36, 0x8000
  s_nop 0
  buffer_load_dwordx4 v5, s[16:19], s7 offen lds
  s_add_u32 s7, s40, 0x400
  s_add_u32 m0, s36, 0x8400
  s_nop 0
  buffer_load_dwordx4 v5, s[16:19], s7 offen lds
  s_add_u32 s7, s40, 0x800
  s_add_u32 m0, s36, 0x8800
  s_nop 0
  buffer_load_dwordx4 v5, s[16:19], s7 offen lds
  s_add_u32 s7, s40, 0xc00
  s_add_u32 m0, s36, 0x8c00
  s_nop 0
  buffer_load_dwordx4 v5, s[16:19], s7 offen lds
  s_add_u32 s7, s41, 0x0
  s_add_u32 m0, s37, 0x8000
  s_nop 0
  buffer_load_dwordx4 v6, s[20:23], s7 offen lds
  s_add_u32 s7, s41, 0x8000
  s_add_u32 m0, s37, 0x8400
  s_nop 0
  buffer_load_dwordx4 v7, s[20:23], s7 offen lds
  s_add_u32 s7, s41, 0x10000
  s_add_u32 m0, s37, 0x8800
  s_nop 0
  buffer_load_dwordx4 v6, s[20:23], s7 offen lds
  s_add_u32 s7, s41, 0x18000
  s_add_u32 m0, s37, 0x8c00
  s_nop 0
  buffer_load_dwordx4 v7, s[20:23], s7 offen lds
  s_add_u32 s7, s42, 0x1000
  s_add_u32 m0, s43, 0x21000
  s_nop 0
  buffer_load_dwordx4 v5, s[16:19], s7 offen lds
  s_waitcnt vmcnt(9)
  s_barrier
  s_add_u32 s39, s38, 10
  s_and_b32 s39, s39, 15
  s_lshl_b32 s40, s39, 12
  s_add_u32 s40, s40, s34
  s_lshl_b32 s41, s39, 7
  s_add_u32 s41, s41, s35
  s_add_u32 s7, s40, 0x0
  s_add_u32 m0, s36, 0x10000
  s_nop 0
  buffer_load_dwordx4 v5, s[16:19], s7 offen lds
  s_add_u32 s7, s40, 0x400
  s_add_u32 m0, s36, 0x10400
  s_nop 0
  buffer_load_dwordx4 v5, s[16:19], s7 offen lds
  s_add_u32 s7, s40, 0x800
  s_add_u32 m0, s36, 0x10800
  s_nop 0
  buffer_load_dwordx4 v5, s[16:19], s7 offen lds
  s_add_u32 s7, s40, 0xc00
  s_add_u32 m0, s36, 0x10c00
  s_nop 0
  buffer_load_dwordx4 v5, s[16:19], s7 offen lds
  s_add_u32 s7, s41, 0x0
  s_add_u32 m0, s37, 0x10000
  s_nop 0
  buffer_load_dwordx4 v6, s[20:23], s7 offen lds
  s_add_u32 s7, s41, 0x8000
  s_add_u32 m0, s37, 0x10400
  s_nop 0
  buffer_load_dwordx4 v7, s[20:23], s7 offen lds
  s_add_u32 s7, s41, 0x10000
  s_add_u32 m0, s37, 0x10800
  s_nop 0
  buffer_load_dwordx4 v6, s[20:23], s7 offen lds
  s_add_u32 s7, s41, 0x18000
  s_add_u32 m0, s37, 0x10c00
  s_nop 0
  buffer_load_dwordx4 v7, s[20:23], s7 offen lds
  s_add_u32 s7, s42, 0x1400
  s_add_u32 m0, s43, 0x21400
  s_nop 0
  buffer_load_dwordx4 v5, s[16:19], s7 offen lds
  s_waitcnt vmcnt(9)
  s_barrier
  s_add_u32 s39, s38, 11
  s_and_b32 s39, s39, 15
  s_lshl_b32 s40, s39, 12
  s_add_u32 s40, s40, s34
  s_lshl_b32 s41, s39, 7
  s_add_u32 s41, s41, s35
  s_add_u32 s7, s40, 0x0
  s_add_u32 m0, s36, 0x18000
  s_nop 0
  buffer_load_dwordx4 v5, s[16:19], s7 offen lds
  s_add_u32 s7, s40, 0x400
  s_add_u32 m0, s36, 0x18400
  s_nop 0
  buffer_load_dwordx4 v5, s[16:19], s7 offen lds
  s_add_u32 s7, s40, 0x800
  s_add_u32 m0, s36, 0x18800
  s_nop 0
  buffer_load_dwordx4 v5, s[16:19], s7 offen lds
  s_add_u32 s7, s40, 0xc00
  s_add_u32 m0, s36, 0x18c00
  s_nop 0
  buffer_load_dwordx4 v5, s[16:19], s7 offen lds
  s_add_u32 s7, s41, 0x0
  s_add_u32 m0, s37, 0x18000
  s_nop 0
  buffer_load_dwordx4 v6, s[20:23], s7 offen lds
  s_add_u32 s7, s41, 0x8000
  s_add_u32 m0, s37, 0x18400
  s_nop 0
  buffer_load_dwordx4 v7, s[20:23], s7 offen lds
  s_add_u32 s7, s41, 0x10000
  s_add_u32 m0, s37, 0x18800
  s_nop 0
  buffer_load_dwordx4 v6, s[20:23], s7 offen lds
  s_add_u32 s7, s41, 0x18000
  s_add_u32 m0, s37, 0x18c00
  s_nop 0
  buffer_load_dwordx4 v7, s[20:23], s7 offen lds
  s_add_u32 s7, s42, 0x1800
  s_add_u32 m0, s43, 0x21800
  s_nop 0
  buffer_load_dwordx4 v5, s[16:19], s7 offen lds
  s_waitcnt vmcnt(9)
  s_barrier
  s_add_u32 s39, s38, 12
  s_and_b32 s39, s39, 15
  s_lshl_b32 s40, s39, 12
  s_add_u32 s40, s40, s34
  s_lshl_b32 s41, s39, 7
  s_add_u32 s41, s41, s35
  s_add_u32 s7, s40, 0x0
  s_add_u32 m0, s36, 0x0
  s_nop 0
  buffer_load_dwordx4 v5, s[16:19], s7 offen lds
  s_add_u32 s7, s40, 0x400
  s_add_u32 m0, s36, 0x400
  s_nop 0
  buffer_load_dwordx4 v5, s[16:19], s7 offen lds
  s_add_u32 s7, s40, 0x800
  s_add_u32 m0, s36, 0x800
  s_nop 0
  buffer_load_dwordx4 v5, s[16:19], s7 offen lds
  s_add_u32 s7, s40, 0xc00
  s_add_u32 m0, s36, 0xc00
  s_nop 0
  buffer_load_dwordx4 v5, s[16:19], s7 offen lds
  s_add_u32 s7, s41, 0x0
  s_add_u32 m0, s37, 0x0
  s_nop 0
  buffer_load_dwordx4 v6, s[20:23], s7 offen lds
  s_add_u32 s7, s41, 0x8000
  s_add_u32 m0, s37, 0x400
  s_nop 0
  buffer_load_dwordx4 v7, s[20:23], s7 offen lds
  s_add_u32 s7, s41, 0x10000
  s_add_u32 m0, s37, 0x800
  s_nop 0
  buffer_load_dwordx4 v6, s[20:23], s7 offen lds
  s_add_u32 s7, s41, 0x18000
  s_add_u32 m0, s37, 0xc00
  s_nop 0
  buffer_load_dwordx4 v7, s[20:23], s7 offen lds
  s_add_u32 s7, s42, 0x1c00
  s_add_u32 m0, s43, 0x21c00
  s_nop 0
  buffer_load_dwordx4 v5, s[16:19], s7 offen lds
  s_waitcnt vmcnt(9)
  s_barrier
  s_add_u32 s39, s38, 13
  s_and_b32 s39, s39, 15
  s_lshl_b32 s40, s39, 12
  s_add_u32 s40, s40, s34
  s_lshl_b32 s41, s39, 7
  s_add_u32 s41, s41, s35
  s_add_u32 s7, s40, 0x0
  s_add_u32 m0, s36, 0x8000
  s_nop 0
  buffer_load_dwordx4 v5, s[16:19], s7 offen lds
  s_add_u32 s7, s40, 0x400
  s_add_u32 m0, s36, 0x8400
  s_nop 0
  buffer_load_dwordx4 v5, s[16:19], s7 offen lds
  s_add_u32 s7, s40, 0x800
  s_add_u32 m0, s36, 0x8800
  s_nop 0
  buffer_load_dwordx4 v5, s[16:19], s7 offen lds
  s_add_u32 s7, s40, 0xc00
  s_add_u32 m0, s36, 0x8c00
  s_nop 0
  buffer_load_dwordx4 v5, s[16:19], s7 offen lds
  s_add_u32 s7, s41, 0x0
  s_add_u32 m0, s37, 0x8000
  s_nop 0
  buffer_load_dwordx4 v6, s[20:23], s7 offen lds
  s_add_u32 s7, s41, 0x8000
  s_add_u32 m0, s37, 0x8400
  s_nop 0
  buffer_load_dwordx4 v7, s[20:23], s7 offen lds
  s_add_u32 s7, s41, 0x10000
  s_add_u32 m0, s37, 0x8800
  s_nop 0
  buffer_load_dwordx4 v6, s[20:23], s7 offen lds
  s_add_u32 s7, s41, 0x18000
  s_add_u32 m0, s37, 0x8c00
  s_nop 0
  buffer_load_dwordx4 v7, s[20:23], s7 offen lds
  s_waitcnt vmcnt(8)
  s_barrier
  s_add_u32 s39, s38, 14
  s_and_b32 s39, s39, 15
  s_lshl_b32 s40, s39, 12
  s_add_u32 s40, s40, s34
  s_lshl_b32 s41, s39, 7
  s_add_u32 s41, s41, s35
  s_add_u32 s7, s40, 0x0
  s_add_u32 m0, s36, 0x10000
  s_nop 0
  buffer_load_dwordx4 v5, s[16:19], s7 offen lds
  s_add_u32 s7, s40, 0x400
  s_add_u32 m0, s36, 0x10400
  s_nop 0
  buffer_load_dwordx4 v5, s[16:19], s7 offen lds
  s_add_u32 s7, s40, 0x800
  s_add_u32 m0, s36, 0x10800
  s_nop 0
  buffer_load_dwordx4 v5, s[16:19], s7 offen lds
  s_add_u32 s7, s40, 0xc00
  s_add_u32 m0, s36, 0x10c00
  s_nop 0
  buffer_load_dwordx4 v5, s[16:19], s7 offen lds
  s_add_u32 s7, s41, 0x0
  s_add_u32 m0, s37, 0x10000
  s_nop 0
  buffer_load_dwordx4 v6, s[20:23], s7 offen lds
  s_add_u32 s7, s41, 0x8000
  s_add_u32 m0, s37, 0x10400
  s_nop 0
  buffer_load_dwordx4 v7, s[20:23], s7 offen lds
  s_add_u32 s7, s41, 0x10000
  s_add_u32 m0, s37, 0x10800
  s_nop 0
  buffer_load_dwordx4 v6, s[20:23], s7 offen lds
  s_add_u32 s7, s41, 0x18000
  s_add_u32 m0, s37, 0x10c00
  s_nop 0
  buffer_load_dwordx4 v7, s[20:23], s7 offen lds
  s_waitcnt vmcnt(8)
  s_barrier
  s_add_u32 s39, s38, 15
  s_and_b32 s39, s39, 15
  s_lshl_b32 s40, s39, 12
  s_add_u32 s40, s40, s34
  s_lshl_b32 s41, s39, 7
  s_add_u32 s41, s41, s35
  s_add_u32 s7, s40, 0x0
  s_add_u32 m0, s36, 0x18000
  s_nop 0
  buffer_load_dwordx4 v5, s[16:19], s7 offen lds
  s_add_u32 s7, s40, 0x400
  s_add_u32 m0, s36, 0x18400
  s_nop 0
  buffer_load_dwordx4 v5, s[16:19], s7 offen lds
  s_add_u32 s7, s40, 0x800
  s_add_u32 m0, s36, 0x18800
  s_nop 0
  buffer_load_dwordx4 v5, s[16:19], s7 offen lds
  s_add_u32 s7, s40, 0xc00
  s_add_u32 m0, s36, 0x18c00
  s_nop 0
  buffer_load_dwordx4 v5, s[16:19], s7 offen lds
  s_add_u32 s7, s41, 0x0
  s_add_u32 m0, s37, 0x18000
  s_nop 0
  buffer_load_dwordx4 v6, s[20:23], s7 offen lds
  s_add_u32 s7, s41, 0x8000
  s_add_u32 m0, s37, 0x18400
  s_nop 0
  buffer_load_dwordx4 v7, s[20:23], s7 offen lds
  s_add_u32 s7, s41, 0x10000
  s_add_u32 m0, s37, 0x18800
  s_nop 0
  buffer_load_dwordx4 v6, s[20:23], s7 offen lds
  s_add_u32 s7, s41, 0x18000
  s_add_u32 m0, s37, 0x18c00
  s_nop 0
  buffer_load_dwordx4 v7, s[20:23], s7 offen lds
  s_waitcnt vmcnt(8)
  s_barrier
  s_waitcnt vmcnt(0)
  s_barrier
  s_lshl_b32 s5, s29, 8
  v_subrev_u32 v8, 256, v0
  v_add_u32 v8, s5, v8
  v_lshlrev_b32 v8, 7, v8
  s_endpgm
k5_sp_kernel_compute_3:
  v_and_b32 v5, 31, v1
  v_lshrrev_b32 v6, 5, v1
  s_and_b32 s44, s4, 1
  s_lshr_b32 s45, s4, 1
  s_lshl_b32 s46, s30, 2
  s_lshl_b32 s5, s45, 1
  s_add_u32 s46, s46, s5
  s_lshl_b32 s47, s31, 2
  s_lshl_b32 s5, s44, 1
  s_add_u32 s47, s47, s5
  v_lshlrev_b32 v7, 4, v1
  v_lshlrev_b32 v2, 2, v5
  v_lshlrev_b32 v3, 1, v5
  s_waitcnt lgkmcnt(0)
  s_mov_b32 s16, s12
  s_and_b32 s17, s13, 0xffff
  s_mov_b32 s18, 0x10000000
  s_mov_b32 s19, 0x20000
  s_mov_b32 s24, s10
  s_and_b32 s25, s11, 0xffff
  s_mov_b32 s26, 0x1000
  s_mov_b32 s27, 0x20000
  s_add_u32 s5, s46, 0
  s_lshl_b32 s7, s5, 7
  s_add_u32 s7, s7, 0xac0000
  buffer_load_dword v40, v2, s[16:19], s7 offen
  s_lshl_b32 s7, s5, 6
  buffer_load_ushort v44, v3, s[24:27], s7 offen
  s_add_u32 s5, s46, 1
  s_lshl_b32 s7, s5, 7
  s_add_u32 s7, s7, 0xac0000
  buffer_load_dword v42, v2, s[16:19], s7 offen
  s_lshl_b32 s7, s5, 6
  buffer_load_ushort v46, v3, s[24:27], s7 offen
  s_getpc_b64 s[48:49]
k5_sp_kernel_pc_4:
  s_add_u32 s48, s48, k6_wout_kernel-k5_sp_kernel_pc_4
  s_addc_u32 s49, s49, 0
  s_mov_b32 s52, s48
  s_and_b32 s53, s49, 0xffff
  s_mov_b32 s54, k6_wout_kernel_end-k6_wout_kernel
  s_mov_b32 s55, 0x20000
  s_lshl_b32 s5, s29, 8
  v_add_u32 v48, s5, v0
  v_lshlrev_b32 v48, 7, v48
  buffer_load_dword v49, v48, s[52:55], 0 offen
  s_lshl_b32 s5, s44, 13
  v_add_u32 v50, s5, v7
  v_bfe_u32 v2, v5, 1, 3
  v_add_u32 v3, 0, v6
  v_xor_b32 v3, v3, v2
  v_lshlrev_b32 v3, 4, v3
  v_lshl_add_u32 v52, v5, 7, v3
  s_lshl_b32 s5, s45, 13
  s_add_u32 s5, s5, 16384
  v_add_u32 v52, s5, v52
  v_add_u32 v3, 2, v6
  v_xor_b32 v3, v3, v2
  v_lshlrev_b32 v3, 4, v3
  v_lshl_add_u32 v53, v5, 7, v3
  s_lshl_b32 s5, s45, 13
  s_add_u32 s5, s5, 16384
  v_add_u32 v53, s5, v53
  v_add_u32 v3, 4, v6
  v_xor_b32 v3, v3, v2
  v_lshlrev_b32 v3, 4, v3
  v_lshl_add_u32 v54, v5, 7, v3
  s_lshl_b32 s5, s45, 13
  s_add_u32 s5, s5, 16384
  v_add_u32 v54, s5, v54
  v_add_u32 v3, 6, v6
  v_xor_b32 v3, v3, v2
  v_lshlrev_b32 v3, 4, v3
  v_lshl_add_u32 v55, v5, 7, v3
  s_lshl_b32 s5, s45, 13
  s_add_u32 s5, s5, 16384
  v_add_u32 v55, s5, v55
  v_add_u32 v56, 65536, v50
  v_add_u32 v60, 65536, v52
  v_add_u32 v61, 65536, v53
  v_add_u32 v62, 65536, v54
  v_add_u32 v63, 65536, v55
  s_barrier
  ds_read_b128 v[128:131], v50 offset:0
  ds_read_b128 v[132:135], v50 offset:4096
  ds_read_b128 v[152:155], v52 offset:0
  ds_read_b128 v[156:159], v52 offset:4096
  ds_read_b128 v[136:139], v50 offset:1024
  ds_read_b128 v[140:143], v50 offset:5120
  ds_read_b128 v[160:163], v53 offset:0
  ds_read_b128 v[164:167], v53 offset:4096
  s_waitcnt lgkmcnt(4)
  v_mfma_f32_32x32x16_bf16 v[64:79], v[128:131], v[152:155], 0
  ds_read_b128 v[144:147], v50 offset:2048
  v_mfma_f32_32x32x16_bf16 v[80:95], v[128:131], v[156:159], 0
  ds_read_b128 v[148:151], v50 offset:6144
  v_mfma_f32_32x32x16_bf16 v[96:111], v[132:135], v[152:155], 0
  ds_read_b128 v[168:171], v54 offset:0
  v_mfma_f32_32x32x16_bf16 v[112:127], v[132:135], v[156:159], 0
  ds_read_b128 v[172:175], v54 offset:4096
  s_waitcnt lgkmcnt(4)
  v_mfma_f32_32x32x16_bf16 v[64:79], v[136:139], v[160:163], v[64:79]
  ds_read_b128 v[128:131], v50 offset:3072
  v_mfma_f32_32x32x16_bf16 v[80:95], v[136:139], v[164:167], v[80:95]
  ds_read_b128 v[132:135], v50 offset:7168
  v_mfma_f32_32x32x16_bf16 v[96:111], v[140:143], v[160:163], v[96:111]
  ds_read_b128 v[152:155], v55 offset:0
  v_mfma_f32_32x32x16_bf16 v[112:127], v[140:143], v[164:167], v[112:127]
  ds_read_b128 v[156:159], v55 offset:4096
  s_waitcnt lgkmcnt(4)
  s_barrier
  v_mfma_f32_32x32x16_bf16 v[64:79], v[144:147], v[168:171], v[64:79]
  ds_read_b128 v[136:139], v50 offset:32768
  v_mfma_f32_32x32x16_bf16 v[80:95], v[144:147], v[172:175], v[80:95]
  ds_read_b128 v[140:143], v50 offset:36864
  v_mfma_f32_32x32x16_bf16 v[96:111], v[148:151], v[168:171], v[96:111]
  ds_read_b128 v[160:163], v52 offset:32768
  v_mfma_f32_32x32x16_bf16 v[112:127], v[148:151], v[172:175], v[112:127]
  ds_read_b128 v[164:167], v52 offset:36864
  s_waitcnt lgkmcnt(4)
  v_mfma_f32_32x32x16_bf16 v[64:79], v[128:131], v[152:155], v[64:79]
  ds_read_b128 v[144:147], v50 offset:33792
  v_mfma_f32_32x32x16_bf16 v[80:95], v[128:131], v[156:159], v[80:95]
  ds_read_b128 v[148:151], v50 offset:37888
  v_mfma_f32_32x32x16_bf16 v[96:111], v[132:135], v[152:155], v[96:111]
  ds_read_b128 v[168:171], v53 offset:32768
  v_mfma_f32_32x32x16_bf16 v[112:127], v[132:135], v[156:159], v[112:127]
  ds_read_b128 v[172:175], v53 offset:36864
  s_waitcnt lgkmcnt(4)
  v_mfma_f32_32x32x16_bf16 v[64:79], v[136:139], v[160:163], v[64:79]
  ds_read_b128 v[128:131], v50 offset:34816
  v_mfma_f32_32x32x16_bf16 v[80:95], v[136:139], v[164:167], v[80:95]
  ds_read_b128 v[132:135], v50 offset:38912
  v_mfma_f32_32x32x16_bf16 v[96:111], v[140:143], v[160:163], v[96:111]
  ds_read_b128 v[152:155], v54 offset:32768
  v_mfma_f32_32x32x16_bf16 v[112:127], v[140:143], v[164:167], v[112:127]
  ds_read_b128 v[156:159], v54 offset:36864
  s_waitcnt lgkmcnt(4)
  v_mfma_f32_32x32x16_bf16 v[64:79], v[144:147], v[168:171], v[64:79]
  ds_read_b128 v[136:139], v50 offset:35840
  v_mfma_f32_32x32x16_bf16 v[80:95], v[144:147], v[172:175], v[80:95]
  ds_read_b128 v[140:143], v50 offset:39936
  v_mfma_f32_32x32x16_bf16 v[96:111], v[148:151], v[168:171], v[96:111]
  ds_read_b128 v[160:163], v55 offset:32768
  v_mfma_f32_32x32x16_bf16 v[112:127], v[148:151], v[172:175], v[112:127]
  ds_read_b128 v[164:167], v55 offset:36864
  s_waitcnt lgkmcnt(4)
  s_barrier
  v_mfma_f32_32x32x16_bf16 v[64:79], v[128:131], v[152:155], v[64:79]
  ds_read_b128 v[144:147], v56 offset:0
  v_mfma_f32_32x32x16_bf16 v[80:95], v[128:131], v[156:159], v[80:95]
  ds_read_b128 v[148:151], v56 offset:4096
  v_mfma_f32_32x32x16_bf16 v[96:111], v[132:135], v[152:155], v[96:111]
  ds_read_b128 v[168:171], v60 offset:0
  v_mfma_f32_32x32x16_bf16 v[112:127], v[132:135], v[156:159], v[112:127]
  ds_read_b128 v[172:175], v60 offset:4096
  s_waitcnt lgkmcnt(4)
  v_mfma_f32_32x32x16_bf16 v[64:79], v[136:139], v[160:163], v[64:79]
  ds_read_b128 v[128:131], v56 offset:1024
  v_mfma_f32_32x32x16_bf16 v[80:95], v[136:139], v[164:167], v[80:95]
  ds_read_b128 v[132:135], v56 offset:5120
  v_mfma_f32_32x32x16_bf16 v[96:111], v[140:143], v[160:163], v[96:111]
  ds_read_b128 v[152:155], v61 offset:0
  v_mfma_f32_32x32x16_bf16 v[112:127], v[140:143], v[164:167], v[112:127]
  ds_read_b128 v[156:159], v61 offset:4096
  s_waitcnt lgkmcnt(4)
  v_mfma_f32_32x32x16_bf16 v[64:79], v[144:147], v[168:171], v[64:79]
  ds_read_b128 v[136:139], v56 offset:2048
  v_mfma_f32_32x32x16_bf16 v[80:95], v[144:147], v[172:175], v[80:95]
  ds_read_b128 v[140:143], v56 offset:6144
  v_mfma_f32_32x32x16_bf16 v[96:111], v[148:151], v[168:171], v[96:111]
  ds_read_b128 v[160:163], v62 offset:0
  v_mfma_f32_32x32x16_bf16 v[112:127], v[148:151], v[172:175], v[112:127]
  ds_read_b128 v[164:167], v62 offset:4096
  s_waitcnt lgkmcnt(4)
  v_mfma_f32_32x32x16_bf16 v[64:79], v[128:131], v[152:155], v[64:79]
  ds_read_b128 v[144:147], v56 offset:3072
  v_mfma_f32_32x32x16_bf16 v[80:95], v[128:131], v[156:159], v[80:95]
  ds_read_b128 v[148:151], v56 offset:7168
  v_mfma_f32_32x32x16_bf16 v[96:111], v[132:135], v[152:155], v[96:111]
  ds_read_b128 v[168:171], v63 offset:0
  v_mfma_f32_32x32x16_bf16 v[112:127], v[132:135], v[156:159], v[112:127]
  ds_read_b128 v[172:175], v63 offset:4096
  s_waitcnt lgkmcnt(4)
  s_barrier
  v_mfma_f32_32x32x16_bf16 v[64:79], v[136:139], v[160:163], v[64:79]
  ds_read_b128 v[128:131], v56 offset:32768
  v_mfma_f32_32x32x16_bf16 v[80:95], v[136:139], v[164:167], v[80:95]
  ds_read_b128 v[132:135], v56 offset:36864
  v_mfma_f32_32x32x16_bf16 v[96:111], v[140:143], v[160:163], v[96:111]
  ds_read_b128 v[152:155], v60 offset:32768
  v_mfma_f32_32x32x16_bf16 v[112:127], v[140:143], v[164:167], v[112:127]
  ds_read_b128 v[156:159], v60 offset:36864
  s_waitcnt lgkmcnt(4)
  v_mfma_f32_32x32x16_bf16 v[64:79], v[144:147], v[168:171], v[64:79]
  ds_read_b128 v[136:139], v56 offset:33792
  v_mfma_f32_32x32x16_bf16 v[80:95], v[144:147], v[172:175], v[80:95]
  ds_read_b128 v[140:143], v56 offset:37888
  v_mfma_f32_32x32x16_bf16 v[96:111], v[148:151], v[168:171], v[96:111]
  ds_read_b128 v[160:163], v61 offset:32768
  v_mfma_f32_32x32x16_bf16 v[112:127], v[148:151], v[172:175], v[112:127]
  ds_read_b128 v[164:167], v61 offset:36864
  s_waitcnt lgkmcnt(4)
  v_mfma_f32_32x32x16_bf16 v[64:79], v[128:131], v[152:155], v[64:79]
  ds_read_b128 v[144:147], v56 offset:34816
  v_mfma_f32_32x32x16_bf16 v[80:95], v[128:131], v[156:159], v[80:95]
  ds_read_b128 v[148:151], v56 offset:38912
  v_mfma_f32_32x32x16_bf16 v[96:111], v[132:135], v[152:155], v[96:111]
  ds_read_b128 v[168:171], v62 offset:32768
  v_mfma_f32_32x32x16_bf16 v[112:127], v[132:135], v[156:159], v[112:127]
  ds_read_b128 v[172:175], v62 offset:36864
  s_waitcnt lgkmcnt(4)
  v_mfma_f32_32x32x16_bf16 v[64:79], v[136:139], v[160:163], v[64:79]
  ds_read_b128 v[128:131], v56 offset:35840
  v_mfma_f32_32x32x16_bf16 v[80:95], v[136:139], v[164:167], v[80:95]
  ds_read_b128 v[132:135], v56 offset:39936
  v_mfma_f32_32x32x16_bf16 v[96:111], v[140:143], v[160:163], v[96:111]
  ds_read_b128 v[152:155], v63 offset:32768
  v_mfma_f32_32x32x16_bf16 v[112:127], v[140:143], v[164:167], v[112:127]
  ds_read_b128 v[156:159], v63 offset:36864
  s_waitcnt lgkmcnt(4)
  s_barrier
  v_mfma_f32_32x32x16_bf16 v[64:79], v[144:147], v[168:171], v[64:79]
  ds_read_b128 v[136:139], v50 offset:0
  v_mfma_f32_32x32x16_bf16 v[80:95], v[144:147], v[172:175], v[80:95]
  ds_read_b128 v[140:143], v50 offset:4096
  v_mfma_f32_32x32x16_bf16 v[96:111], v[148:151], v[168:171], v[96:111]
  ds_read_b128 v[160:163], v52 offset:0
  v_mfma_f32_32x32x16_bf16 v[112:127], v[148:151], v[172:175], v[112:127]
  ds_read_b128 v[164:167], v52 offset:4096
  s_waitcnt lgkmcnt(4)
  v_mfma_f32_32x32x16_bf16 v[64:79], v[128:131], v[152:155], v[64:79]
  ds_read_b128 v[144:147], v50 offset:1024
  v_mfma_f32_32x32x16_bf16 v[80:95], v[128:131], v[156:159], v[80:95]
  ds_read_b128 v[148:151], v50 offset:5120
  v_mfma_f32_32x32x16_bf16 v[96:111], v[132:135], v[152:155], v[96:111]
  ds_read_b128 v[168:171], v53 offset:0
  v_mfma_f32_32x32x16_bf16 v[112:127], v[132:135], v[156:159], v[112:127]
  ds_read_b128 v[172:175], v53 offset:4096
  s_waitcnt lgkmcnt(4)
  v_mfma_f32_32x32x16_bf16 v[64:79], v[136:139], v[160:163], v[64:79]
  ds_read_b128 v[128:131], v50 offset:2048
  v_mfma_f32_32x32x16_bf16 v[80:95], v[136:139], v[164:167], v[80:95]
  ds_read_b128 v[132:135], v50 offset:6144
  v_mfma_f32_32x32x16_bf16 v[96:111], v[140:143], v[160:163], v[96:111]
  ds_read_b128 v[152:155], v54 offset:0
  v_mfma_f32_32x32x16_bf16 v[112:127], v[140:143], v[164:167], v[112:127]
  ds_read_b128 v[156:159], v54 offset:4096
  s_waitcnt lgkmcnt(4)
  v_mfma_f32_32x32x16_bf16 v[64:79], v[144:147], v[168:171], v[64:79]
  ds_read_b128 v[136:139], v50 offset:3072
  v_mfma_f32_32x32x16_bf16 v[80:95], v[144:147], v[172:175], v[80:95]
  ds_read_b128 v[140:143], v50 offset:7168
  v_mfma_f32_32x32x16_bf16 v[96:111], v[148:151], v[168:171], v[96:111]
  ds_read_b128 v[160:163], v55 offset:0
  v_mfma_f32_32x32x16_bf16 v[112:127], v[148:151], v[172:175], v[112:127]
  ds_read_b128 v[164:167], v55 offset:4096
  s_waitcnt lgkmcnt(4)
  s_barrier
  v_mfma_f32_32x32x16_bf16 v[64:79], v[128:131], v[152:155], v[64:79]
  ds_read_b128 v[144:147], v50 offset:32768
  v_mfma_f32_32x32x16_bf16 v[80:95], v[128:131], v[156:159], v[80:95]
  ds_read_b128 v[148:151], v50 offset:36864
  v_mfma_f32_32x32x16_bf16 v[96:111], v[132:135], v[152:155], v[96:111]
  ds_read_b128 v[168:171], v52 offset:32768
  v_mfma_f32_32x32x16_bf16 v[112:127], v[132:135], v[156:159], v[112:127]
  ds_read_b128 v[172:175], v52 offset:36864
  s_waitcnt lgkmcnt(4)
  v_mfma_f32_32x32x16_bf16 v[64:79], v[136:139], v[160:163], v[64:79]
  ds_read_b128 v[128:131], v50 offset:33792
  v_mfma_f32_32x32x16_bf16 v[80:95], v[136:139], v[164:167], v[80:95]
  ds_read_b128 v[132:135], v50 offset:37888
  v_mfma_f32_32x32x16_bf16 v[96:111], v[140:143], v[160:163], v[96:111]
  ds_read_b128 v[152:155], v53 offset:32768
  v_mfma_f32_32x32x16_bf16 v[112:127], v[140:143], v[164:167], v[112:127]
  ds_read_b128 v[156:159], v53 offset:36864
  s_waitcnt lgkmcnt(4)
  v_mfma_f32_32x32x16_bf16 v[64:79], v[144:147], v[168:171], v[64:79]
  ds_read_b128 v[136:139], v50 offset:34816
  v_mfma_f32_32x32x16_bf16 v[80:95], v[144:147], v[172:175], v[80:95]
  ds_read_b128 v[140:143], v50 offset:38912
  v_mfma_f32_32x32x16_bf16 v[96:111], v[148:151], v[168:171], v[96:111]
  ds_read_b128 v[160:163], v54 offset:32768
  v_mfma_f32_32x32x16_bf16 v[112:127], v[148:151], v[172:175], v[112:127]
  ds_read_b128 v[164:167], v54 offset:36864
  s_waitcnt lgkmcnt(4)
  v_mfma_f32_32x32x16_bf16 v[64:79], v[128:131], v[152:155], v[64:79]
  ds_read_b128 v[144:147], v50 offset:35840
  v_mfma_f32_32x32x16_bf16 v[80:95], v[128:131], v[156:159], v[80:95]
  ds_read_b128 v[148:151], v50 offset:39936
  v_mfma_f32_32x32x16_bf16 v[96:111], v[132:135], v[152:155], v[96:111]
  ds_read_b128 v[168:171], v55 offset:32768
  v_mfma_f32_32x32x16_bf16 v[112:127], v[132:135], v[156:159], v[112:127]
  ds_read_b128 v[172:175], v55 offset:36864
  s_waitcnt lgkmcnt(4)
  s_barrier
  v_mfma_f32_32x32x16_bf16 v[64:79], v[136:139], v[160:163], v[64:79]
  ds_read_b128 v[128:131], v56 offset:0
  v_mfma_f32_32x32x16_bf16 v[80:95], v[136:139], v[164:167], v[80:95]
  ds_read_b128 v[132:135], v56 offset:4096
  v_mfma_f32_32x32x16_bf16 v[96:111], v[140:143], v[160:163], v[96:111]
  ds_read_b128 v[152:155], v60 offset:0
  v_mfma_f32_32x32x16_bf16 v[112:127], v[140:143], v[164:167], v[112:127]
  ds_read_b128 v[156:159], v60 offset:4096
  s_waitcnt lgkmcnt(4)
  v_mfma_f32_32x32x16_bf16 v[64:79], v[144:147], v[168:171], v[64:79]
  ds_read_b128 v[136:139], v56 offset:1024
  v_mfma_f32_32x32x16_bf16 v[80:95], v[144:147], v[172:175], v[80:95]
  ds_read_b128 v[140:143], v56 offset:5120
  v_mfma_f32_32x32x16_bf16 v[96:111], v[148:151], v[168:171], v[96:111]
  ds_read_b128 v[160:163], v61 offset:0
  v_mfma_f32_32x32x16_bf16 v[112:127], v[148:151], v[172:175], v[112:127]
  ds_read_b128 v[164:167], v61 offset:4096
  s_waitcnt lgkmcnt(4)
  v_mfma_f32_32x32x16_bf16 v[64:79], v[128:131], v[152:155], v[64:79]
  ds_read_b128 v[144:147], v56 offset:2048
  v_mfma_f32_32x32x16_bf16 v[80:95], v[128:131], v[156:159], v[80:95]
  ds_read_b128 v[148:151], v56 offset:6144
  v_mfma_f32_32x32x16_bf16 v[96:111], v[132:135], v[152:155], v[96:111]
  ds_read_b128 v[168:171], v62 offset:0
  v_mfma_f32_32x32x16_bf16 v[112:127], v[132:135], v[156:159], v[112:127]
  ds_read_b128 v[172:175], v62 offset:4096
  s_waitcnt lgkmcnt(4)
  v_mfma_f32_32x32x16_bf16 v[64:79], v[136:139], v[160:163], v[64:79]
  ds_read_b128 v[128:131], v56 offset:3072
  v_mfma_f32_32x32x16_bf16 v[80:95], v[136:139], v[164:167], v[80:95]
  ds_read_b128 v[132:135], v56 offset:7168
  v_mfma_f32_32x32x16_bf16 v[96:111], v[140:143], v[160:163], v[96:111]
  ds_read_b128 v[152:155], v63 offset:0
  v_mfma_f32_32x32x16_bf16 v[112:127], v[140:143], v[164:167], v[112:127]
  ds_read_b128 v[156:159], v63 offset:4096
  s_waitcnt lgkmcnt(4)
  s_barrier
  v_mfma_f32_32x32x16_bf16 v[64:79], v[144:147], v[168:171], v[64:79]
  ds_read_b128 v[136:139], v56 offset:32768
  v_mfma_f32_32x32x16_bf16 v[80:95], v[144:147], v[172:175], v[80:95]
  ds_read_b128 v[140:143], v56 offset:36864
  v_mfma_f32_32x32x16_bf16 v[96:111], v[148:151], v[168:171], v[96:111]
  ds_read_b128 v[160:163], v60 offset:32768
  v_mfma_f32_32x32x16_bf16 v[112:127], v[148:151], v[172:175], v[112:127]
  ds_read_b128 v[164:167], v60 offset:36864
  s_waitcnt lgkmcnt(4)
  v_mfma_f32_32x32x16_bf16 v[64:79], v[128:131], v[152:155], v[64:79]
  ds_read_b128 v[144:147], v56 offset:33792
  v_mfma_f32_32x32x16_bf16 v[80:95], v[128:131], v[156:159], v[80:95]
  ds_read_b128 v[148:151], v56 offset:37888
  v_mfma_f32_32x32x16_bf16 v[96:111], v[132:135], v[152:155], v[96:111]
  ds_read_b128 v[168:171], v61 offset:32768
  v_mfma_f32_32x32x16_bf16 v[112:127], v[132:135], v[156:159], v[112:127]
  ds_read_b128 v[172:175], v61 offset:36864
  s_waitcnt lgkmcnt(4)
  v_mfma_f32_32x32x16_bf16 v[64:79], v[136:139], v[160:163], v[64:79]
  ds_read_b128 v[128:131], v56 offset:34816
  v_mfma_f32_32x32x16_bf16 v[80:95], v[136:139], v[164:167], v[80:95]
  ds_read_b128 v[132:135], v56 offset:38912
  v_mfma_f32_32x32x16_bf16 v[96:111], v[140:143], v[160:163], v[96:111]
  ds_read_b128 v[152:155], v62 offset:32768
  v_mfma_f32_32x32x16_bf16 v[112:127], v[140:143], v[164:167], v[112:127]
  ds_read_b128 v[156:159], v62 offset:36864
  s_waitcnt lgkmcnt(4)
  v_mfma_f32_32x32x16_bf16 v[64:79], v[144:147], v[168:171], v[64:79]
  ds_read_b128 v[136:139], v56 offset:35840
  v_mfma_f32_32x32x16_bf16 v[80:95], v[144:147], v[172:175], v[80:95]
  ds_read_b128 v[140:143], v56 offset:39936
  v_mfma_f32_32x32x16_bf16 v[96:111], v[148:151], v[168:171], v[96:111]
  ds_read_b128 v[160:163], v63 offset:32768
  v_mfma_f32_32x32x16_bf16 v[112:127], v[148:151], v[172:175], v[112:127]
  ds_read_b128 v[164:167], v63 offset:36864
  s_waitcnt lgkmcnt(4)
  s_barrier
  v_mfma_f32_32x32x16_bf16 v[64:79], v[128:131], v[152:155], v[64:79]
  ds_read_b128 v[144:147], v50 offset:0
  v_mfma_f32_32x32x16_bf16 v[80:95], v[128:131], v[156:159], v[80:95]
  ds_read_b128 v[148:151], v50 offset:4096
  v_mfma_f32_32x32x16_bf16 v[96:111], v[132:135], v[152:155], v[96:111]
  ds_read_b128 v[168:171], v52 offset:0
  v_mfma_f32_32x32x16_bf16 v[112:127], v[132:135], v[156:159], v[112:127]
  ds_read_b128 v[172:175], v52 offset:4096
  s_waitcnt lgkmcnt(4)
  v_mfma_f32_32x32x16_bf16 v[64:79], v[136:139], v[160:163], v[64:79]
  ds_read_b128 v[128:131], v50 offset:1024
  v_mfma_f32_32x32x16_bf16 v[80:95], v[136:139], v[164:167], v[80:95]
  ds_read_b128 v[132:135], v50 offset:5120
  v_mfma_f32_32x32x16_bf16 v[96:111], v[140:143], v[160:163], v[96:111]
  ds_read_b128 v[152:155], v53 offset:0
  v_mfma_f32_32x32x16_bf16 v[112:127], v[140:143], v[164:167], v[112:127]
  ds_read_b128 v[156:159], v53 offset:4096
  s_waitcnt lgkmcnt(4)
  v_mfma_f32_32x32x16_bf16 v[64:79], v[144:147], v[168:171], v[64:79]
  ds_read_b128 v[136:139], v50 offset:2048
  v_mfma_f32_32x32x16_bf16 v[80:95], v[144:147], v[172:175], v[80:95]
  ds_read_b128 v[140:143], v50 offset:6144
  v_mfma_f32_32x32x16_bf16 v[96:111], v[148:151], v[168:171], v[96:111]
  ds_read_b128 v[160:163], v54 offset:0
  v_mfma_f32_32x32x16_bf16 v[112:127], v[148:151], v[172:175], v[112:127]
  ds_read_b128 v[164:167], v54 offset:4096
  s_waitcnt lgkmcnt(4)
  v_mfma_f32_32x32x16_bf16 v[64:79], v[128:131], v[152:155], v[64:79]
  ds_read_b128 v[144:147], v50 offset:3072
  v_mfma_f32_32x32x16_bf16 v[80:95], v[128:131], v[156:159], v[80:95]
  ds_read_b128 v[148:151], v50 offset:7168
  v_mfma_f32_32x32x16_bf16 v[96:111], v[132:135], v[152:155], v[96:111]
  ds_read_b128 v[168:171], v55 offset:0
  v_mfma_f32_32x32x16_bf16 v[112:127], v[132:135], v[156:159], v[112:127]
  ds_read_b128 v[172:175], v55 offset:4096
  s_waitcnt lgkmcnt(4)
  s_barrier
  v_mfma_f32_32x32x16_bf16 v[64:79], v[136:139], v[160:163], v[64:79]
  ds_read_b128 v[128:131], v50 offset:32768
  v_mfma_f32_32x32x16_bf16 v[80:95], v[136:139], v[164:167], v[80:95]
  ds_read_b128 v[132:135], v50 offset:36864
  v_mfma_f32_32x32x16_bf16 v[96:111], v[140:143], v[160:163], v[96:111]
  ds_read_b128 v[152:155], v52 offset:32768
  v_mfma_f32_32x32x16_bf16 v[112:127], v[140:143], v[164:167], v[112:127]
  ds_read_b128 v[156:159], v52 offset:36864
  s_waitcnt lgkmcnt(4)
  v_mfma_f32_32x32x16_bf16 v[64:79], v[144:147], v[168:171], v[64:79]
  ds_read_b128 v[136:139], v50 offset:33792
  v_mfma_f32_32x32x16_bf16 v[80:95], v[144:147], v[172:175], v[80:95]
  ds_read_b128 v[140:143], v50 offset:37888
  v_mfma_f32_32x32x16_bf16 v[96:111], v[148:151], v[168:171], v[96:111]
  ds_read_b128 v[160:163], v53 offset:32768
  v_mfma_f32_32x32x16_bf16 v[112:127], v[148:151], v[172:175], v[112:127]
  ds_read_b128 v[164:167], v53 offset:36864
  s_waitcnt lgkmcnt(4)
  v_mfma_f32_32x32x16_bf16 v[64:79], v[128:131], v[152:155], v[64:79]
  ds_read_b128 v[144:147], v50 offset:34816
  v_mfma_f32_32x32x16_bf16 v[80:95], v[128:131], v[156:159], v[80:95]
  ds_read_b128 v[148:151], v50 offset:38912
  v_mfma_f32_32x32x16_bf16 v[96:111], v[132:135], v[152:155], v[96:111]
  ds_read_b128 v[168:171], v54 offset:32768
  v_mfma_f32_32x32x16_bf16 v[112:127], v[132:135], v[156:159], v[112:127]
  ds_read_b128 v[172:175], v54 offset:36864
  s_waitcnt lgkmcnt(4)
  v_mfma_f32_32x32x16_bf16 v[64:79], v[136:139], v[160:163], v[64:79]
  ds_read_b128 v[128:131], v50 offset:35840
  v_mfma_f32_32x32x16_bf16 v[80:95], v[136:139], v[164:167], v[80:95]
  ds_read_b128 v[132:135], v50 offset:39936
  v_mfma_f32_32x32x16_bf16 v[96:111], v[140:143], v[160:163], v[96:111]
  ds_read_b128 v[152:155], v55 offset:32768
  v_mfma_f32_32x32x16_bf16 v[112:127], v[140:143], v[164:167], v[112:127]
  ds_read_b128 v[156:159], v55 offset:36864
  s_waitcnt lgkmcnt(4)
  s_barrier
  v_mfma_f32_32x32x16_bf16 v[64:79], v[144:147], v[168:171], v[64:79]
  ds_read_b128 v[136:139], v56 offset:0
  v_mfma_f32_32x32x16_bf16 v[80:95], v[144:147], v[172:175], v[80:95]
  ds_read_b128 v[140:143], v56 offset:4096
  v_mfma_f32_32x32x16_bf16 v[96:111], v[148:151], v[168:171], v[96:111]
  ds_read_b128 v[160:163], v60 offset:0
  v_mfma_f32_32x32x16_bf16 v[112:127], v[148:151], v[172:175], v[112:127]
  ds_read_b128 v[164:167], v60 offset:4096
  s_waitcnt lgkmcnt(4)
  v_mfma_f32_32x32x16_bf16 v[64:79], v[128:131], v[152:155], v[64:79]
  ds_read_b128 v[144:147], v56 offset:1024
  v_mfma_f32_32x32x16_bf16 v[80:95], v[128:131], v[156:159], v[80:95]
  ds_read_b128 v[148:151], v56 offset:5120
  v_mfma_f32_32x32x16_bf16 v[96:111], v[132:135], v[152:155], v[96:111]
  ds_read_b128 v[168:171], v61 offset:0
  v_mfma_f32_32x32x16_bf16 v[112:127], v[132:135], v[156:159], v[112:127]
  ds_read_b128 v[172:175], v61 offset:4096
  s_waitcnt lgkmcnt(4)
  v_mfma_f32_32x32x16_bf16 v[64:79], v[136:139], v[160:163], v[64:79]
  ds_read_b128 v[128:131], v56 offset:2048
  v_mfma_f32_32x32x16_bf16 v[80:95], v[136:139], v[164:167], v[80:95]
  ds_read_b128 v[132:135], v56 offset:6144
  v_mfma_f32_32x32x16_bf16 v[96:111], v[140:143], v[160:163], v[96:111]
  ds_read_b128 v[152:155], v62 offset:0
  v_mfma_f32_32x32x16_bf16 v[112:127], v[140:143], v[164:167], v[112:127]
  ds_read_b128 v[156:159], v62 offset:4096
  s_waitcnt lgkmcnt(4)
  v_mfma_f32_32x32x16_bf16 v[64:79], v[144:147], v[168:171], v[64:79]
  ds_read_b128 v[136:139], v56 offset:3072
  v_mfma_f32_32x32x16_bf16 v[80:95], v[144:147], v[172:175], v[80:95]
  ds_read_b128 v[140:143], v56 offset:7168
  v_mfma_f32_32x32x16_bf16 v[96:111], v[148:151], v[168:171], v[96:111]
  ds_read_b128 v[160:163], v63 offset:0
  v_mfma_f32_32x32x16_bf16 v[112:127], v[148:151], v[172:175], v[112:127]
  ds_read_b128 v[164:167], v63 offset:4096
  s_waitcnt lgkmcnt(4)
  s_barrier
  v_mfma_f32_32x32x16_bf16 v[64:79], v[128:131], v[152:155], v[64:79]
  ds_read_b128 v[144:147], v56 offset:32768
  v_mfma_f32_32x32x16_bf16 v[80:95], v[128:131], v[156:159], v[80:95]
  ds_read_b128 v[148:151], v56 offset:36864
  v_mfma_f32_32x32x16_bf16 v[96:111], v[132:135], v[152:155], v[96:111]
  ds_read_b128 v[168:171], v60 offset:32768
  v_mfma_f32_32x32x16_bf16 v[112:127], v[132:135], v[156:159], v[112:127]
  ds_read_b128 v[172:175], v60 offset:36864
  s_waitcnt lgkmcnt(4)
  v_mfma_f32_32x32x16_bf16 v[64:79], v[136:139], v[160:163], v[64:79]
  ds_read_b128 v[128:131], v56 offset:33792
  v_mfma_f32_32x32x16_bf16 v[80:95], v[136:139], v[164:167], v[80:95]
  ds_read_b128 v[132:135], v56 offset:37888
  v_mfma_f32_32x32x16_bf16 v[96:111], v[140:143], v[160:163], v[96:111]
  ds_read_b128 v[152:155], v61 offset:32768
  v_mfma_f32_32x32x16_bf16 v[112:127], v[140:143], v[164:167], v[112:127]
  ds_read_b128 v[156:159], v61 offset:36864
  s_waitcnt lgkmcnt(4)
  v_mfma_f32_32x32x16_bf16 v[64:79], v[144:147], v[168:171], v[64:79]
  ds_read_b128 v[136:139], v56 offset:34816
  v_mfma_f32_32x32x16_bf16 v[80:95], v[144:147], v[172:175], v[80:95]
  ds_read_b128 v[140:143], v56 offset:38912
  v_mfma_f32_32x32x16_bf16 v[96:111], v[148:151], v[168:171], v[96:111]
  ds_read_b128 v[160:163], v62 offset:32768
  v_mfma_f32_32x32x16_bf16 v[112:127], v[148:151], v[172:175], v[112:127]
  ds_read_b128 v[164:167], v62 offset:36864
  s_waitcnt lgkmcnt(4)
  v_mfma_f32_32x32x16_bf16 v[64:79], v[128:131], v[152:155], v[64:79]
  ds_read_b128 v[144:147], v56 offset:35840
  v_mfma_f32_32x32x16_bf16 v[80:95], v[128:131], v[156:159], v[80:95]
  ds_read_b128 v[148:151], v56 offset:39936
  v_mfma_f32_32x32x16_bf16 v[96:111], v[132:135], v[152:155], v[96:111]
  ds_read_b128 v[168:171], v63 offset:32768
  v_mfma_f32_32x32x16_bf16 v[112:127], v[132:135], v[156:159], v[112:127]
  ds_read_b128 v[172:175], v63 offset:36864
  s_waitcnt lgkmcnt(4)
  s_barrier
  v_mfma_f32_32x32x16_bf16 v[64:79], v[136:139], v[160:163], v[64:79]
  ds_read_b128 v[128:131], v50 offset:0
  v_mfma_f32_32x32x16_bf16 v[80:95], v[136:139], v[164:167], v[80:95]
  ds_read_b128 v[132:135], v50 offset:4096
  v_mfma_f32_32x32x16_bf16 v[96:111], v[140:143], v[160:163], v[96:111]
  ds_read_b128 v[152:155], v52 offset:0
  v_mfma_f32_32x32x16_bf16 v[112:127], v[140:143], v[164:167], v[112:127]
  ds_read_b128 v[156:159], v52 offset:4096
  s_waitcnt lgkmcnt(4)
  v_mfma_f32_32x32x16_bf16 v[64:79], v[144:147], v[168:171], v[64:79]
  ds_read_b128 v[136:139], v50 offset:1024
  v_mfma_f32_32x32x16_bf16 v[80:95], v[144:147], v[172:175], v[80:95]
  ds_read_b128 v[140:143], v50 offset:5120
  v_mfma_f32_32x32x16_bf16 v[96:111], v[148:151], v[168:171], v[96:111]
  ds_read_b128 v[160:163], v53 offset:0
  v_mfma_f32_32x32x16_bf16 v[112:127], v[148:151], v[172:175], v[112:127]
  ds_read_b128 v[164:167], v53 offset:4096
  s_waitcnt lgkmcnt(4)
  v_mfma_f32_32x32x16_bf16 v[64:79], v[128:131], v[152:155], v[64:79]
  ds_read_b128 v[144:147], v50 offset:2048
  v_mfma_f32_32x32x16_bf16 v[80:95], v[128:131], v[156:159], v[80:95]
  ds_read_b128 v[148:151], v50 offset:6144
  v_mfma_f32_32x32x16_bf16 v[96:111], v[132:135], v[152:155], v[96:111]
  ds_read_b128 v[168:171], v54 offset:0
  v_mfma_f32_32x32x16_bf16 v[112:127], v[132:135], v[156:159], v[112:127]
  ds_read_b128 v[172:175], v54 offset:4096
  s_waitcnt lgkmcnt(4)
  v_mfma_f32_32x32x16_bf16 v[64:79], v[136:139], v[160:163], v[64:79]
  ds_read_b128 v[128:131], v50 offset:3072
  v_mfma_f32_32x32x16_bf16 v[80:95], v[136:139], v[164:167], v[80:95]
  ds_read_b128 v[132:135], v50 offset:7168
  v_mfma_f32_32x32x16_bf16 v[96:111], v[140:143], v[160:163], v[96:111]
  ds_read_b128 v[152:155], v55 offset:0
  v_mfma_f32_32x32x16_bf16 v[112:127], v[140:143], v[164:167], v[112:127]
  ds_read_b128 v[156:159], v55 offset:4096
  s_waitcnt lgkmcnt(4)
  s_barrier
  v_mfma_f32_32x32x16_bf16 v[64:79], v[144:147], v[168:171], v[64:79]
  ds_read_b128 v[136:139], v50 offset:32768
  v_mfma_f32_32x32x16_bf16 v[80:95], v[144:147], v[172:175], v[80:95]
  ds_read_b128 v[140:143], v50 offset:36864
  v_mfma_f32_32x32x16_bf16 v[96:111], v[148:151], v[168:171], v[96:111]
  ds_read_b128 v[160:163], v52 offset:32768
  v_mfma_f32_32x32x16_bf16 v[112:127], v[148:151], v[172:175], v[112:127]
  ds_read_b128 v[164:167], v52 offset:36864
  s_waitcnt lgkmcnt(4)
  v_mfma_f32_32x32x16_bf16 v[64:79], v[128:131], v[152:155], v[64:79]
  ds_read_b128 v[144:147], v50 offset:33792
  v_mfma_f32_32x32x16_bf16 v[80:95], v[128:131], v[156:159], v[80:95]
  ds_read_b128 v[148:151], v50 offset:37888
  v_mfma_f32_32x32x16_bf16 v[96:111], v[132:135], v[152:155], v[96:111]
  ds_read_b128 v[168:171], v53 offset:32768
  v_mfma_f32_32x32x16_bf16 v[112:127], v[132:135], v[156:159], v[112:127]
  ds_read_b128 v[172:175], v53 offset:36864
  s_waitcnt lgkmcnt(4)
  v_mfma_f32_32x32x16_bf16 v[64:79], v[136:139], v[160:163], v[64:79]
  ds_read_b128 v[128:131], v50 offset:34816
  v_mfma_f32_32x32x16_bf16 v[80:95], v[136:139], v[164:167], v[80:95]
  ds_read_b128 v[132:135], v50 offset:38912
  v_mfma_f32_32x32x16_bf16 v[96:111], v[140:143], v[160:163], v[96:111]
  ds_read_b128 v[152:155], v54 offset:32768
  v_mfma_f32_32x32x16_bf16 v[112:127], v[140:143], v[164:167], v[112:127]
  ds_read_b128 v[156:159], v54 offset:36864
  s_waitcnt lgkmcnt(4)
  v_mfma_f32_32x32x16_bf16 v[64:79], v[144:147], v[168:171], v[64:79]
  ds_read_b128 v[136:139], v50 offset:35840
  v_mfma_f32_32x32x16_bf16 v[80:95], v[144:147], v[172:175], v[80:95]
  ds_read_b128 v[140:143], v50 offset:39936
  v_mfma_f32_32x32x16_bf16 v[96:111], v[148:151], v[168:171], v[96:111]
  ds_read_b128 v[160:163], v55 offset:32768
  v_mfma_f32_32x32x16_bf16 v[112:127], v[148:151], v[172:175], v[112:127]
  ds_read_b128 v[164:167], v55 offset:36864
  s_waitcnt lgkmcnt(4)
  s_barrier
  v_mfma_f32_32x32x16_bf16 v[64:79], v[128:131], v[152:155], v[64:79]
  ds_read_b128 v[144:147], v56 offset:0
  v_mfma_f32_32x32x16_bf16 v[80:95], v[128:131], v[156:159], v[80:95]
  ds_read_b128 v[148:151], v56 offset:4096
  v_mfma_f32_32x32x16_bf16 v[96:111], v[132:135], v[152:155], v[96:111]
  ds_read_b128 v[168:171], v60 offset:0
  v_mfma_f32_32x32x16_bf16 v[112:127], v[132:135], v[156:159], v[112:127]
  ds_read_b128 v[172:175], v60 offset:4096
  s_waitcnt lgkmcnt(4)
  v_mfma_f32_32x32x16_bf16 v[64:79], v[136:139], v[160:163], v[64:79]
  ds_read_b128 v[128:131], v56 offset:1024
  v_mfma_f32_32x32x16_bf16 v[80:95], v[136:139], v[164:167], v[80:95]
  ds_read_b128 v[132:135], v56 offset:5120
  v_mfma_f32_32x32x16_bf16 v[96:111], v[140:143], v[160:163], v[96:111]
  ds_read_b128 v[152:155], v61 offset:0
  v_mfma_f32_32x32x16_bf16 v[112:127], v[140:143], v[164:167], v[112:127]
  ds_read_b128 v[156:159], v61 offset:4096
  s_waitcnt lgkmcnt(4)
  v_mfma_f32_32x32x16_bf16 v[64:79], v[144:147], v[168:171], v[64:79]
  ds_read_b128 v[136:139], v56 offset:2048
  v_mfma_f32_32x32x16_bf16 v[80:95], v[144:147], v[172:175], v[80:95]
  ds_read_b128 v[140:143], v56 offset:6144
  v_mfma_f32_32x32x16_bf16 v[96:111], v[148:151], v[168:171], v[96:111]
  ds_read_b128 v[160:163], v62 offset:0
  v_mfma_f32_32x32x16_bf16 v[112:127], v[148:151], v[172:175], v[112:127]
  ds_read_b128 v[164:167], v62 offset:4096
  s_waitcnt lgkmcnt(4)
  v_mfma_f32_32x32x16_bf16 v[64:79], v[128:131], v[152:155], v[64:79]
  ds_read_b128 v[144:147], v56 offset:3072
  v_mfma_f32_32x32x16_bf16 v[80:95], v[128:131], v[156:159], v[80:95]
  ds_read_b128 v[148:151], v56 offset:7168
  v_mfma_f32_32x32x16_bf16 v[96:111], v[132:135], v[152:155], v[96:111]
  ds_read_b128 v[168:171], v63 offset:0
  v_mfma_f32_32x32x16_bf16 v[112:127], v[132:135], v[156:159], v[112:127]
  ds_read_b128 v[172:175], v63 offset:4096
  s_waitcnt lgkmcnt(4)
  s_barrier
  v_mfma_f32_32x32x16_bf16 v[64:79], v[136:139], v[160:163], v[64:79]
  ds_read_b128 v[128:131], v56 offset:32768
  v_mfma_f32_32x32x16_bf16 v[80:95], v[136:139], v[164:167], v[80:95]
  ds_read_b128 v[132:135], v56 offset:36864
  v_mfma_f32_32x32x16_bf16 v[96:111], v[140:143], v[160:163], v[96:111]
  ds_read_b128 v[152:155], v60 offset:32768
  v_mfma_f32_32x32x16_bf16 v[112:127], v[140:143], v[164:167], v[112:127]
  ds_read_b128 v[156:159], v60 offset:36864
  s_waitcnt lgkmcnt(4)
  v_mfma_f32_32x32x16_bf16 v[64:79], v[144:147], v[168:171], v[64:79]
  ds_read_b128 v[136:139], v56 offset:33792
  v_mfma_f32_32x32x16_bf16 v[80:95], v[144:147], v[172:175], v[80:95]
  ds_read_b128 v[140:143], v56 offset:37888
  v_mfma_f32_32x32x16_bf16 v[96:111], v[148:151], v[168:171], v[96:111]
  ds_read_b128 v[160:163], v61 offset:32768
  v_mfma_f32_32x32x16_bf16 v[112:127], v[148:151], v[172:175], v[112:127]
  ds_read_b128 v[164:167], v61 offset:36864
  s_waitcnt lgkmcnt(4)
  v_mfma_f32_32x32x16_bf16 v[64:79], v[128:131], v[152:155], v[64:79]
  ds_read_b128 v[144:147], v56 offset:34816
  v_mfma_f32_32x32x16_bf16 v[80:95], v[128:131], v[156:159], v[80:95]
  ds_read_b128 v[148:151], v56 offset:38912
  v_mfma_f32_32x32x16_bf16 v[96:111], v[132:135], v[152:155], v[96:111]
  ds_read_b128 v[168:171], v62 offset:32768
  v_mfma_f32_32x32x16_bf16 v[112:127], v[132:135], v[156:159], v[112:127]
  ds_read_b128 v[172:175], v62 offset:36864
  s_waitcnt lgkmcnt(4)
  v_mfma_f32_32x32x16_bf16 v[64:79], v[136:139], v[160:163], v[64:79]
  ds_read_b128 v[128:131], v56 offset:35840
  v_mfma_f32_32x32x16_bf16 v[80:95], v[136:139], v[164:167], v[80:95]
  ds_read_b128 v[132:135], v56 offset:39936
  v_mfma_f32_32x32x16_bf16 v[96:111], v[140:143], v[160:163], v[96:111]
  ds_read_b128 v[152:155], v63 offset:32768
  v_mfma_f32_32x32x16_bf16 v[112:127], v[140:143], v[164:167], v[112:127]
  ds_read_b128 v[156:159], v63 offset:36864
  s_waitcnt lgkmcnt(4)
  v_mfma_f32_32x32x16_bf16 v[64:79], v[144:147], v[168:171], v[64:79]
  v_mfma_f32_32x32x16_bf16 v[80:95], v[144:147], v[172:175], v[80:95]
  v_mfma_f32_32x32x16_bf16 v[96:111], v[148:151], v[168:171], v[96:111]
  v_mfma_f32_32x32x16_bf16 v[112:127], v[148:151], v[172:175], v[112:127]
  s_waitcnt lgkmcnt(0)
  v_mfma_f32_32x32x16_bf16 v[64:79], v[128:131], v[152:155], v[64:79]
  v_mfma_f32_32x32x16_bf16 v[80:95], v[128:131], v[156:159], v[80:95]
  v_mfma_f32_32x32x16_bf16 v[96:111], v[132:135], v[152:155], v[96:111]
  v_mfma_f32_32x32x16_bf16 v[112:127], v[132:135], v[156:159], v[112:127]
  s_lshl_b32 s5, s45, 14
  s_lshl_b32 s6, s44, 12
  s_add_u32 s5, s5, s6
  s_add_u32 s5, s5, 131072
  v_add_u32 v176, s5, v7
  ds_read_b128 v[8:11], v176 offset:0
  ds_read_b128 v[12:15], v176 offset:1024
  ds_read_b128 v[24:27], v176 offset:2048
  ds_read_b128 v[28:31], v176 offset:3072
  ds_read_b128 v[16:19], v176 offset:8192
  ds_read_b128 v[20:23], v176 offset:9216
  ds_read_b128 v[32:35], v176 offset:10240
  ds_read_b128 v[36:39], v176 offset:11264
  s_waitcnt vmcnt(1)
  v_lshlrev_b32 v44, 16, v44
  v_mul_f32 v44, v44, v40
  v_lshlrev_b32 v46, 16, v46
  v_mul_f32 v46, v46, v42
  s_cmp_eq_u32 s32, 0
  s_cselect_b32 s5, 1.0, 0
  v_mul_f32 v44, s5, v44
  v_mul_f32 v46, s5, v46
  s_mul_i32 s56, s32, 4194304
  s_add_u32 s56, s56, 0x1300000
  v_pk_fma_f32 v[64:65], v[64:65], v[40:41], v[44:45] op_sel_hi:[1,0,0]
  v_pk_fma_f32 v[66:67], v[66:67], v[40:41], v[44:45] op_sel_hi:[1,0,0]
  v_pk_fma_f32 v[68:69], v[68:69], v[40:41], v[44:45] op_sel_hi:[1,0,0]
  v_pk_fma_f32 v[70:71], v[70:71], v[40:41], v[44:45] op_sel_hi:[1,0,0]
  v_pk_fma_f32 v[72:73], v[72:73], v[40:41], v[44:45] op_sel_hi:[1,0,0]
  v_pk_fma_f32 v[74:75], v[74:75], v[40:41], v[44:45] op_sel_hi:[1,0,0]
  v_pk_fma_f32 v[76:77], v[76:77], v[40:41], v[44:45] op_sel_hi:[1,0,0]
  v_pk_fma_f32 v[78:79], v[78:79], v[40:41], v[44:45] op_sel_hi:[1,0,0]
  s_waitcnt lgkmcnt(6)
  v_lshlrev_b32 v178, 16, v8
  v_and_b32 v179, 0xffff0000, v8
  v_pk_mul_f32 v[64:65], v[64:65], v[178:179]
  v_lshlrev_b32 v180, 16, v9
  v_and_b32 v181, 0xffff0000, v9
  v_pk_mul_f32 v[66:67], v[66:67], v[180:181]
  v_lshlrev_b32 v182, 16, v10
  v_and_b32 v183, 0xffff0000, v10
  v_pk_mul_f32 v[68:69], v[68:69], v[182:183]
  v_lshlrev_b32 v184, 16, v11
  v_and_b32 v185, 0xffff0000, v11
  v_pk_mul_f32 v[70:71], v[70:71], v[184:185]
  v_lshlrev_b32 v178, 16, v12
  v_and_b32 v179, 0xffff0000, v12
  v_pk_mul_f32 v[72:73], v[72:73], v[178:179]
  v_lshlrev_b32 v180, 16, v13
  v_and_b32 v181, 0xffff0000, v13
  v_pk_mul_f32 v[74:75], v[74:75], v[180:181]
  v_lshlrev_b32 v182, 16, v14
  v_and_b32 v183, 0xffff0000, v14
  v_pk_mul_f32 v[76:77], v[76:77], v[182:183]
  v_lshlrev_b32 v184, 16, v15
  v_and_b32 v185, 0xffff0000, v15
  v_pk_mul_f32 v[78:79], v[78:79], v[184:185]
  v_cvt_pk_bf16_f32 v188, v64, v65
  v_cvt_pk_bf16_f32 v189, v66, v67
  v_cvt_pk_bf16_f32 v190, v68, v69
  v_cvt_pk_bf16_f32 v191, v70, v71
  v_cvt_pk_bf16_f32 v192, v72, v73
  v_cvt_pk_bf16_f32 v193, v74, v75
  v_cvt_pk_bf16_f32 v194, v76, v77
  v_cvt_pk_bf16_f32 v195, v78, v79
  s_add_u32 s5, s46, 0
  s_mul_i32 s7, s5, 57344
  s_add_u32 s5, s47, 0
  s_lshl_b32 s5, s5, 11
  s_add_u32 s7, s7, s5
  s_add_u32 s7, s7, s56
  buffer_store_dwordx4 v[188:191], v7, s[16:19], s7 offen sc1
  buffer_store_dwordx4 v[192:195], v7, s[16:19], s7 offen offset:1024 sc1
  v_pk_fma_f32 v[96:97], v[96:97], v[40:41], v[44:45] op_sel_hi:[1,0,0]
  v_pk_fma_f32 v[98:99], v[98:99], v[40:41], v[44:45] op_sel_hi:[1,0,0]
  v_pk_fma_f32 v[100:101], v[100:101], v[40:41], v[44:45] op_sel_hi:[1,0,0]
  v_pk_fma_f32 v[102:103], v[102:103], v[40:41], v[44:45] op_sel_hi:[1,0,0]
  v_pk_fma_f32 v[104:105], v[104:105], v[40:41], v[44:45] op_sel_hi:[1,0,0]
  v_pk_fma_f32 v[106:107], v[106:107], v[40:41], v[44:45] op_sel_hi:[1,0,0]
  v_pk_fma_f32 v[108:109], v[108:109], v[40:41], v[44:45] op_sel_hi:[1,0,0]
  v_pk_fma_f32 v[110:111], v[110:111], v[40:41], v[44:45] op_sel_hi:[1,0,0]
  s_waitcnt lgkmcnt(4)
  v_lshlrev_b32 v178, 16, v24
  v_and_b32 v179, 0xffff0000, v24
  v_pk_mul_f32 v[96:97], v[96:97], v[178:179]
  v_lshlrev_b32 v180, 16, v25
  v_and_b32 v181, 0xffff0000, v25
  v_pk_mul_f32 v[98:99], v[98:99], v[180:181]
  v_lshlrev_b32 v182, 16, v26
  v_and_b32 v183, 0xffff0000, v26
  v_pk_mul_f32 v[100:101], v[100:101], v[182:183]
  v_lshlrev_b32 v184, 16, v27
  v_and_b32 v185, 0xffff0000, v27
  v_pk_mul_f32 v[102:103], v[102:103], v[184:185]
  v_lshlrev_b32 v178, 16, v28
  v_and_b32 v179, 0xffff0000, v28
  v_pk_mul_f32 v[104:105], v[104:105], v[178:179]
  v_lshlrev_b32 v180, 16, v29
  v_and_b32 v181, 0xffff0000, v29
  v_pk_mul_f32 v[106:107], v[106:107], v[180:181]
  v_lshlrev_b32 v182, 16, v30
  v_and_b32 v183, 0xffff0000, v30
  v_pk_mul_f32 v[108:109], v[108:109], v[182:183]
  v_lshlrev_b32 v184, 16, v31
  v_and_b32 v185, 0xffff0000, v31
  v_pk_mul_f32 v[110:111], v[110:111], v[184:185]
  v_cvt_pk_bf16_f32 v196, v96, v97
  v_cvt_pk_bf16_f32 v197, v98, v99
  v_cvt_pk_bf16_f32 v198, v100, v101
  v_cvt_pk_bf16_f32 v199, v102, v103
  v_cvt_pk_bf16_f32 v200, v104, v105
  v_cvt_pk_bf16_f32 v201, v106, v107
  v_cvt_pk_bf16_f32 v202, v108, v109
  v_cvt_pk_bf16_f32 v203, v110, v111
  s_add_u32 s5, s46, 0
  s_mul_i32 s7, s5, 57344
  s_add_u32 s5, s47, 1
  s_lshl_b32 s5, s5, 11
  s_add_u32 s7, s7, s5
  s_add_u32 s7, s7, s56
  buffer_store_dwordx4 v[196:199], v7, s[16:19], s7 offen sc1
  buffer_store_dwordx4 v[200:203], v7, s[16:19], s7 offen offset:1024 sc1
  v_pk_fma_f32 v[80:81], v[80:81], v[42:43], v[46:47] op_sel_hi:[1,0,0]
  v_pk_fma_f32 v[82:83], v[82:83], v[42:43], v[46:47] op_sel_hi:[1,0,0]
  v_pk_fma_f32 v[84:85], v[84:85], v[42:43], v[46:47] op_sel_hi:[1,0,0]
  v_pk_fma_f32 v[86:87], v[86:87], v[42:43], v[46:47] op_sel_hi:[1,0,0]
  v_pk_fma_f32 v[88:89], v[88:89], v[42:43], v[46:47] op_sel_hi:[1,0,0]
  v_pk_fma_f32 v[90:91], v[90:91], v[42:43], v[46:47] op_sel_hi:[1,0,0]
  v_pk_fma_f32 v[92:93], v[92:93], v[42:43], v[46:47] op_sel_hi:[1,0,0]
  v_pk_fma_f32 v[94:95], v[94:95], v[42:43], v[46:47] op_sel_hi:[1,0,0]
  s_waitcnt lgkmcnt(2)
  v_lshlrev_b32 v178, 16, v16
  v_and_b32 v179, 0xffff0000, v16
  v_pk_mul_f32 v[80:81], v[80:81], v[178:179]
  v_lshlrev_b32 v180, 16, v17
  v_and_b32 v181, 0xffff0000, v17
  v_pk_mul_f32 v[82:83], v[82:83], v[180:181]
  v_lshlrev_b32 v182, 16, v18
  v_and_b32 v183, 0xffff0000, v18
  v_pk_mul_f32 v[84:85], v[84:85], v[182:183]
  v_lshlrev_b32 v184, 16, v19
  v_and_b32 v185, 0xffff0000, v19
  v_pk_mul_f32 v[86:87], v[86:87], v[184:185]
  v_lshlrev_b32 v178, 16, v20
  v_and_b32 v179, 0xffff0000, v20
  v_pk_mul_f32 v[88:89], v[88:89], v[178:179]
  v_lshlrev_b32 v180, 16, v21
  v_and_b32 v181, 0xffff0000, v21
  v_pk_mul_f32 v[90:91], v[90:91], v[180:181]
  v_lshlrev_b32 v182, 16, v22
  v_and_b32 v183, 0xffff0000, v22
  v_pk_mul_f32 v[92:93], v[92:93], v[182:183]
  v_lshlrev_b32 v184, 16, v23
  v_and_b32 v185, 0xffff0000, v23
  v_pk_mul_f32 v[94:95], v[94:95], v[184:185]
  v_cvt_pk_bf16_f32 v188, v80, v81
  v_cvt_pk_bf16_f32 v189, v82, v83
  v_cvt_pk_bf16_f32 v190, v84, v85
  v_cvt_pk_bf16_f32 v191, v86, v87
  v_cvt_pk_bf16_f32 v192, v88, v89
  v_cvt_pk_bf16_f32 v193, v90, v91
  v_cvt_pk_bf16_f32 v194, v92, v93
  v_cvt_pk_bf16_f32 v195, v94, v95
  s_add_u32 s5, s46, 1
  s_mul_i32 s7, s5, 57344
  s_add_u32 s5, s47, 0
  s_lshl_b32 s5, s5, 11
  s_add_u32 s7, s7, s5
  s_add_u32 s7, s7, s56
  buffer_store_dwordx4 v[188:191], v7, s[16:19], s7 offen sc1
  buffer_store_dwordx4 v[192:195], v7, s[16:19], s7 offen offset:1024 sc1
  v_pk_fma_f32 v[112:113], v[112:113], v[42:43], v[46:47] op_sel_hi:[1,0,0]
  v_pk_fma_f32 v[114:115], v[114:115], v[42:43], v[46:47] op_sel_hi:[1,0,0]
  v_pk_fma_f32 v[116:117], v[116:117], v[42:43], v[46:47] op_sel_hi:[1,0,0]
  v_pk_fma_f32 v[118:119], v[118:119], v[42:43], v[46:47] op_sel_hi:[1,0,0]
  v_pk_fma_f32 v[120:121], v[120:121], v[42:43], v[46:47] op_sel_hi:[1,0,0]
  v_pk_fma_f32 v[122:123], v[122:123], v[42:43], v[46:47] op_sel_hi:[1,0,0]
  v_pk_fma_f32 v[124:125], v[124:125], v[42:43], v[46:47] op_sel_hi:[1,0,0]
  v_pk_fma_f32 v[126:127], v[126:127], v[42:43], v[46:47] op_sel_hi:[1,0,0]
  s_waitcnt lgkmcnt(0)
  v_lshlrev_b32 v178, 16, v32
  v_and_b32 v179, 0xffff0000, v32
  v_pk_mul_f32 v[112:113], v[112:113], v[178:179]
  v_lshlrev_b32 v180, 16, v33
  v_and_b32 v181, 0xffff0000, v33
  v_pk_mul_f32 v[114:115], v[114:115], v[180:181]
  v_lshlrev_b32 v182, 16, v34
  v_and_b32 v183, 0xffff0000, v34
  v_pk_mul_f32 v[116:117], v[116:117], v[182:183]
  v_lshlrev_b32 v184, 16, v35
  v_and_b32 v185, 0xffff0000, v35
  v_pk_mul_f32 v[118:119], v[118:119], v[184:185]
  v_lshlrev_b32 v178, 16, v36
  v_and_b32 v179, 0xffff0000, v36
  v_pk_mul_f32 v[120:121], v[120:121], v[178:179]
  v_lshlrev_b32 v180, 16, v37
  v_and_b32 v181, 0xffff0000, v37
  v_pk_mul_f32 v[122:123], v[122:123], v[180:181]
  v_lshlrev_b32 v182, 16, v38
  v_and_b32 v183, 0xffff0000, v38
  v_pk_mul_f32 v[124:125], v[124:125], v[182:183]
  v_lshlrev_b32 v184, 16, v39
  v_and_b32 v185, 0xffff0000, v39
  v_pk_mul_f32 v[126:127], v[126:127], v[184:185]
  v_cvt_pk_bf16_f32 v196, v112, v113
  v_cvt_pk_bf16_f32 v197, v114, v115
  v_cvt_pk_bf16_f32 v198, v116, v117
  v_cvt_pk_bf16_f32 v199, v118, v119
  v_cvt_pk_bf16_f32 v200, v120, v121
  v_cvt_pk_bf16_f32 v201, v122, v123
  v_cvt_pk_bf16_f32 v202, v124, v125
  v_cvt_pk_bf16_f32 v203, v126, v127
  s_add_u32 s5, s46, 1
  s_mul_i32 s7, s5, 57344
  s_add_u32 s5, s47, 1
  s_lshl_b32 s5, s5, 11
  s_add_u32 s7, s7, s5
  s_add_u32 s7, s7, s56
  buffer_store_dwordx4 v[196:199], v7, s[16:19], s7 offen sc1
  buffer_store_dwordx4 v[200:203], v7, s[16:19], s7 offen offset:1024 sc1
  s_endpgm
k5_sp_kernel_pfrole_2:
  s_sub_u32 s5, s29, 28
  s_lshl_b32 s5, s5, 9
  v_add_u32 v204, s5, v0
  v_lshlrev_b32 v204, 7, v204
  s_load_dwordx2 s[58:59], s[0:1], 56
  s_waitcnt lgkmcnt(0)
  s_mov_b32 s60, s58
  s_and_b32 s61, s59, 0xffff
  s_mov_b32 s62, 0xc4000
  s_mov_b32 s63, 0x20000
  s_mov_b32 s5, 0x0
  buffer_load_dword v205, v204, s[60:63], s5 offen
  s_mov_b32 s5, 0x40000
  buffer_load_dword v206, v204, s[60:63], s5 offen
  s_mov_b32 s5, 0x80000
  buffer_load_dword v207, v204, s[60:63], s5 offen
  s_mov_b32 s5, 0xc0000
  buffer_load_dword v208, v204, s[60:63], s5 offen
k5_sp_kernel_done_1:
  s_endpgm
k5_sp_kernel_end:
.globl k6_wout_kernel
.p2align 8
.type k6_wout_kernel,@function
k6_wout_kernel:
  s_cmp_ge_u32 s2, 224
  s_cbranch_scc1 k6_wout_kernel_done_1
  v_lshrrev_b32 v2, 6, v0
  v_and_b32 v1, 63, v0
  v_readfirstlane_b32 s4, v2
  s_load_dwordx2 s[8:9], s[0:1], 56
  s_load_dwordx2 s[10:11], s[0:1], 64
  s_load_dwordx2 s[12:13], s[0:1], 80
  s_and_b32 s28, s2, 7
  s_lshr_b32 s29, s2, 3
  s_and_b32 s32, s4, 3
  s_mul_i32 s5, s29, 37
  s_lshr_b32 s5, s5, 8
  s_mul_i32 s6, s5, 7
  s_sub_u32 s31, s29, s6
  s_lshl_b32 s30, s28, 2
  s_add_u32 s30, s30, s5
  s_cmp_lt_u32 s4, 4
  s_cbranch_scc1 k6_wout_kernel_compute_2
  v_lshlrev_b32 v5, 4, v1
  v_lshrrev_b32 v2, 3, v1
  v_mul_u32_u24 v2, 896, v2
  v_bfe_u32 v3, v1, 4, 1
  v_lshlrev_b32 v3, 2, v3
  v_and_b32 v4, 7, v1
  v_xor_b32 v3, v3, v4
  v_lshl_add_u32 v6, v3, 4, v2
  s_lshr_b32 s5, s32, 1
  s_lshl_b32 s6, s30, 1
  s_add_u32 s6, s6, s5
  s_mul_i32 s33, s6, 57344
  s_and_b32 s6, s32, 1
  s_mul_i32 s35, s6, 4194304
  s_add_u32 s33, s33, s35
  s_add_u32 s33, s33, 0x1300000
  s_lshl_b32 s35, s6, 13
  s_lshl_b32 s5, s5, 12
  s_add_u32 s35, s35, s5
  s_mul_i32 s34, s32, 14336
  s_lshl_b32 s6, s31, 7
  s_add_u32 s34, s34, s6
  s_lshl_b32 s36, s32, 11
  s_add_u32 s36, s36, 16384
  s_lshl_b32 s5, s31, 1
  s_and_b32 s6, s30, 3
  s_mul_i32 s6, s6, 3
  s_add_u32 s37, s5, s6
  s_cmp_ge_u32 s37, 14
  s_cselect_b32 s5, 14, 0
  s_sub_u32 s37, s37, s5
  s_mov_b32 s37, 0
  s_waitcnt lgkmcnt(0)
  s_mov_b32 s16, s12
  s_and_b32 s17, s13, 0xffff
  s_mov_b32 s18, 0x10000000
  s_mov_b32 s19, 0x20000
  s_mov_b32 s20, s8
  s_and_b32 s21, s9, 0xffff
  s_mov_b32 s22, 0xc4000
  s_mov_b32 s23, 0x20000
  s_add_u32 s38, s37, 0
  s_cmp_ge_u32 s38, 14
  s_cselect_b32 s3, 14, 0
  s_sub_u32 s38, s38, s3
  s_lshl_b32 s39, s38, 12
  s_add_u32 s39, s39, s33
  s_mul_i32 s40, s38, 57344
  s_add_u32 s40, s40, s34
  s_add_u32 s7, s39, 0x0
  s_add_u32 m0, s35, 0x0
  s_nop 0
  buffer_load_dwordx4 v5, s[16:19], s7 offen lds
  s_add_u32 s7, s39, 0x400
  s_add_u32 m0, s35, 0x400
  s_nop 0
  buffer_load_dwordx4 v5, s[16:19], s7 offen lds
  s_add_u32 s7, s39, 0x800
  s_add_u32 m0, s35, 0x800
  s_nop 0
  buffer_load_dwordx4 v5, s[16:19], s7 offen lds
  s_add_u32 s7, s39, 0xc00
  s_add_u32 m0, s35, 0xc00
  s_nop 0
  buffer_load_dwordx4 v5, s[16:19], s7 offen lds
  s_add_u32 s7, s40, 0x0
  s_add_u32 m0, s36, 0x0
  s_nop 0
  buffer_load_dwordx4 v6, s[20:23], s7 offen lds
  s_add_u32 s7, s40, 0x1c00
  s_add_u32 m0, s36, 0x400
  s_nop 0
  buffer_load_dwordx4 v6, s[20:23], s7 offen lds
  s_add_u32 s38, s37, 1
  s_cmp_ge_u32 s38, 14
  s_cselect_b32 s3, 14, 0
  s_sub_u32 s38, s38, s3
  s_lshl_b32 s39, s38, 12
  s_add_u32 s39, s39, s33
  s_mul_i32 s40, s38, 57344
  s_add_u32 s40, s40, s34
  s_add_u32 s7, s39, 0x0
  s_add_u32 m0, s35, 0x6000
  s_nop 0
  buffer_load_dwordx4 v5, s[16:19], s7 offen lds
  s_add_u32 s7, s39, 0x400
  s_add_u32 m0, s35, 0x6400
  s_nop 0
  buffer_load_dwordx4 v5, s[16:19], s7 offen lds
  s_add_u32 s7, s39, 0x800
  s_add_u32 m0, s35, 0x6800
  s_nop 0
  buffer_load_dwordx4 v5, s[16:19], s7 offen lds
  s_add_u32 s7, s39, 0xc00
  s_add_u32 m0, s35, 0x6c00
  s_nop 0
  buffer_load_dwordx4 v5, s[16:19], s7 offen lds
  s_add_u32 s7, s40, 0x0
  s_add_u32 m0, s36, 0x6000
  s_nop 0
  buffer_load_dwordx4 v6, s[20:23], s7 offen lds
  s_add_u32 s7, s40, 0x1c00
  s_add_u32 m0, s36, 0x6400
  s_nop 0
  buffer_load_dwordx4 v6, s[20:23], s7 offen lds
  s_add_u32 s38, s37, 2
  s_cmp_ge_u32 s38, 14
  s_cselect_b32 s3, 14, 0
  s_sub_u32 s38, s38, s3
  s_lshl_b32 s39, s38, 12
  s_add_u32 s39, s39, s33
  s_mul_i32 s40, s38, 57344
  s_add_u32 s40, s40, s34
  s_add_u32 s7, s39, 0x0
  s_add_u32 m0, s35, 0xc000
  s_nop 0
  buffer_load_dwordx4 v5, s[16:19], s7 offen lds
  s_add_u32 s7, s39, 0x400
  s_add_u32 m0, s35, 0xc400
  s_nop 0
  buffer_load_dwordx4 v5, s[16:19], s7 offen lds
  s_add_u32 s7, s39, 0x800
  s_add_u32 m0, s35, 0xc800
  s_nop 0
  buffer_load_dwordx4 v5, s[16:19], s7 offen lds
  s_add_u32 s7, s39, 0xc00
  s_add_u32 m0, s35, 0xcc00
  s_nop 0
  buffer_load_dwordx4 v5, s[16:19], s7 offen lds
  s_add_u32 s7, s40, 0x0
  s_add_u32 m0, s36, 0xc000
  s_nop 0
  buffer_load_dwordx4 v6, s[20:23], s7 offen lds
  s_add_u32 s7, s40, 0x1c00
  s_add_u32 m0, s36, 0xc400
  s_nop 0
  buffer_load_dwordx4 v6, s[20:23], s7 offen lds
  s_waitcnt vmcnt(12)
  s_barrier
  s_add_u32 s38, s37, 3
  s_cmp_ge_u32 s38, 14
  s_cselect_b32 s3, 14, 0
  s_sub_u32 s38, s38, s3
  s_lshl_b32 s39, s38, 12
  s_add_u32 s39, s39, s33
  s_mul_i32 s40, s38, 57344
  s_add_u32 s40, s40, s34
  s_add_u32 s7, s39, 0x0
  s_add_u32 m0, s35, 0x12000
  s_nop 0
  buffer_load_dwordx4 v5, s[16:19], s7 offen lds
  s_add_u32 s7, s39, 0x400
  s_add_u32 m0, s35, 0x12400
  s_nop 0
  buffer_load_dwordx4 v5, s[16:19], s7 offen lds
  s_add_u32 s7, s39, 0x800
  s_add_u32 m0, s35, 0x12800
  s_nop 0
  buffer_load_dwordx4 v5, s[16:19], s7 offen lds
  s_add_u32 s7, s39, 0xc00
  s_add_u32 m0, s35, 0x12c00
  s_nop 0
  buffer_load_dwordx4 v5, s[16:19], s7 offen lds
  s_add_u32 s7, s40, 0x0
  s_add_u32 m0, s36, 0x12000
  s_nop 0
  buffer_load_dwordx4 v6, s[20:23], s7 offen lds
  s_add_u32 s7, s40, 0x1c00
  s_add_u32 m0, s36, 0x12400
  s_nop 0
  buffer_load_dwordx4 v6, s[20:23], s7 offen lds
  s_add_u32 s38, s37, 4
  s_cmp_ge_u32 s38, 14
  s_cselect_b32 s3, 14, 0
  s_sub_u32 s38, s38, s3
  s_lshl_b32 s39, s38, 12
  s_add_u32 s39, s39, s33
  s_mul_i32 s40, s38, 57344
  s_add_u32 s40, s40, s34
  s_add_u32 s7, s39, 0x0
  s_add_u32 m0, s35, 0x18000
  s_nop 0
  buffer_load_dwordx4 v5, s[16:19], s7 offen lds
  s_add_u32 s7, s39, 0x400
  s_add_u32 m0, s35, 0x18400
  s_nop 0
  buffer_load_dwordx4 v5, s[16:19], s7 offen lds
  s_add_u32 s7, s39, 0x800
  s_add_u32 m0, s35, 0x18800
  s_nop 0
  buffer_load_dwordx4 v5, s[16:19], s7 offen lds
  s_add_u32 s7, s39, 0xc00
  s_add_u32 m0, s35, 0x18c00
  s_nop 0
  buffer_load_dwordx4 v5, s[16:19], s7 offen lds
  s_add_u32 s7, s40, 0x0
  s_add_u32 m0, s36, 0x18000
  s_nop 0
  buffer_load_dwordx4 v6, s[20:23], s7 offen lds
  s_add_u32 s7, s40, 0x1c00
  s_add_u32 m0, s36, 0x18400
  s_nop 0
  buffer_load_dwordx4 v6, s[20:23], s7 offen lds
  s_add_u32 s38, s37, 5
  s_cmp_ge_u32 s38, 14
  s_cselect_b32 s3, 14, 0
  s_sub_u32 s38, s38, s3
  s_lshl_b32 s39, s38, 12
  s_add_u32 s39, s39, s33
  s_mul_i32 s40, s38, 57344
  s_add_u32 s40, s40, s34
  s_add_u32 s7, s39, 0x0
  s_add_u32 m0, s35, 0x1e000
  s_nop 0
  buffer_load_dwordx4 v5, s[16:19], s7 offen lds
  s_add_u32 s7, s39, 0x400
  s_add_u32 m0, s35, 0x1e400
  s_nop 0
  buffer_load_dwordx4 v5, s[16:19], s7 offen lds
  s_add_u32 s7, s39, 0x800
  s_add_u32 m0, s35, 0x1e800
  s_nop 0
  buffer_load_dwordx4 v5, s[16:19], s7 offen lds
  s_add_u32 s7, s39, 0xc00
  s_add_u32 m0, s35, 0x1ec00
  s_nop 0
  buffer_load_dwordx4 v5, s[16:19], s7 offen lds
  s_add_u32 s7, s40, 0x0
  s_add_u32 m0, s36, 0x1e000
  s_nop 0
  buffer_load_dwordx4 v6, s[20:23], s7 offen lds
  s_add_u32 s7, s40, 0x1c00
  s_add_u32 m0, s36, 0x1e400
  s_nop 0
  buffer_load_dwordx4 v6, s[20:23], s7 offen lds
  s_waitcnt vmcnt(24)
  s_barrier
  s_waitcnt vmcnt(18)
  s_barrier
  s_add_u32 s38, s37, 6
  s_cmp_ge_u32 s38, 14
  s_cselect_b32 s3, 14, 0
  s_sub_u32 s38, s38, s3
  s_lshl_b32 s39, s38, 12
  s_add_u32 s39, s39, s33
  s_mul_i32 s40, s38, 57344
  s_add_u32 s40, s40, s34
  s_add_u32 s7, s39, 0x0
  s_add_u32 m0, s35, 0x0
  s_nop 0
  buffer_load_dwordx4 v5, s[16:19], s7 offen lds
  s_add_u32 s7, s39, 0x400
  s_add_u32 m0, s35, 0x400
  s_nop 0
  buffer_load_dwordx4 v5, s[16:19], s7 offen lds
  s_add_u32 s7, s39, 0x800
  s_add_u32 m0, s35, 0x800
  s_nop 0
  buffer_load_dwordx4 v5, s[16:19], s7 offen lds
  s_add_u32 s7, s39, 0xc00
  s_add_u32 m0, s35, 0xc00
  s_nop 0
  buffer_load_dwordx4 v5, s[16:19], s7 offen lds
  s_add_u32 s7, s40, 0x0
  s_add_u32 m0, s36, 0x0
  s_nop 0
  buffer_load_dwordx4 v6, s[20:23], s7 offen lds
  s_add_u32 s7, s40, 0x1c00
  s_add_u32 m0, s36, 0x400
  s_nop 0
  buffer_load_dwordx4 v6, s[20:23], s7 offen lds
  s_waitcnt vmcnt(18)
  s_barrier
  s_add_u32 s38, s37, 7
  s_cmp_ge_u32 s38, 14
  s_cselect_b32 s3, 14, 0
  s_sub_u32 s38, s38, s3
  s_lshl_b32 s39, s38, 12
  s_add_u32 s39, s39, s33
  s_mul_i32 s40, s38, 57344
  s_add_u32 s40, s40, s34
  s_add_u32 s7, s39, 0x0
  s_add_u32 m0, s35, 0x6000
  s_nop 0
  buffer_load_dwordx4 v5, s[16:19], s7 offen lds
  s_add_u32 s7, s39, 0x400
  s_add_u32 m0, s35, 0x6400
  s_nop 0
  buffer_load_dwordx4 v5, s[16:19], s7 offen lds
  s_add_u32 s7, s39, 0x800
  s_add_u32 m0, s35, 0x6800
  s_nop 0
  buffer_load_dwordx4 v5, s[16:19], s7 offen lds
  s_add_u32 s7, s39, 0xc00
  s_add_u32 m0, s35, 0x6c00
  s_nop 0
  buffer_load_dwordx4 v5, s[16:19], s7 offen lds
  s_add_u32 s7, s40, 0x0
  s_add_u32 m0, s36, 0x6000
  s_nop 0
  buffer_load_dwordx4 v6, s[20:23], s7 offen lds
  s_add_u32 s7, s40, 0x1c00
  s_add_u32 m0, s36, 0x6400
  s_nop 0
  buffer_load_dwordx4 v6, s[20:23], s7 offen lds
  s_waitcnt vmcnt(18)
  s_barrier
  s_add_u32 s38, s37, 8
  s_cmp_ge_u32 s38, 14
  s_cselect_b32 s3, 14, 0
  s_sub_u32 s38, s38, s3
  s_lshl_b32 s39, s38, 12
  s_add_u32 s39, s39, s33
  s_mul_i32 s40, s38, 57344
  s_add_u32 s40, s40, s34
  s_add_u32 s7, s39, 0x0
  s_add_u32 m0, s35, 0xc000
  s_nop 0
  buffer_load_dwordx4 v5, s[16:19], s7 offen lds
  s_add_u32 s7, s39, 0x400
  s_add_u32 m0, s35, 0xc400
  s_nop 0
  buffer_load_dwordx4 v5, s[16:19], s7 offen lds
  s_add_u32 s7, s39, 0x800
  s_add_u32 m0, s35, 0xc800
  s_nop 0
  buffer_load_dwordx4 v5, s[16:19], s7 offen lds
  s_add_u32 s7, s39, 0xc00
  s_add_u32 m0, s35, 0xcc00
  s_nop 0
  buffer_load_dwordx4 v5, s[16:19], s7 offen lds
  s_add_u32 s7, s40, 0x0
  s_add_u32 m0, s36, 0xc000
  s_nop 0
  buffer_load_dwordx4 v6, s[20:23], s7 offen lds
  s_add_u32 s7, s40, 0x1c00
  s_add_u32 m0, s36, 0xc400
  s_nop 0
  buffer_load_dwordx4 v6, s[20:23], s7 offen lds
  s_waitcnt vmcnt(18)
  s_barrier
  s_add_u32 s38, s37, 9
  s_cmp_ge_u32 s38, 14
  s_cselect_b32 s3, 14, 0
  s_sub_u32 s38, s38, s3
  s_lshl_b32 s39, s38, 12
  s_add_u32 s39, s39, s33
  s_mul_i32 s40, s38, 57344
  s_add_u32 s40, s40, s34
  s_add_u32 s7, s39, 0x0
  s_add_u32 m0, s35, 0x12000
  s_nop 0
  buffer_load_dwordx4 v5, s[16:19], s7 offen lds
  s_add_u32 s7, s39, 0x400
  s_add_u32 m0, s35, 0x12400
  s_nop 0
  buffer_load_dwordx4 v5, s[16:19], s7 offen lds
  s_add_u32 s7, s39, 0x800
  s_add_u32 m0, s35, 0x12800
  s_nop 0
  buffer_load_dwordx4 v5, s[16:19], s7 offen lds
  s_add_u32 s7, s39, 0xc00
  s_add_u32 m0, s35, 0x12c00
  s_nop 0
  buffer_load_dwordx4 v5, s[16:19], s7 offen lds
  s_add_u32 s7, s40, 0x0
  s_add_u32 m0, s36, 0x12000
  s_nop 0
  buffer_load_dwordx4 v6, s[20:23], s7 offen lds
  s_add_u32 s7, s40, 0x1c00
  s_add_u32 m0, s36, 0x12400
  s_nop 0
  buffer_load_dwordx4 v6, s[20:23], s7 offen lds
  s_waitcnt vmcnt(18)
  s_barrier
  s_add_u32 s38, s37, 10
  s_cmp_ge_u32 s38, 14
  s_cselect_b32 s3, 14, 0
  s_sub_u32 s38, s38, s3
  s_lshl_b32 s39, s38, 12
  s_add_u32 s39, s39, s33
  s_mul_i32 s40, s38, 57344
  s_add_u32 s40, s40, s34
  s_add_u32 s7, s39, 0x0
  s_add_u32 m0, s35, 0x18000
  s_nop 0
  buffer_load_dwordx4 v5, s[16:19], s7 offen lds
  s_add_u32 s7, s39, 0x400
  s_add_u32 m0, s35, 0x18400
  s_nop 0
  buffer_load_dwordx4 v5, s[16:19], s7 offen lds
  s_add_u32 s7, s39, 0x800
  s_add_u32 m0, s35, 0x18800
  s_nop 0
  buffer_load_dwordx4 v5, s[16:19], s7 offen lds
  s_add_u32 s7, s39, 0xc00
  s_add_u32 m0, s35, 0x18c00
  s_nop 0
  buffer_load_dwordx4 v5, s[16:19], s7 offen lds
  s_add_u32 s7, s40, 0x0
  s_add_u32 m0, s36, 0x18000
  s_nop 0
  buffer_load_dwordx4 v6, s[20:23], s7 offen lds
  s_add_u32 s7, s40, 0x1c00
  s_add_u32 m0, s36, 0x18400
  s_nop 0
  buffer_load_dwordx4 v6, s[20:23], s7 offen lds
  s_waitcnt vmcnt(18)
  s_barrier
  s_add_u32 s38, s37, 11
  s_cmp_ge_u32 s38, 14
  s_cselect_b32 s3, 14, 0
  s_sub_u32 s38, s38, s3
  s_lshl_b32 s39, s38, 12
  s_add_u32 s39, s39, s33
  s_mul_i32 s40, s38, 57344
  s_add_u32 s40, s40, s34
  s_add_u32 s7, s39, 0x0
  s_add_u32 m0, s35, 0x1e000
  s_nop 0
  buffer_load_dwordx4 v5, s[16:19], s7 offen lds
  s_add_u32 s7, s39, 0x400
  s_add_u32 m0, s35, 0x1e400
  s_nop 0
  buffer_load_dwordx4 v5, s[16:19], s7 offen lds
  s_add_u32 s7, s39, 0x800
  s_add_u32 m0, s35, 0x1e800
  s_nop 0
  buffer_load_dwordx4 v5, s[16:19], s7 offen lds
  s_add_u32 s7, s39, 0xc00
  s_add_u32 m0, s35, 0x1ec00
  s_nop 0
  buffer_load_dwordx4 v5, s[16:19], s7 offen lds
  s_add_u32 s7, s40, 0x0
  s_add_u32 m0, s36, 0x1e000
  s_nop 0
  buffer_load_dwordx4 v6, s[20:23], s7 offen lds
  s_add_u32 s7, s40, 0x1c00
  s_add_u32 m0, s36, 0x1e400
  s_nop 0
  buffer_load_dwordx4 v6, s[20:23], s7 offen lds
  s_waitcnt vmcnt(18)
  s_barrier
  s_add_u32 s38, s37, 12
  s_cmp_ge_u32 s38, 14
  s_cselect_b32 s3, 14, 0
  s_sub_u32 s38, s38, s3
  s_lshl_b32 s39, s38, 12
  s_add_u32 s39, s39, s33
  s_mul_i32 s40, s38, 57344
  s_add_u32 s40, s40, s34
  s_add_u32 s7, s39, 0x0
  s_add_u32 m0, s35, 0x0
  s_nop 0
  buffer_load_dwordx4 v5, s[16:19], s7 offen lds
  s_add_u32 s7, s39, 0x400
  s_add_u32 m0, s35, 0x400
  s_nop 0
  buffer_load_dwordx4 v5, s[16:19], s7 offen lds
  s_add_u32 s7, s39, 0x800
  s_add_u32 m0, s35, 0x800
  s_nop 0
  buffer_load_dwordx4 v5, s[16:19], s7 offen lds
  s_add_u32 s7, s39, 0xc00
  s_add_u32 m0, s35, 0xc00
  s_nop 0
  buffer_load_dwordx4 v5, s[16:19], s7 offen lds
  s_add_u32 s7, s40, 0x0
  s_add_u32 m0, s36, 0x0
  s_nop 0
  buffer_load_dwordx4 v6, s[20:23], s7 offen lds
  s_add_u32 s7, s40, 0x1c00
  s_add_u32 m0, s36, 0x400
  s_nop 0
  buffer_load_dwordx4 v6, s[20:23], s7 offen lds
  s_waitcnt vmcnt(18)
  s_barrier
  s_add_u32 s38, s37, 13
  s_cmp_ge_u32 s38, 14
  s_cselect_b32 s3, 14, 0
  s_sub_u32 s38, s38, s3
  s_lshl_b32 s39, s38, 12
  s_add_u32 s39, s39, s33
  s_mul_i32 s40, s38, 57344
  s_add_u32 s40, s40, s34
  s_add_u32 s7, s39, 0x0
  s_add_u32 m0, s35, 0x6000
  s_nop 0
  buffer_load_dwordx4 v5, s[16:19], s7 offen lds
  s_add_u32 s7, s39, 0x400
  s_add_u32 m0, s35, 0x6400
  s_nop 0
  buffer_load_dwordx4 v5, s[16:19], s7 offen lds
  s_add_u32 s7, s39, 0x800
  s_add_u32 m0, s35, 0x6800
  s_nop 0
  buffer_load_dwordx4 v5, s[16:19], s7 offen lds
  s_add_u32 s7, s39, 0xc00
  s_add_u32 m0, s35, 0x6c00
  s_nop 0
  buffer_load_dwordx4 v5, s[16:19], s7 offen lds
  s_add_u32 s7, s40, 0x0
  s_add_u32 m0, s36, 0x6000
  s_nop 0
  buffer_load_dwordx4 v6, s[20:23], s7 offen lds
  s_add_u32 s7, s40, 0x1c00
  s_add_u32 m0, s36, 0x6400
  s_nop 0
  buffer_load_dwordx4 v6, s[20:23], s7 offen lds
  s_waitcnt vmcnt(18)
  s_barrier
  s_waitcnt vmcnt(12)
  s_barrier
  s_waitcnt vmcnt(6)
  s_barrier
  s_waitcnt vmcnt(0)
  s_barrier
  s_endpgm
k6_wout_kernel_compute_2:
  v_and_b32 v5, 31, v1
  v_lshrrev_b32 v6, 5, v1
  s_and_b32 s41, s4, 1
  s_lshr_b32 s42, s4, 1
  s_lshl_b32 s43, s30, 1
  s_add_u32 s43, s43, s41
  s_lshl_b32 s44, s31, 1
  s_add_u32 s44, s44, s42
  v_lshlrev_b32 v7, 4, v1
  s_mul_i32 s7, s43, 28672
  s_lshl_b32 s5, s44, 11
  s_add_u32 s7, s7, s5
  s_add_u32 s7, s7, 0x800000
  s_waitcnt lgkmcnt(0)
  s_mov_b32 s16, s12
  s_and_b32 s17, s13, 0xffff
  s_mov_b32 s18, 0x10000000
  s_mov_b32 s19, 0x20000
  s_mov_b32 s24, s10
  s_and_b32 s25, s11, 0xffff
  s_mov_b32 s26, 0x1c0000
  s_mov_b32 s27, 0x20000
  buffer_load_dwordx4 v[8:11], v7, s[16:19], s7 offen
  buffer_load_dwordx4 v[12:15], v7, s[16:19], s7 offen offset:1024
  s_lshl_b32 s5, s41, 12
  v_add_u32 v16, s5, v7
  v_bfe_u32 v2, v1, 2, 2
  v_lshl_add_u32 v2, v6, 2, v2
  v_lshlrev_b32 v17, 7, v2
  v_add_u32 v17, 16384, v17
  v_bfe_u32 v2, v1, 4, 1
  v_lshlrev_b32 v2, 1, v2
  v_bfe_u32 v3, v1, 1, 1
  v_add_u32 v2, v2, v3
  s_lshl_b32 s5, s42, 2
  v_add_u32 v2, s5, v2
  v_bfe_u32 v3, v1, 3, 1
  v_lshlrev_b32 v3, 2, v3
  v_xor_b32 v2, v2, v3
  v_lshl_add_u32 v17, v2, 4, v17
  v_and_b32 v2, 1, v1
  v_lshl_add_u32 v17, v2, 3, v17
  v_add_u32 v18, 73728, v16
  v_add_u32 v19, 73728, v17
  s_barrier
  ds_read_b128 v[36:39], v16 offset:0
  ds_read_b128 v[40:43], v16 offset:8192
  ds_read_b64_tr_b16 v[60:61], v17 offset:0
  ds_read_b64_tr_b16 v[62:63], v17 offset:1024
  ds_read_b128 v[44:47], v16 offset:1024
  ds_read_b128 v[48:51], v16 offset:9216
  ds_read_b64_tr_b16 v[64:65], v17 offset:2048
  ds_read_b64_tr_b16 v[66:67], v17 offset:3072
  s_waitcnt lgkmcnt(4)
  v_mfma_f32_32x32x16_bf16 v[20:35], v[60:63], v[36:39], 0
  ds_read_b128 v[52:55], v16 offset:2048
  ds_read_b128 v[56:59], v16 offset:10240
  v_mfma_f32_32x32x16_bf16 v[20:35], v[60:63], v[40:43], v[20:35]
  ds_read_b64_tr_b16 v[68:69], v17 offset:4096
  ds_read_b64_tr_b16 v[70:71], v17 offset:5120
  s_waitcnt lgkmcnt(4)
  v_mfma_f32_32x32x16_bf16 v[20:35], v[64:67], v[44:47], v[20:35]
  ds_read_b128 v[36:39], v16 offset:3072
  ds_read_b128 v[40:43], v16 offset:11264
  v_mfma_f32_32x32x16_bf16 v[20:35], v[64:67], v[48:51], v[20:35]
  ds_read_b64_tr_b16 v[60:61], v17 offset:6144
  ds_read_b64_tr_b16 v[62:63], v17 offset:7168
  s_waitcnt lgkmcnt(4)
  s_barrier
  v_mfma_f32_32x32x16_bf16 v[20:35], v[68:71], v[52:55], v[20:35]
  ds_read_b128 v[44:47], v16 offset:24576
  ds_read_b128 v[48:51], v16 offset:32768
  v_mfma_f32_32x32x16_bf16 v[20:35], v[68:71], v[56:59], v[20:35]
  ds_read_b64_tr_b16 v[64:65], v17 offset:24576
  ds_read_b64_tr_b16 v[66:67], v17 offset:25600
  s_waitcnt lgkmcnt(4)
  v_mfma_f32_32x32x16_bf16 v[20:35], v[60:63], v[36:39], v[20:35]
  ds_read_b128 v[52:55], v16 offset:25600
  ds_read_b128 v[56:59], v16 offset:33792
  v_mfma_f32_32x32x16_bf16 v[20:35], v[60:63], v[40:43], v[20:35]
  ds_read_b64_tr_b16 v[68:69], v17 offset:26624
  ds_read_b64_tr_b16 v[70:71], v17 offset:27648
  s_waitcnt lgkmcnt(4)
  v_mfma_f32_32x32x16_bf16 v[20:35], v[64:67], v[44:47], v[20:35]
  ds_read_b128 v[36:39], v16 offset:26624
  ds_read_b128 v[40:43], v16 offset:34816
  v_mfma_f32_32x32x16_bf16 v[20:35], v[64:67], v[48:51], v[20:35]
  ds_read_b64_tr_b16 v[60:61], v17 offset:28672
  ds_read_b64_tr_b16 v[62:63], v17 offset:29696
  s_waitcnt lgkmcnt(4)
  v_mfma_f32_32x32x16_bf16 v[20:35], v[68:71], v[52:55], v[20:35]
  ds_read_b128 v[44:47], v16 offset:27648
  ds_read_b128 v[48:51], v16 offset:35840
  v_mfma_f32_32x32x16_bf16 v[20:35], v[68:71], v[56:59], v[20:35]
  ds_read_b64_tr_b16 v[64:65], v17 offset:30720
  ds_read_b64_tr_b16 v[66:67], v17 offset:31744
  s_waitcnt lgkmcnt(4)
  s_barrier
  v_mfma_f32_32x32x16_bf16 v[20:35], v[60:63], v[36:39], v[20:35]
  ds_read_b128 v[52:55], v16 offset:49152
  ds_read_b128 v[56:59], v16 offset:57344
  v_mfma_f32_32x32x16_bf16 v[20:35], v[60:63], v[40:43], v[20:35]
  ds_read_b64_tr_b16 v[68:69], v17 offset:49152
  ds_read_b64_tr_b16 v[70:71], v17 offset:50176
  s_waitcnt lgkmcnt(4)
  v_mfma_f32_32x32x16_bf16 v[20:35], v[64:67], v[44:47], v[20:35]
  ds_read_b128 v[36:39], v16 offset:50176
  ds_read_b128 v[40:43], v16 offset:58368
  v_mfma_f32_32x32x16_bf16 v[20:35], v[64:67], v[48:51], v[20:35]
  ds_read_b64_tr_b16 v[60:61], v17 offset:51200
  ds_read_b64_tr_b16 v[62:63], v17 offset:52224
  s_waitcnt lgkmcnt(4)
  v_mfma_f32_32x32x16_bf16 v[20:35], v[68:71], v[52:55], v[20:35]
  ds_read_b128 v[44:47], v16 offset:51200
  ds_read_b128 v[48:51], v16 offset:59392
  v_mfma_f32_32x32x16_bf16 v[20:35], v[68:71], v[56:59], v[20:35]
  ds_read_b64_tr_b16 v[64:65], v17 offset:53248
  ds_read_b64_tr_b16 v[66:67], v17 offset:54272
  s_waitcnt lgkmcnt(4)
  v_mfma_f32_32x32x16_bf16 v[20:35], v[60:63], v[36:39], v[20:35]
  ds_read_b128 v[52:55], v16 offset:52224
  ds_read_b128 v[56:59], v16 offset:60416
  v_mfma_f32_32x32x16_bf16 v[20:35], v[60:63], v[40:43], v[20:35]
  ds_read_b64_tr_b16 v[68:69], v17 offset:55296
  ds_read_b64_tr_b16 v[70:71], v17 offset:56320
  s_waitcnt lgkmcnt(4)
  s_barrier
  v_mfma_f32_32x32x16_bf16 v[20:35], v[64:67], v[44:47], v[20:35]
  ds_read_b128 v[36:39], v18 offset:0
  ds_read_b128 v[40:43], v18 offset:8192
  v_mfma_f32_32x32x16_bf16 v[20:35], v[64:67], v[48:51], v[20:35]
  ds_read_b64_tr_b16 v[60:61], v19 offset:0
  ds_read_b64_tr_b16 v[62:63], v19 offset:1024
  s_waitcnt lgkmcnt(4)
  v_mfma_f32_32x32x16_bf16 v[20:35], v[68:71], v[52:55], v[20:35]
  ds_read_b128 v[44:47], v18 offset:1024
  ds_read_b128 v[48:51], v18 offset:9216
  v_mfma_f32_32x32x16_bf16 v[20:35], v[68:71], v[56:59], v[20:35]
  ds_read_b64_tr_b16 v[64:65], v19 offset:2048
  ds_read_b64_tr_b16 v[66:67], v19 offset:3072
  s_waitcnt lgkmcnt(4)
  v_mfma_f32_32x32x16_bf16 v[20:35], v[60:63], v[36:39], v[20:35]
  ds_read_b128 v[52:55], v18 offset:2048
  ds_read_b128 v[56:59], v18 offset:10240
  v_mfma_f32_32x32x16_bf16 v[20:35], v[60:63], v[40:43], v[20:35]
  ds_read_b64_tr_b16 v[68:69], v19 offset:4096
  ds_read_b64_tr_b16 v[70:71], v19 offset:5120
  s_waitcnt lgkmcnt(4)
  v_mfma_f32_32x32x16_bf16 v[20:35], v[64:67], v[44:47], v[20:35]
  ds_read_b128 v[36:39], v18 offset:3072
  ds_read_b128 v[40:43], v18 offset:11264
  v_mfma_f32_32x32x16_bf16 v[20:35], v[64:67], v[48:51], v[20:35]
  ds_read_b64_tr_b16 v[60:61], v19 offset:6144
  ds_read_b64_tr_b16 v[62:63], v19 offset:7168
  s_waitcnt lgkmcnt(4)
  s_barrier
  v_mfma_f32_32x32x16_bf16 v[20:35], v[68:71], v[52:55], v[20:35]
  ds_read_b128 v[44:47], v18 offset:24576
  ds_read_b128 v[48:51], v18 offset:32768
  v_mfma_f32_32x32x16_bf16 v[20:35], v[68:71], v[56:59], v[20:35]
  ds_read_b64_tr_b16 v[64:65], v19 offset:24576
  ds_read_b64_tr_b16 v[66:67], v19 offset:25600
  s_waitcnt lgkmcnt(4)
  v_mfma_f32_32x32x16_bf16 v[20:35], v[60:63], v[36:39], v[20:35]
  ds_read_b128 v[52:55], v18 offset:25600
  ds_read_b128 v[56:59], v18 offset:33792
  v_mfma_f32_32x32x16_bf16 v[20:35], v[60:63], v[40:43], v[20:35]
  ds_read_b64_tr_b16 v[68:69], v19 offset:26624
  ds_read_b64_tr_b16 v[70:71], v19 offset:27648
  s_waitcnt lgkmcnt(4)
  v_mfma_f32_32x32x16_bf16 v[20:35], v[64:67], v[44:47], v[20:35]
  ds_read_b128 v[36:39], v18 offset:26624
  ds_read_b128 v[40:43], v18 offset:34816
  v_mfma_f32_32x32x16_bf16 v[20:35], v[64:67], v[48:51], v[20:35]
  ds_read_b64_tr_b16 v[60:61], v19 offset:28672
  ds_read_b64_tr_b16 v[62:63], v19 offset:29696
  s_waitcnt lgkmcnt(4)
  v_mfma_f32_32x32x16_bf16 v[20:35], v[68:71], v[52:55], v[20:35]
  ds_read_b128 v[44:47], v18 offset:27648
  ds_read_b128 v[48:51], v18 offset:35840
  v_mfma_f32_32x32x16_bf16 v[20:35], v[68:71], v[56:59], v[20:35]
  ds_read_b64_tr_b16 v[64:65], v19 offset:30720
  ds_read_b64_tr_b16 v[66:67], v19 offset:31744
  s_waitcnt lgkmcnt(4)
  s_barrier
  v_mfma_f32_32x32x16_bf16 v[20:35], v[60:63], v[36:39], v[20:35]
  ds_read_b128 v[52:55], v18 offset:49152
  ds_read_b128 v[56:59], v18 offset:57344
  v_mfma_f32_32x32x16_bf16 v[20:35], v[60:63], v[40:43], v[20:35]
  ds_read_b64_tr_b16 v[68:69], v19 offset:49152
  ds_read_b64_tr_b16 v[70:71], v19 offset:50176
  s_waitcnt lgkmcnt(4)
  v_mfma_f32_32x32x16_bf16 v[20:35], v[64:67], v[44:47], v[20:35]
  ds_read_b128 v[36:39], v18 offset:50176
  ds_read_b128 v[40:43], v18 offset:58368
  v_mfma_f32_32x32x16_bf16 v[20:35], v[64:67], v[48:51], v[20:35]
  ds_read_b64_tr_b16 v[60:61], v19 offset:51200
  ds_read_b64_tr_b16 v[62:63], v19 offset:52224
  s_waitcnt lgkmcnt(4)
  v_mfma_f32_32x32x16_bf16 v[20:35], v[68:71], v[52:55], v[20:35]
  ds_read_b128 v[44:47], v18 offset:51200
  ds_read_b128 v[48:51], v18 offset:59392
  v_mfma_f32_32x32x16_bf16 v[20:35], v[68:71], v[56:59], v[20:35]
  ds_read_b64_tr_b16 v[64:65], v19 offset:53248
  ds_read_b64_tr_b16 v[66:67], v19 offset:54272
  s_waitcnt lgkmcnt(4)
  v_mfma_f32_32x32x16_bf16 v[20:35], v[60:63], v[36:39], v[20:35]
  ds_read_b128 v[52:55], v18 offset:52224
  ds_read_b128 v[56:59], v18 offset:60416
  v_mfma_f32_32x32x16_bf16 v[20:35], v[60:63], v[40:43], v[20:35]
  ds_read_b64_tr_b16 v[68:69], v19 offset:55296
  ds_read_b64_tr_b16 v[70:71], v19 offset:56320
  s_waitcnt lgkmcnt(4)
  s_barrier
  v_mfma_f32_32x32x16_bf16 v[20:35], v[64:67], v[44:47], v[20:35]
  ds_read_b128 v[36:39], v16 offset:0
  ds_read_b128 v[40:43], v16 offset:8192
  v_mfma_f32_32x32x16_bf16 v[20:35], v[64:67], v[48:51], v[20:35]
  ds_read_b64_tr_b16 v[60:61], v17 offset:0
  ds_read_b64_tr_b16 v[62:63], v17 offset:1024
  s_waitcnt lgkmcnt(4)
  v_mfma_f32_32x32x16_bf16 v[20:35], v[68:71], v[52:55], v[20:35]
  ds_read_b128 v[44:47], v16 offset:1024
  ds_read_b128 v[48:51], v16 offset:9216
  v_mfma_f32_32x32x16_bf16 v[20:35], v[68:71], v[56:59], v[20:35]
  ds_read_b64_tr_b16 v[64:65], v17 offset:2048
  ds_read_b64_tr_b16 v[66:67], v17 offset:3072
  s_waitcnt lgkmcnt(4)
  v_mfma_f32_32x32x16_bf16 v[20:35], v[60:63], v[36:39], v[20:35]
  ds_read_b128 v[52:55], v16 offset:2048
  ds_read_b128 v[56:59], v16 offset:10240
  v_mfma_f32_32x32x16_bf16 v[20:35], v[60:63], v[40:43], v[20:35]
  ds_read_b64_tr_b16 v[68:69], v17 offset:4096
  ds_read_b64_tr_b16 v[70:71], v17 offset:5120
  s_waitcnt lgkmcnt(4)
  v_mfma_f32_32x32x16_bf16 v[20:35], v[64:67], v[44:47], v[20:35]
  ds_read_b128 v[36:39], v16 offset:3072
  ds_read_b128 v[40:43], v16 offset:11264
  v_mfma_f32_32x32x16_bf16 v[20:35], v[64:67], v[48:51], v[20:35]
  ds_read_b64_tr_b16 v[60:61], v17 offset:6144
  ds_read_b64_tr_b16 v[62:63], v17 offset:7168
  s_waitcnt lgkmcnt(4)
  s_barrier
  v_mfma_f32_32x32x16_bf16 v[20:35], v[68:71], v[52:55], v[20:35]
  ds_read_b128 v[44:47], v16 offset:24576
  ds_read_b128 v[48:51], v16 offset:32768
  v_mfma_f32_32x32x16_bf16 v[20:35], v[68:71], v[56:59], v[20:35]
  ds_read_b64_tr_b16 v[64:65], v17 offset:24576
  ds_read_b64_tr_b16 v[66:67], v17 offset:25600
  s_waitcnt lgkmcnt(4)
  v_mfma_f32_32x32x16_bf16 v[20:35], v[60:63], v[36:39], v[20:35]
  ds_read_b128 v[52:55], v16 offset:25600
  ds_read_b128 v[56:59], v16 offset:33792
  v_mfma_f32_32x32x16_bf16 v[20:35], v[60:63], v[40:43], v[20:35]
  ds_read_b64_tr_b16 v[68:69], v17 offset:26624
  ds_read_b64_tr_b16 v[70:71], v17 offset:27648
  s_waitcnt lgkmcnt(4)
  v_mfma_f32_32x32x16_bf16 v[20:35], v[64:67], v[44:47], v[20:35]
  ds_read_b128 v[36:39], v16 offset:26624
  ds_read_b128 v[40:43], v16 offset:34816
  v_mfma_f32_32x32x16_bf16 v[20:35], v[64:67], v[48:51], v[20:35]
  ds_read_b64_tr_b16 v[60:61], v17 offset:28672
  ds_read_b64_tr_b16 v[62:63], v17 offset:29696
  s_waitcnt lgkmcnt(4)
  v_mfma_f32_32x32x16_bf16 v[20:35], v[68:71], v[52:55], v[20:35]
  ds_read_b128 v[44:47], v16 offset:27648
  ds_read_b128 v[48:51], v16 offset:35840
  v_mfma_f32_32x32x16_bf16 v[20:35], v[68:71], v[56:59], v[20:35]
  ds_read_b64_tr_b16 v[64:65], v17 offset:30720
  ds_read_b64_tr_b16 v[66:67], v17 offset:31744
  s_waitcnt lgkmcnt(4)
  s_barrier
  v_mfma_f32_32x32x16_bf16 v[20:35], v[60:63], v[36:39], v[20:35]
  ds_read_b128 v[52:55], v16 offset:49152
  ds_read_b128 v[56:59], v16 offset:57344
  v_mfma_f32_32x32x16_bf16 v[20:35], v[60:63], v[40:43], v[20:35]
  ds_read_b64_tr_b16 v[68:69], v17 offset:49152
  ds_read_b64_tr_b16 v[70:71], v17 offset:50176
  s_waitcnt lgkmcnt(4)
  v_mfma_f32_32x32x16_bf16 v[20:35], v[64:67], v[44:47], v[20:35]
  ds_read_b128 v[36:39], v16 offset:50176
  ds_read_b128 v[40:43], v16 offset:58368
  v_mfma_f32_32x32x16_bf16 v[20:35], v[64:67], v[48:51], v[20:35]
  ds_read_b64_tr_b16 v[60:61], v17 offset:51200
  ds_read_b64_tr_b16 v[62:63], v17 offset:52224
  s_waitcnt lgkmcnt(4)
  v_mfma_f32_32x32x16_bf16 v[20:35], v[68:71], v[52:55], v[20:35]
  ds_read_b128 v[44:47], v16 offset:51200
  ds_read_b128 v[48:51], v16 offset:59392
  v_mfma_f32_32x32x16_bf16 v[20:35], v[68:71], v[56:59], v[20:35]
  ds_read_b64_tr_b16 v[64:65], v17 offset:53248
  ds_read_b64_tr_b16 v[66:67], v17 offset:54272
  s_waitcnt lgkmcnt(4)
  v_mfma_f32_32x32x16_bf16 v[20:35], v[60:63], v[36:39], v[20:35]
  ds_read_b128 v[52:55], v16 offset:52224
  ds_read_b128 v[56:59], v16 offset:60416
  v_mfma_f32_32x32x16_bf16 v[20:35], v[60:63], v[40:43], v[20:35]
  ds_read_b64_tr_b16 v[68:69], v17 offset:55296
  ds_read_b64_tr_b16 v[70:71], v17 offset:56320
  s_waitcnt lgkmcnt(4)
  s_barrier
  v_mfma_f32_32x32x16_bf16 v[20:35], v[64:67], v[44:47], v[20:35]
  ds_read_b128 v[36:39], v18 offset:0
  ds_read_b128 v[40:43], v18 offset:8192
  v_mfma_f32_32x32x16_bf16 v[20:35], v[64:67], v[48:51], v[20:35]
  ds_read_b64_tr_b16 v[60:61], v19 offset:0
  ds_read_b64_tr_b16 v[62:63], v19 offset:1024
  s_waitcnt lgkmcnt(4)
  v_mfma_f32_32x32x16_bf16 v[20:35], v[68:71], v[52:55], v[20:35]
  ds_read_b128 v[44:47], v18 offset:1024
  ds_read_b128 v[48:51], v18 offset:9216
  v_mfma_f32_32x32x16_bf16 v[20:35], v[68:71], v[56:59], v[20:35]
  ds_read_b64_tr_b16 v[64:65], v19 offset:2048
  ds_read_b64_tr_b16 v[66:67], v19 offset:3072
  s_waitcnt lgkmcnt(4)
  v_mfma_f32_32x32x16_bf16 v[20:35], v[60:63], v[36:39], v[20:35]
  ds_read_b128 v[52:55], v18 offset:2048
  ds_read_b128 v[56:59], v18 offset:10240
  v_mfma_f32_32x32x16_bf16 v[20:35], v[60:63], v[40:43], v[20:35]
  ds_read_b64_tr_b16 v[68:69], v19 offset:4096
  ds_read_b64_tr_b16 v[70:71], v19 offset:5120
  s_waitcnt lgkmcnt(4)
  v_mfma_f32_32x32x16_bf16 v[20:35], v[64:67], v[44:47], v[20:35]
  ds_read_b128 v[36:39], v18 offset:3072
  ds_read_b128 v[40:43], v18 offset:11264
  v_mfma_f32_32x32x16_bf16 v[20:35], v[64:67], v[48:51], v[20:35]
  ds_read_b64_tr_b16 v[60:61], v19 offset:6144
  ds_read_b64_tr_b16 v[62:63], v19 offset:7168
  s_waitcnt lgkmcnt(4)
  s_barrier
  v_mfma_f32_32x32x16_bf16 v[20:35], v[68:71], v[52:55], v[20:35]
  ds_read_b128 v[44:47], v18 offset:24576
  ds_read_b128 v[48:51], v18 offset:32768
  v_mfma_f32_32x32x16_bf16 v[20:35], v[68:71], v[56:59], v[20:35]
  ds_read_b64_tr_b16 v[64:65], v19 offset:24576
  ds_read_b64_tr_b16 v[66:67], v19 offset:25600
  s_waitcnt lgkmcnt(4)
  v_mfma_f32_32x32x16_bf16 v[20:35], v[60:63], v[36:39], v[20:35]
  ds_read_b128 v[52:55], v18 offset:25600
  ds_read_b128 v[56:59], v18 offset:33792
  v_mfma_f32_32x32x16_bf16 v[20:35], v[60:63], v[40:43], v[20:35]
  ds_read_b64_tr_b16 v[68:69], v19 offset:26624
  ds_read_b64_tr_b16 v[70:71], v19 offset:27648
  s_waitcnt lgkmcnt(4)
  v_mfma_f32_32x32x16_bf16 v[20:35], v[64:67], v[44:47], v[20:35]
  ds_read_b128 v[36:39], v18 offset:26624
  ds_read_b128 v[40:43], v18 offset:34816
  v_mfma_f32_32x32x16_bf16 v[20:35], v[64:67], v[48:51], v[20:35]
  ds_read_b64_tr_b16 v[60:61], v19 offset:28672
  ds_read_b64_tr_b16 v[62:63], v19 offset:29696
  s_waitcnt lgkmcnt(4)
  v_mfma_f32_32x32x16_bf16 v[20:35], v[68:71], v[52:55], v[20:35]
  ds_read_b128 v[44:47], v18 offset:27648
  ds_read_b128 v[48:51], v18 offset:35840
  v_mfma_f32_32x32x16_bf16 v[20:35], v[68:71], v[56:59], v[20:35]
  ds_read_b64_tr_b16 v[64:65], v19 offset:30720
  ds_read_b64_tr_b16 v[66:67], v19 offset:31744
  s_waitcnt lgkmcnt(4)
  s_barrier
  v_mfma_f32_32x32x16_bf16 v[20:35], v[60:63], v[36:39], v[20:35]
  ds_read_b128 v[52:55], v18 offset:49152
  ds_read_b128 v[56:59], v18 offset:57344
  v_mfma_f32_32x32x16_bf16 v[20:35], v[60:63], v[40:43], v[20:35]
  ds_read_b64_tr_b16 v[68:69], v19 offset:49152
  ds_read_b64_tr_b16 v[70:71], v19 offset:50176
  s_waitcnt lgkmcnt(4)
  v_mfma_f32_32x32x16_bf16 v[20:35], v[64:67], v[44:47], v[20:35]
  ds_read_b128 v[36:39], v18 offset:50176
  ds_read_b128 v[40:43], v18 offset:58368
  v_mfma_f32_32x32x16_bf16 v[20:35], v[64:67], v[48:51], v[20:35]
  ds_read_b64_tr_b16 v[60:61], v19 offset:51200
  ds_read_b64_tr_b16 v[62:63], v19 offset:52224
  s_waitcnt lgkmcnt(4)
  v_mfma_f32_32x32x16_bf16 v[20:35], v[68:71], v[52:55], v[20:35]
  ds_read_b128 v[44:47], v18 offset:51200
  ds_read_b128 v[48:51], v18 offset:59392
  v_mfma_f32_32x32x16_bf16 v[20:35], v[68:71], v[56:59], v[20:35]
  ds_read_b64_tr_b16 v[64:65], v19 offset:53248
  ds_read_b64_tr_b16 v[66:67], v19 offset:54272
  s_waitcnt lgkmcnt(4)
  v_mfma_f32_32x32x16_bf16 v[20:35], v[60:63], v[36:39], v[20:35]
  ds_read_b128 v[52:55], v18 offset:52224
  ds_read_b128 v[56:59], v18 offset:60416
  v_mfma_f32_32x32x16_bf16 v[20:35], v[60:63], v[40:43], v[20:35]
  ds_read_b64_tr_b16 v[68:69], v19 offset:55296
  ds_read_b64_tr_b16 v[70:71], v19 offset:56320
  s_waitcnt lgkmcnt(4)
  s_barrier
  v_mfma_f32_32x32x16_bf16 v[20:35], v[64:67], v[44:47], v[20:35]
  ds_read_b128 v[36:39], v16 offset:0
  ds_read_b128 v[40:43], v16 offset:8192
  v_mfma_f32_32x32x16_bf16 v[20:35], v[64:67], v[48:51], v[20:35]
  ds_read_b64_tr_b16 v[60:61], v17 offset:0
  ds_read_b64_tr_b16 v[62:63], v17 offset:1024
  s_waitcnt lgkmcnt(4)
  v_mfma_f32_32x32x16_bf16 v[20:35], v[68:71], v[52:55], v[20:35]
  ds_read_b128 v[44:47], v16 offset:1024
  ds_read_b128 v[48:51], v16 offset:9216
  v_mfma_f32_32x32x16_bf16 v[20:35], v[68:71], v[56:59], v[20:35]
  ds_read_b64_tr_b16 v[64:65], v17 offset:2048
  ds_read_b64_tr_b16 v[66:67], v17 offset:3072
  s_waitcnt lgkmcnt(4)
  v_mfma_f32_32x32x16_bf16 v[20:35], v[60:63], v[36:39], v[20:35]
  ds_read_b128 v[52:55], v16 offset:2048
  ds_read_b128 v[56:59], v16 offset:10240
  v_mfma_f32_32x32x16_bf16 v[20:35], v[60:63], v[40:43], v[20:35]
  ds_read_b64_tr_b16 v[68:69], v17 offset:4096
  ds_read_b64_tr_b16 v[70:71], v17 offset:5120
  s_waitcnt lgkmcnt(4)
  v_mfma_f32_32x32x16_bf16 v[20:35], v[64:67], v[44:47], v[20:35]
  ds_read_b128 v[36:39], v16 offset:3072
  ds_read_b128 v[40:43], v16 offset:11264
  v_mfma_f32_32x32x16_bf16 v[20:35], v[64:67], v[48:51], v[20:35]
  ds_read_b64_tr_b16 v[60:61], v17 offset:6144
  ds_read_b64_tr_b16 v[62:63], v17 offset:7168
  s_waitcnt lgkmcnt(4)
  s_barrier
  v_mfma_f32_32x32x16_bf16 v[20:35], v[68:71], v[52:55], v[20:35]
  ds_read_b128 v[44:47], v16 offset:24576
  ds_read_b128 v[48:51], v16 offset:32768
  v_mfma_f32_32x32x16_bf16 v[20:35], v[68:71], v[56:59], v[20:35]
  ds_read_b64_tr_b16 v[64:65], v17 offset:24576
  ds_read_b64_tr_b16 v[66:67], v17 offset:25600
  s_waitcnt lgkmcnt(4)
  v_mfma_f32_32x32x16_bf16 v[20:35], v[60:63], v[36:39], v[20:35]
  ds_read_b128 v[52:55], v16 offset:25600
  ds_read_b128 v[56:59], v16 offset:33792
  v_mfma_f32_32x32x16_bf16 v[20:35], v[60:63], v[40:43], v[20:35]
  ds_read_b64_tr_b16 v[68:69], v17 offset:26624
  ds_read_b64_tr_b16 v[70:71], v17 offset:27648
  s_waitcnt lgkmcnt(4)
  v_mfma_f32_32x32x16_bf16 v[20:35], v[64:67], v[44:47], v[20:35]
  ds_read_b128 v[36:39], v16 offset:26624
  ds_read_b128 v[40:43], v16 offset:34816
  v_mfma_f32_32x32x16_bf16 v[20:35], v[64:67], v[48:51], v[20:35]
  ds_read_b64_tr_b16 v[60:61], v17 offset:28672
  ds_read_b64_tr_b16 v[62:63], v17 offset:29696
  s_waitcnt lgkmcnt(4)
  v_mfma_f32_32x32x16_bf16 v[20:35], v[68:71], v[52:55], v[20:35]
  ds_read_b128 v[44:47], v16 offset:27648
  ds_read_b128 v[48:51], v16 offset:35840
  v_mfma_f32_32x32x16_bf16 v[20:35], v[68:71], v[56:59], v[20:35]
  ds_read_b64_tr_b16 v[64:65], v17 offset:30720
  ds_read_b64_tr_b16 v[66:67], v17 offset:31744
  s_waitcnt lgkmcnt(4)
  v_mfma_f32_32x32x16_bf16 v[20:35], v[60:63], v[36:39], v[20:35]
  v_mfma_f32_32x32x16_bf16 v[20:35], v[60:63], v[40:43], v[20:35]
  s_waitcnt lgkmcnt(0)
  v_mfma_f32_32x32x16_bf16 v[20:35], v[64:67], v[44:47], v[20:35]
  v_mfma_f32_32x32x16_bf16 v[20:35], v[64:67], v[48:51], v[20:35]
  s_waitcnt vmcnt(0)
  v_lshlrev_b32 v72, 16, v8
  v_and_b32 v73, 0xffff0000, v8
  s_nop 8
  v_pk_add_f32 v[20:21], v[20:21], v[72:73]
  v_lshlrev_b32 v74, 16, v9
  v_and_b32 v75, 0xffff0000, v9
  v_pk_add_f32 v[22:23], v[22:23], v[74:75]
  v_lshlrev_b32 v76, 16, v10
  v_and_b32 v77, 0xffff0000, v10
  v_pk_add_f32 v[24:25], v[24:25], v[76:77]
  v_lshlrev_b32 v78, 16, v11
  v_and_b32 v79, 0xffff0000, v11
  v_pk_add_f32 v[26:27], v[26:27], v[78:79]
  v_lshlrev_b32 v72, 16, v12
  v_and_b32 v73, 0xffff0000, v12
  v_pk_add_f32 v[28:29], v[28:29], v[72:73]
  v_lshlrev_b32 v74, 16, v13
  v_and_b32 v75, 0xffff0000, v13
  v_pk_add_f32 v[30:31], v[30:31], v[74:75]
  v_lshlrev_b32 v76, 16, v14
  v_and_b32 v77, 0xffff0000, v14
  v_pk_add_f32 v[32:33], v[32:33], v[76:77]
  v_lshlrev_b32 v78, 16, v15
  v_and_b32 v79, 0xffff0000, v15
  v_pk_add_f32 v[34:35], v[34:35], v[78:79]
  v_cvt_pk_bf16_f32 v80, v20, v21
  v_cvt_pk_bf16_f32 v81, v22, v23
  v_cvt_pk_bf16_f32 v82, v24, v25
  v_cvt_pk_bf16_f32 v83, v26, v27
  v_cvt_pk_bf16_f32 v84, v28, v29
  v_cvt_pk_bf16_f32 v85, v30, v31
  v_cvt_pk_bf16_f32 v86, v32, v33
  v_cvt_pk_bf16_f32 v87, v34, v35
  v_permlane32_swap_b32 v80, v82
  v_permlane32_swap_b32 v81, v83
  v_permlane32_swap_b32 v84, v86
  v_permlane32_swap_b32 v85, v87
  v_mul_u32_u24 v88, 896, v5
  v_lshl_add_u32 v88, v6, 4, v88
  s_mul_i32 s7, s43, 28672
  s_lshl_b32 s5, s44, 6
  s_add_u32 s7, s7, s5
  buffer_store_dwordx4 v[80:83], v88, s[24:27], s7 offen offset:0
  buffer_store_dwordx4 v[84:87], v88, s[24:27], s7 offen offset:32
k6_wout_kernel_done_1:
  s_endpgm
k6_wout_kernel_end:
code_end:
.set CODE_BYTES, code_end - k1_qkv_kernel
.section .rodata,"a"
.p2align 6
.amdhsa_kernel k1_qkv_kernel
  .amdhsa_next_free_vgpr 224
  .amdhsa_next_free_sgpr 60
  .amdhsa_accum_offset 224
  .amdhsa_group_segment_fixed_size 0
  .amdhsa_kernarg_size 88
  .amdhsa_user_sgpr_count 2
  .amdhsa_user_sgpr_kernarg_segment_ptr 1
  .amdhsa_system_sgpr_workgroup_id_x 1
  .amdhsa_float_denorm_mode_32 3
  .amdhsa_float_denorm_mode_16_64 3
.end_amdhsa_kernel

.p2align 6
.amdhsa_kernel k2_attn_kernel
  .amdhsa_next_free_vgpr 241
  .amdhsa_next_free_sgpr 49
  .amdhsa_accum_offset 244
  .amdhsa_group_segment_fixed_size 0
  .amdhsa_kernarg_size 88
  .amdhsa_user_sgpr_count 2
  .amdhsa_user_sgpr_kernarg_segment_ptr 1
  .amdhsa_system_sgpr_workgroup_id_x 1
  .amdhsa_float_denorm_mode_32 3
  .amdhsa_float_denorm_mode_16_64 3
.end_amdhsa_kernel

.p2align 6
.amdhsa_kernel k3_wo_kernel
  .amdhsa_next_free_vgpr 87
  .amdhsa_next_free_sgpr 62
  .amdhsa_accum_offset 88
  .amdhsa_group_segment_fixed_size 0
  .amdhsa_kernarg_size 88
  .amdhsa_user_sgpr_count 2
  .amdhsa_user_sgpr_kernarg_segment_ptr 1
  .amdhsa_system_sgpr_workgroup_id_x 1
  .amdhsa_float_denorm_mode_32 3
  .amdhsa_float_denorm_mode_16_64 3
.end_amdhsa_kernel

.p2align 6
.amdhsa_kernel k4_win_kernel
  .amdhsa_next_free_vgpr 200
  .amdhsa_next_free_sgpr 52
  .amdhsa_accum_offset 200
  .amdhsa_group_segment_fixed_size 0
  .amdhsa_kernarg_size 88
  .amdhsa_user_sgpr_count 2
  .amdhsa_user_sgpr_kernarg_segment_ptr 1
  .amdhsa_system_sgpr_workgroup_id_x 1
  .amdhsa_float_denorm_mode_32 3
  .amdhsa_float_denorm_mode_16_64 3
.end_amdhsa_kernel

.p2align 6
.amdhsa_kernel k5_sp_kernel
  .amdhsa_next_free_vgpr 209
  .amdhsa_next_free_sgpr 64
  .amdhsa_accum_offset 212
  .amdhsa_group_segment_fixed_size 0
  .amdhsa_kernarg_size 88
  .amdhsa_user_sgpr_count 2
  .amdhsa_user_sgpr_kernarg_segment_ptr 1
  .amdhsa_system_sgpr_workgroup_id_x 1
  .amdhsa_float_denorm_mode_32 3
  .amdhsa_float_denorm_mode_16_64 3
.end_amdhsa_kernel

.p2align 6
.amdhsa_kernel k6_wout_kernel
  .amdhsa_next_free_vgpr 89
  .amdhsa_next_free_sgpr 45
  .amdhsa_accum_offset 92
  .amdhsa_group_segment_fixed_size 0
  .amdhsa_kernarg_size 88
  .amdhsa_user_sgpr_count 2
  .amdhsa_user_sgpr_kernarg_segment_ptr 1
  .amdhsa_system_sgpr_workgroup_id_x 1
  .amdhsa_float_denorm_mode_32 3
  .amdhsa_float_denorm_mode_16_64 3
.end_amdhsa_kernel
```
